```python
import torch

def _softmax(x, axis=-1):
    return torch.softmax(x, dim=axis)
def _gelu(x):
    return torch.nn.functional.gelu(x, approximate="tanh")
def _silu(x):
    return torch.nn.functional.silu(x)
def _sigmoid(x):
    return torch.sigmoid(x)
def _layernorm(x, axis=-1, eps=1e-5):
    m = x.mean(dim=axis, keepdim=True)
    v = x.var(dim=axis, keepdim=True, unbiased=False)
    return (x - m) / torch.sqrt(v + eps)
def _scatter_add(tgt, idx, src, axis=0):
    return tgt.clone().index_add_(axis, idx, src)
def _segment_sum(src, seg, n):
    out = torch.zeros((n,) + src.shape[1:], dtype=src.dtype)
    return out.index_add_(0, seg, src)
def _pad(x, pw):
    flat = tuple(v for pair in reversed(pw) for v in pair)
    return torch.nn.functional.pad(x, flat)

kernel_name = 'recurrent_scan__sliding_block_cached__dense_activation_relu__prompt'

def setup_inputs():

    _w = (lambda a: (lambda t: t.to(torch.bfloat16) if t.is_floating_point() else t)(torch.as_tensor(a)))
    def _A_setup():
        B, Sq, D = 1, 2048, 1024
        Hq, Hkv, Sk, Dh = 32, 4, 2048, 128
        assert Hq % Hkv == 0, (Hq, Hkv)
        return {
            "x": _w((lambda *s: torch.randn(*s, dtype=torch.bfloat16) * 0.05)(B, Sq, D)),
            "k_cache": _w((lambda *s: torch.randn(*s, dtype=torch.bfloat16) * 0.8)(B, Hkv, Sk, Dh)),
            "v_cache": _w((lambda *s: torch.randn(*s, dtype=torch.bfloat16) * 0.2)(B, Hkv, Sk, Dh)),
            "wq": _w((lambda *s: torch.randn(*s, dtype=torch.bfloat16) * 0.8)(D, Hq * Dh) * (D ** -0.5)),
            "wo": _w((lambda *s: torch.randn(*s, dtype=torch.bfloat16) * 0.2)(Hq * Dh, D) * ((Hq * Dh) ** -0.5)),
        }
    _A_in = _A_setup()

    def _B_setup():
        B, S, D, Dff = 1, 2048, 1024, 3584
        return {
            "x": _w((lambda *s: torch.randn(*s, dtype=torch.bfloat16) * 0.05)(B, S, D)),
            "w1": _w((lambda *s: torch.randn(*s, dtype=torch.bfloat16) * 0.1)(D, Dff)),
            "w2": _w((lambda *s: torch.randn(*s, dtype=torch.bfloat16) * 0.1)(Dff, D)),
        }
    _B_in = _B_setup()

    return {
        "A_x": _A_in["x"],
        "A_k_cache": _A_in["k_cache"],
        "A_v_cache": _A_in["v_cache"],
        "A_wq": _A_in["wq"],
        "A_wo": _A_in["wo"],
        "B_x": _B_in["x"],
        "B_w1": _B_in["w1"],
        "B_w2": _B_in["w2"],
    }

def reference(A_x, A_k_cache, A_v_cache, A_wq, A_wo, B_x, B_w1, B_w2):
    def _A_ref(x, k_cache, v_cache, wq, wo):
        B, Sq, D = x.shape
        Hq, Dh = 32, 128
        Hkv, Sk = k_cache.shape[1], k_cache.shape[2]
        W = min(4096, max(256, Sk // 4))
        rep = Hq // Hkv
        q = (lambda x, *d: x.permute(*d))((x @ wq).reshape(B, Sq, Hq, Dh), 0, 2, 1, 3)
        k = (lambda x, n, axis: torch.repeat_interleave(x, n, dim=axis))(k_cache[:, :, Sk - W:, :], rep, axis=1)
        v = (lambda x, n, axis: torch.repeat_interleave(x, n, dim=axis))(v_cache[:, :, Sk - W:, :], rep, axis=1)
        scores = torch.einsum("bhqd,bhkd->bhqk", q, k) * (Dh ** -0.5)
        p = _softmax(scores, axis=-1)
        o = torch.einsum("bhqk,bhkd->bhqd", p, v)
        return (lambda x, *d: x.permute(*d))(o, 0, 2, 1, 3).reshape(B, Sq, Hq * Dh) @ wo

    def _B_ref(x, w1, w2):
        h = torch.einsum("bsd,df->bsf", x, w1)
        zero = torch.zeros_like(h)
        h = torch.maximum(h, zero)
        return torch.einsum("bsf,fd->bsd", h, w2)

    x = A_x
    xn = _layernorm(x, axis=-1)
    s = _A_ref(xn, A_k_cache, A_v_cache, A_wq, A_wo)
    g = _silu(_B_ref(xn, B_w1, B_w2))
    return x + s * g
```

```asm
; @launch kernel=ln_kernel grid=(1008,1,1) block=(256,1,1) lds=0
; @launch kernel=gemm1_kernel grid=(240,1,1) block=(256,1,1) lds=131072
; @launch kernel=attn_kernel grid=(256,1,1) block=(512,1,1) lds=81920
; @launch kernel=gemm2_kernel grid=(256,1,1) block=(256,1,1) lds=131072
.amdgcn_target "amdgcn-amd-amdhsa--gfx950"
.text
.globl ln_kernel
.p2align 8
.type ln_kernel,@function
ln_kernel:
    s_cmp_ge_u32 s2, 1008
    s_cbranch_scc1 ln_kernel_end
    s_cmp_ge_u32 s2, 512
    s_cbranch_scc1 ln_kernel_pf
    s_load_dwordx2 s[4:5], s[0:1], 0
    s_load_dwordx2 s[6:7], s[0:1], 80
    v_lshrrev_b32 v2, 6, v0
    s_lshl_b32 s16, s2, 2
    v_add_u32 v2, s16, v2
    v_lshlrev_b32 v2, 11, v2
    v_and_b32 v3, 63, v0
    v_lshlrev_b32 v3, 5, v3
    v_add_u32 v1, v2, v3
    s_waitcnt lgkmcnt(0)
    s_mov_b32 s8, s4
    s_and_b32 s9, s5, 65535
    s_mov_b32 s10, 4194304
    s_mov_b32 s11, 131072
    s_mov_b32 s12, s6
    s_and_b32 s13, s7, 65535
    s_mov_b32 s14, 4194304
    s_mov_b32 s15, 131072
    buffer_load_dwordx4 v[4:7], v1, s[8:11], 0 offen
    buffer_load_dwordx4 v[8:11], v1, s[8:11], 0 offen offset:16
    s_waitcnt vmcnt(1)
    v_lshlrev_b32 v12, 16, v4
    v_and_b32 v13, 4294901760, v4
    v_lshlrev_b32 v14, 16, v5
    v_and_b32 v15, 4294901760, v5
    v_lshlrev_b32 v16, 16, v6
    v_and_b32 v17, 4294901760, v6
    v_lshlrev_b32 v18, 16, v7
    v_and_b32 v19, 4294901760, v7
    s_waitcnt vmcnt(0)
    v_lshlrev_b32 v20, 16, v8
    v_and_b32 v21, 4294901760, v8
    v_lshlrev_b32 v22, 16, v9
    v_and_b32 v23, 4294901760, v9
    v_lshlrev_b32 v24, 16, v10
    v_and_b32 v25, 4294901760, v10
    v_lshlrev_b32 v26, 16, v11
    v_and_b32 v27, 4294901760, v11
    v_add_f32 v32, v12, v13
    v_add_f32 v33, v14, v15
    v_add_f32 v34, v16, v17
    v_add_f32 v35, v18, v19
    v_add_f32 v36, v20, v21
    v_add_f32 v37, v22, v23
    v_add_f32 v38, v24, v25
    v_add_f32 v39, v26, v27
    v_add_f32 v32, v32, v36
    v_add_f32 v33, v33, v37
    v_add_f32 v34, v34, v38
    v_add_f32 v35, v35, v39
    v_add_f32 v32, v32, v34
    v_add_f32 v33, v33, v35
    v_add_f32 v28, v32, v33
    ds_swizzle_b32 v29, v28 offset:0x41f
    s_waitcnt lgkmcnt(0)
    v_add_f32 v28, v28, v29
    ds_swizzle_b32 v29, v28 offset:0x81f
    s_waitcnt lgkmcnt(0)
    v_add_f32 v28, v28, v29
    ds_swizzle_b32 v29, v28 offset:0x101f
    s_waitcnt lgkmcnt(0)
    v_add_f32 v28, v28, v29
    ds_swizzle_b32 v29, v28 offset:0x201f
    s_waitcnt lgkmcnt(0)
    v_add_f32 v28, v28, v29
    ds_swizzle_b32 v29, v28 offset:0x401f
    s_waitcnt lgkmcnt(0)
    v_add_f32 v28, v28, v29
    s_nop 0
    v_readlane_b32 s18, v28, 0
    v_readlane_b32 s19, v28, 32
    s_nop 0
    v_mov_b32 v28, s18
    v_add_f32 v28, s19, v28
    v_mul_f32 v30, 0.0009765625, v28
    v_sub_f32 v40, v12, v30
    v_sub_f32 v41, v13, v30
    v_sub_f32 v42, v14, v30
    v_sub_f32 v43, v15, v30
    v_sub_f32 v44, v16, v30
    v_sub_f32 v45, v17, v30
    v_sub_f32 v46, v18, v30
    v_sub_f32 v47, v19, v30
    v_sub_f32 v48, v20, v30
    v_sub_f32 v49, v21, v30
    v_sub_f32 v50, v22, v30
    v_sub_f32 v51, v23, v30
    v_sub_f32 v52, v24, v30
    v_sub_f32 v53, v25, v30
    v_sub_f32 v54, v26, v30
    v_sub_f32 v55, v27, v30
    v_mul_f32 v32, v40, v40
    v_fmac_f32 v32, v41, v41
    v_mul_f32 v33, v42, v42
    v_fmac_f32 v33, v43, v43
    v_mul_f32 v34, v44, v44
    v_fmac_f32 v34, v45, v45
    v_mul_f32 v35, v46, v46
    v_fmac_f32 v35, v47, v47
    v_mul_f32 v36, v48, v48
    v_fmac_f32 v36, v49, v49
    v_mul_f32 v37, v50, v50
    v_fmac_f32 v37, v51, v51
    v_mul_f32 v38, v52, v52
    v_fmac_f32 v38, v53, v53
    v_mul_f32 v39, v54, v54
    v_fmac_f32 v39, v55, v55
    v_add_f32 v32, v32, v36
    v_add_f32 v33, v33, v37
    v_add_f32 v34, v34, v38
    v_add_f32 v35, v35, v39
    v_add_f32 v32, v32, v34
    v_add_f32 v33, v33, v35
    v_add_f32 v28, v32, v33
    ds_swizzle_b32 v29, v28 offset:0x41f
    s_waitcnt lgkmcnt(0)
    v_add_f32 v28, v28, v29
    ds_swizzle_b32 v29, v28 offset:0x81f
    s_waitcnt lgkmcnt(0)
    v_add_f32 v28, v28, v29
    ds_swizzle_b32 v29, v28 offset:0x101f
    s_waitcnt lgkmcnt(0)
    v_add_f32 v28, v28, v29
    ds_swizzle_b32 v29, v28 offset:0x201f
    s_waitcnt lgkmcnt(0)
    v_add_f32 v28, v28, v29
    ds_swizzle_b32 v29, v28 offset:0x401f
    s_waitcnt lgkmcnt(0)
    v_add_f32 v28, v28, v29
    s_nop 0
    v_readlane_b32 s18, v28, 0
    v_readlane_b32 s19, v28, 32
    s_nop 0
    v_mov_b32 v28, s18
    v_add_f32 v28, s19, v28
    v_mul_f32 v56, 0.0009765625, v28
    v_mov_b32 v31, v30
    v_cvt_pk_bf16_f32 v29, v31, v31
    v_lshlrev_b32 v31, 16, v29
    v_cvt_pk_bf16_f32 v29, v56, v56
    v_lshlrev_b32 v56, 16, v29
    v_add_f32 v56, 1e-05, v56
    v_cvt_pk_bf16_f32 v29, v56, v56
    v_lshlrev_b32 v56, 16, v29
    v_sqrt_f32 v56, v56
    s_nop 0
    v_cvt_pk_bf16_f32 v29, v56, v56
    v_lshlrev_b32 v56, 16, v29
    v_rcp_f32 v57, v56
    v_sub_f32 v40, v12, v31
    v_sub_f32 v41, v13, v31
    v_cvt_pk_bf16_f32 v29, v40, v41
    v_lshlrev_b32 v40, 16, v29
    v_and_b32 v41, 4294901760, v29
    v_mul_f32 v32, v40, v57
    v_mul_f32 v33, v41, v57
    v_fma_f32 v34, -v32, v56, v40
    v_fma_f32 v35, -v33, v56, v41
    v_fma_f32 v32, v34, v57, v32
    v_fma_f32 v33, v35, v57, v33
    v_cvt_pk_bf16_f32 v60, v32, v33
    v_sub_f32 v42, v14, v31
    v_sub_f32 v43, v15, v31
    v_cvt_pk_bf16_f32 v29, v42, v43
    v_lshlrev_b32 v42, 16, v29
    v_and_b32 v43, 4294901760, v29
    v_mul_f32 v32, v42, v57
    v_mul_f32 v33, v43, v57
    v_fma_f32 v34, -v32, v56, v42
    v_fma_f32 v35, -v33, v56, v43
    v_fma_f32 v32, v34, v57, v32
    v_fma_f32 v33, v35, v57, v33
    v_cvt_pk_bf16_f32 v61, v32, v33
    v_sub_f32 v44, v16, v31
    v_sub_f32 v45, v17, v31
    v_cvt_pk_bf16_f32 v29, v44, v45
    v_lshlrev_b32 v44, 16, v29
    v_and_b32 v45, 4294901760, v29
    v_mul_f32 v32, v44, v57
    v_mul_f32 v33, v45, v57
    v_fma_f32 v34, -v32, v56, v44
    v_fma_f32 v35, -v33, v56, v45
    v_fma_f32 v32, v34, v57, v32
    v_fma_f32 v33, v35, v57, v33
    v_cvt_pk_bf16_f32 v62, v32, v33
    v_sub_f32 v46, v18, v31
    v_sub_f32 v47, v19, v31
    v_cvt_pk_bf16_f32 v29, v46, v47
    v_lshlrev_b32 v46, 16, v29
    v_and_b32 v47, 4294901760, v29
    v_mul_f32 v32, v46, v57
    v_mul_f32 v33, v47, v57
    v_fma_f32 v34, -v32, v56, v46
    v_fma_f32 v35, -v33, v56, v47
    v_fma_f32 v32, v34, v57, v32
    v_fma_f32 v33, v35, v57, v33
    v_cvt_pk_bf16_f32 v63, v32, v33
    v_sub_f32 v48, v20, v31
    v_sub_f32 v49, v21, v31
    v_cvt_pk_bf16_f32 v29, v48, v49
    v_lshlrev_b32 v48, 16, v29
    v_and_b32 v49, 4294901760, v29
    v_mul_f32 v32, v48, v57
    v_mul_f32 v33, v49, v57
    v_fma_f32 v34, -v32, v56, v48
    v_fma_f32 v35, -v33, v56, v49
    v_fma_f32 v32, v34, v57, v32
    v_fma_f32 v33, v35, v57, v33
    v_cvt_pk_bf16_f32 v64, v32, v33
    v_sub_f32 v50, v22, v31
    v_sub_f32 v51, v23, v31
    v_cvt_pk_bf16_f32 v29, v50, v51
    v_lshlrev_b32 v50, 16, v29
    v_and_b32 v51, 4294901760, v29
    v_mul_f32 v32, v50, v57
    v_mul_f32 v33, v51, v57
    v_fma_f32 v34, -v32, v56, v50
    v_fma_f32 v35, -v33, v56, v51
    v_fma_f32 v32, v34, v57, v32
    v_fma_f32 v33, v35, v57, v33
    v_cvt_pk_bf16_f32 v65, v32, v33
    v_sub_f32 v52, v24, v31
    v_sub_f32 v53, v25, v31
    v_cvt_pk_bf16_f32 v29, v52, v53
    v_lshlrev_b32 v52, 16, v29
    v_and_b32 v53, 4294901760, v29
    v_mul_f32 v32, v52, v57
    v_mul_f32 v33, v53, v57
    v_fma_f32 v34, -v32, v56, v52
    v_fma_f32 v35, -v33, v56, v53
    v_fma_f32 v32, v34, v57, v32
    v_fma_f32 v33, v35, v57, v33
    v_cvt_pk_bf16_f32 v66, v32, v33
    v_sub_f32 v54, v26, v31
    v_sub_f32 v55, v27, v31
    v_cvt_pk_bf16_f32 v29, v54, v55
    v_lshlrev_b32 v54, 16, v29
    v_and_b32 v55, 4294901760, v29
    v_mul_f32 v32, v54, v57
    v_mul_f32 v33, v55, v57
    v_fma_f32 v34, -v32, v56, v54
    v_fma_f32 v35, -v33, v56, v55
    v_fma_f32 v32, v34, v57, v32
    v_fma_f32 v33, v35, v57, v33
    v_cvt_pk_bf16_f32 v67, v32, v33
    buffer_store_dwordx4 v[60:63], v1, s[12:15], 0 offen
    buffer_store_dwordx4 v[64:67], v1, s[12:15], 0 offen offset:16
    s_branch ln_kernel_end
ln_kernel_pf:
    s_waitcnt vmcnt(0) lgkmcnt(0)
    s_nop 15
    s_nop 7
    s_sub_u32 s20, s2, 512
    s_cmp_lt_u32 s20, 480
    s_cbranch_scc1 ln_kernel_pfw
    s_sub_u32 s20, s20, 480
    s_load_dwordx2 s[22:23], s[0:1], 8
    s_load_dwordx2 s[26:27], s[0:1], 16
    s_cmp_ge_u32 s20, 8
    s_waitcnt lgkmcnt(0)
    s_cselect_b32 s22, s26, s22
    s_cmp_ge_u32 s20, 8
    s_cselect_b32 s23, s27, s23
    s_bfe_u32 s21, s20, 131073
    s_lshl_b32 s21, s21, 3
    s_and_b32 s20, s20, 1
    s_add_u32 s20, s20, s21
    s_add_u32 s20, s20, 6
    s_mov_b32 s21, 2097152
    s_branch ln_kernel_pfgo
ln_kernel_pfw:
    s_waitcnt vmcnt(0) lgkmcnt(0)
    s_nop 15
    s_nop 7
    s_cmp_ge_u32 s20, 128
    s_cbranch_scc1 ln_kernel_pf1
    s_load_dwordx2 s[22:23], s[0:1], 24
    s_sub_u32 s20, s20, 0
    s_mov_b32 s21, 8388608
    s_branch ln_kernel_pfgo
ln_kernel_pf1:
    s_waitcnt vmcnt(0) lgkmcnt(0)
    s_nop 15
    s_nop 7
    s_cmp_ge_u32 s20, 240
    s_cbranch_scc1 ln_kernel_pf2
    s_load_dwordx2 s[22:23], s[0:1], 48
    s_sub_u32 s20, s20, 128
    s_mov_b32 s21, 7340032
    s_branch ln_kernel_pfgo
ln_kernel_pf2:
    s_waitcnt vmcnt(0) lgkmcnt(0)
    s_nop 15
    s_nop 7
    s_cmp_ge_u32 s20, 368
    s_cbranch_scc1 ln_kernel_pf3
    s_load_dwordx2 s[22:23], s[0:1], 32
    s_sub_u32 s20, s20, 240
    s_mov_b32 s21, 8388608
    s_branch ln_kernel_pfgo
ln_kernel_pf3:
    s_waitcnt vmcnt(0) lgkmcnt(0)
    s_nop 15
    s_nop 7
    s_load_dwordx2 s[22:23], s[0:1], 56
    s_sub_u32 s20, s20, 368
    s_mov_b32 s21, 7340032
    s_branch ln_kernel_pfgo
ln_kernel_pfgo:
    s_waitcnt vmcnt(0) lgkmcnt(0)
    s_nop 15
    s_nop 7
    s_mov_b32 s8, s22
    s_and_b32 s9, s23, 65535
    s_mov_b32 s10, s21
    s_mov_b32 s11, 131072
    s_lshl_b32 s20, s20, 16
    v_lshlrev_b32 v1, 4, v0
    v_add_u32 v1, s20, v1
    buffer_load_dwordx4 v[4:7], v1, s[8:11], 0 offen
    v_add_u32 v1, 4096, v1
    buffer_load_dwordx4 v[8:11], v1, s[8:11], 0 offen
    v_add_u32 v1, 4096, v1
    buffer_load_dwordx4 v[12:15], v1, s[8:11], 0 offen
    v_add_u32 v1, 4096, v1
    buffer_load_dwordx4 v[16:19], v1, s[8:11], 0 offen
    v_add_u32 v1, 4096, v1
    buffer_load_dwordx4 v[20:23], v1, s[8:11], 0 offen
    v_add_u32 v1, 4096, v1
    buffer_load_dwordx4 v[24:27], v1, s[8:11], 0 offen
    v_add_u32 v1, 4096, v1
    buffer_load_dwordx4 v[28:31], v1, s[8:11], 0 offen
    v_add_u32 v1, 4096, v1
    buffer_load_dwordx4 v[32:35], v1, s[8:11], 0 offen
    v_add_u32 v1, 4096, v1
    buffer_load_dwordx4 v[4:7], v1, s[8:11], 0 offen
    v_add_u32 v1, 4096, v1
    buffer_load_dwordx4 v[8:11], v1, s[8:11], 0 offen
    v_add_u32 v1, 4096, v1
    buffer_load_dwordx4 v[12:15], v1, s[8:11], 0 offen
    v_add_u32 v1, 4096, v1
    buffer_load_dwordx4 v[16:19], v1, s[8:11], 0 offen
    v_add_u32 v1, 4096, v1
    buffer_load_dwordx4 v[20:23], v1, s[8:11], 0 offen
    v_add_u32 v1, 4096, v1
    buffer_load_dwordx4 v[24:27], v1, s[8:11], 0 offen
    v_add_u32 v1, 4096, v1
    buffer_load_dwordx4 v[28:31], v1, s[8:11], 0 offen
    v_add_u32 v1, 4096, v1
    buffer_load_dwordx4 v[32:35], v1, s[8:11], 0 offen
    v_add_u32 v1, 4096, v1
ln_kernel_end:
    s_endpgm
.globl gemm1_kernel
.p2align 8
.type gemm1_kernel,@function
gemm1_kernel:
    s_cmp_ge_u32 s2, 240
    s_cbranch_scc1 gemm1_kernel_end
    s_load_dwordx2 s[32:33], s[0:1], 80
    s_load_dwordx2 s[34:35], s[0:1], 24
    s_load_dwordx2 s[36:37], s[0:1], 48
    s_and_b32 s26, s2, 7
    s_lshr_b32 s27, s2, 3
    s_mul_i32 s30, s26, 14
    s_add_u32 s30, s30, s27
    s_sub_u32 s30, s30, 16
    s_lshl_b32 s29, s26, 1
    s_lshr_b32 s31, s27, 3
    s_add_u32 s29, s29, s31
    s_cmp_lt_u32 s27, 16
    s_cselect_b32 s28, s27, s30
    s_and_b32 s28, s28, 7
    s_lshr_b32 s30, s30, 3
    s_cmp_lt_u32 s27, 16
    s_cselect_b32 s29, s29, s30
    s_cmp_lt_u32 s27, 16
    s_waitcnt lgkmcnt(0)
    s_cselect_b32 s38, s34, s36
    s_cmp_lt_u32 s27, 16
    s_cselect_b32 s39, s35, s37
    s_mov_b32 s21, 7168
    s_cmp_lt_u32 s27, 16
    s_cselect_b32 s21, 8192, s21
    s_mov_b32 s22, 7424
    s_cmp_lt_u32 s27, 16
    s_cselect_b32 s22, 8448, s22
    s_mov_b32 s20, 2048
    s_mov_b32 s23, 1
    s_cmp_lt_u32 s27, 16
    s_cselect_b32 s23, 0, s23
    s_mov_b32 s40, 23068672
    s_cmp_lt_u32 s27, 16
    s_cselect_b32 s40, 4194304, s40
    s_mov_b32 s41, 15204352
    s_cmp_lt_u32 s27, 16
    s_cselect_b32 s41, 17301504, s41
    s_mov_b32 s42, 7340032
    s_cmp_lt_u32 s27, 16
    s_cselect_b32 s42, 8388608, s42
    s_mov_b32 s19, 7
    s_lshl_b32 s43, s28, 19
    s_add_u32 s44, s43, 0
    s_add_u32 s4, s32, s44
    s_addc_u32 s5, s33, 0
    s_and_b32 s5, s5, 65535
    s_mov_b32 s6, 0
    s_mov_b32 s7, 131072
    s_sub_u32 s6, 4194304, s43
    s_lshl_b32 s43, s29, 9
    s_add_u32 s8, s38, s43
    s_addc_u32 s9, s39, 0
    s_and_b32 s9, s9, 65535
    s_mov_b32 s10, 0
    s_mov_b32 s11, 131072
    s_sub_u32 s10, s42, s43
    s_lshl_b32 s44, s28, 8
    s_mul_i32 s44, s44, s22
    s_add_u32 s43, s43, s44
    s_add_u32 s44, s43, s40
    s_add_u32 s12, s32, s44
    s_addc_u32 s13, s33, 0
    s_and_b32 s13, s13, 65535
    s_mov_b32 s14, 0
    s_mov_b32 s15, 131072
    s_sub_u32 s14, s41, s43
    v_and_b32 v168, 63, v0
    v_lshrrev_b32 v169, 6, v0
    s_nop 0
    v_readfirstlane_b32 s26, v169
    s_mul_i32 s24, s26, 8192
    s_mul_i32 s25, s26, 8192
    s_mov_b32 s16, 0
    s_mov_b32 s17, 0
    s_lshl_b32 s18, s21, 6
    s_add_u32 m0, s24, 0
    v_and_b32 v170, 7, v168
    v_lshrrev_b32 v171, 3, v168
    v_mad_u32_u24 v171, v169, 64, v171
    v_add_u32 v172, 0, v171
    v_bfe_u32 v173, v172, 1, 3
    v_xor_b32 v173, v173, v170
    v_lshlrev_b32 v173, 4, v173
    v_mad_u32_u24 v132, v172, s20, v173
    buffer_load_dwordx4 v132, s[4:7], s16 offen lds
    s_add_u32 m0, s24, 1024
    v_add_u32 v172, 8, v171
    v_bfe_u32 v173, v172, 1, 3
    v_xor_b32 v173, v173, v170
    v_lshlrev_b32 v173, 4, v173
    v_mad_u32_u24 v133, v172, s20, v173
    buffer_load_dwordx4 v133, s[4:7], s16 offen lds
    s_add_u32 m0, s24, 2048
    v_add_u32 v172, 16, v171
    v_bfe_u32 v173, v172, 1, 3
    v_xor_b32 v173, v173, v170
    v_lshlrev_b32 v173, 4, v173
    v_mad_u32_u24 v134, v172, s20, v173
    buffer_load_dwordx4 v134, s[4:7], s16 offen lds
    s_add_u32 m0, s24, 3072
    v_add_u32 v172, 24, v171
    v_bfe_u32 v173, v172, 1, 3
    v_xor_b32 v173, v173, v170
    v_lshlrev_b32 v173, 4, v173
    v_mad_u32_u24 v135, v172, s20, v173
    buffer_load_dwordx4 v135, s[4:7], s16 offen lds
    s_add_u32 m0, s24, 4096
    v_add_u32 v172, 32, v171
    v_bfe_u32 v173, v172, 1, 3
    v_xor_b32 v173, v173, v170
    v_lshlrev_b32 v173, 4, v173
    v_mad_u32_u24 v136, v172, s20, v173
    buffer_load_dwordx4 v136, s[4:7], s16 offen lds
    s_add_u32 m0, s24, 5120
    v_add_u32 v172, 40, v171
    v_bfe_u32 v173, v172, 1, 3
    v_xor_b32 v173, v173, v170
    v_lshlrev_b32 v173, 4, v173
    v_mad_u32_u24 v137, v172, s20, v173
    buffer_load_dwordx4 v137, s[4:7], s16 offen lds
    s_add_u32 m0, s24, 6144
    v_add_u32 v172, 48, v171
    v_bfe_u32 v173, v172, 1, 3
    v_xor_b32 v173, v173, v170
    v_lshlrev_b32 v173, 4, v173
    v_mad_u32_u24 v138, v172, s20, v173
    buffer_load_dwordx4 v138, s[4:7], s16 offen lds
    s_add_u32 m0, s24, 7168
    v_add_u32 v172, 56, v171
    v_bfe_u32 v173, v172, 1, 3
    v_xor_b32 v173, v173, v170
    v_lshlrev_b32 v173, 4, v173
    v_mad_u32_u24 v139, v172, s20, v173
    buffer_load_dwordx4 v139, s[4:7], s16 offen lds
    s_add_u32 m0, s25, 32768
    v_and_b32 v170, 31, v168
    v_lshrrev_b32 v171, 5, v168
    v_mad_u32_u24 v171, v169, 16, v171
    v_add_u32 v172, 0, v171
    v_and_b32 v173, 3, v172
    v_bfe_u32 v174, v172, 3, 1
    v_lshl_or_b32 v173, v174, 2, v173
    v_lshrrev_b32 v174, 1, v170
    v_xor_b32 v173, v173, v174
    v_lshlrev_b32 v173, 5, v173
    v_and_b32 v174, 1, v170
    v_lshl_or_b32 v173, v174, 4, v173
    v_mad_u32_u24 v140, v172, s21, v173
    buffer_load_dwordx4 v140, s[8:11], s17 offen lds
    s_add_u32 m0, s25, 33792
    v_add_u32 v172, 2, v171
    v_and_b32 v173, 3, v172
    v_bfe_u32 v174, v172, 3, 1
    v_lshl_or_b32 v173, v174, 2, v173
    v_lshrrev_b32 v174, 1, v170
    v_xor_b32 v173, v173, v174
    v_lshlrev_b32 v173, 5, v173
    v_and_b32 v174, 1, v170
    v_lshl_or_b32 v173, v174, 4, v173
    v_mad_u32_u24 v141, v172, s21, v173
    buffer_load_dwordx4 v141, s[8:11], s17 offen lds
    s_add_u32 m0, s25, 34816
    v_add_u32 v172, 4, v171
    v_and_b32 v173, 3, v172
    v_bfe_u32 v174, v172, 3, 1
    v_lshl_or_b32 v173, v174, 2, v173
    v_lshrrev_b32 v174, 1, v170
    v_xor_b32 v173, v173, v174
    v_lshlrev_b32 v173, 5, v173
    v_and_b32 v174, 1, v170
    v_lshl_or_b32 v173, v174, 4, v173
    v_mad_u32_u24 v142, v172, s21, v173
    buffer_load_dwordx4 v142, s[8:11], s17 offen lds
    s_add_u32 m0, s25, 35840
    v_add_u32 v172, 6, v171
    v_and_b32 v173, 3, v172
    v_bfe_u32 v174, v172, 3, 1
    v_lshl_or_b32 v173, v174, 2, v173
    v_lshrrev_b32 v174, 1, v170
    v_xor_b32 v173, v173, v174
    v_lshlrev_b32 v173, 5, v173
    v_and_b32 v174, 1, v170
    v_lshl_or_b32 v173, v174, 4, v173
    v_mad_u32_u24 v143, v172, s21, v173
    buffer_load_dwordx4 v143, s[8:11], s17 offen lds
    s_add_u32 m0, s25, 36864
    v_add_u32 v172, 8, v171
    v_and_b32 v173, 3, v172
    v_bfe_u32 v174, v172, 3, 1
    v_lshl_or_b32 v173, v174, 2, v173
    v_lshrrev_b32 v174, 1, v170
    v_xor_b32 v173, v173, v174
    v_lshlrev_b32 v173, 5, v173
    v_and_b32 v174, 1, v170
    v_lshl_or_b32 v173, v174, 4, v173
    v_mad_u32_u24 v144, v172, s21, v173
    buffer_load_dwordx4 v144, s[8:11], s17 offen lds
    s_add_u32 m0, s25, 37888
    v_add_u32 v172, 10, v171
    v_and_b32 v173, 3, v172
    v_bfe_u32 v174, v172, 3, 1
    v_lshl_or_b32 v173, v174, 2, v173
    v_lshrrev_b32 v174, 1, v170
    v_xor_b32 v173, v173, v174
    v_lshlrev_b32 v173, 5, v173
    v_and_b32 v174, 1, v170
    v_lshl_or_b32 v173, v174, 4, v173
    v_mad_u32_u24 v145, v172, s21, v173
    buffer_load_dwordx4 v145, s[8:11], s17 offen lds
    s_add_u32 m0, s25, 38912
    v_add_u32 v172, 12, v171
    v_and_b32 v173, 3, v172
    v_bfe_u32 v174, v172, 3, 1
    v_lshl_or_b32 v173, v174, 2, v173
    v_lshrrev_b32 v174, 1, v170
    v_xor_b32 v173, v173, v174
    v_lshlrev_b32 v173, 5, v173
    v_and_b32 v174, 1, v170
    v_lshl_or_b32 v173, v174, 4, v173
    v_mad_u32_u24 v146, v172, s21, v173
    buffer_load_dwordx4 v146, s[8:11], s17 offen lds
    s_add_u32 m0, s25, 39936
    v_add_u32 v172, 14, v171
    v_and_b32 v173, 3, v172
    v_bfe_u32 v174, v172, 3, 1
    v_lshl_or_b32 v173, v174, 2, v173
    v_lshrrev_b32 v174, 1, v170
    v_xor_b32 v173, v173, v174
    v_lshlrev_b32 v173, 5, v173
    v_and_b32 v174, 1, v170
    v_lshl_or_b32 v173, v174, 4, v173
    v_mad_u32_u24 v147, v172, s21, v173
    buffer_load_dwordx4 v147, s[8:11], s17 offen lds
    s_add_u32 s16, s16, 128
    s_add_u32 s17, s17, s18
    s_add_u32 m0, s24, 65536
    v_lshrrev_b32 v170, 1, v169
    v_and_b32 v171, 1, v169
    v_and_b32 v172, 15, v168
    v_lshrrev_b32 v173, 4, v168
    v_mul_u32_u24 v174, 128, v170
    v_add_u32 v174, v174, v172
    v_lshlrev_b32 v174, 7, v174
    v_lshrrev_b32 v175, 1, v172
    v_xor_b32 v175, v175, v173
    v_lshl_add_u32 v148, v175, 4, v174
    v_xor_b32 v149, 64, v148
    v_add_u32 v150, 65536, v148
    v_add_u32 v151, 65536, v149
    v_lshrrev_b32 v176, 4, v168
    v_bfe_u32 v177, v168, 2, 2
    v_and_b32 v178, 3, v168
    v_and_b32 v179, 1, v176
    v_lshl_or_b32 v179, v179, 2, v177
    v_lshl_add_u32 v174, v176, 3, v177
    v_mul_u32_u24 v174, 512, v174
    buffer_load_dwordx4 v132, s[4:7], s16 offen lds
    s_add_u32 m0, s24, 66560
    v_lshl_add_u32 v174, v178, 3, v174
    v_add_u32 v174, 32768, v174
    v_mul_u32_u24 v175, 8, v171
    v_add_u32 v175, 0, v175
    v_xor_b32 v175, v175, v179
    v_lshl_add_u32 v152, v175, 5, v174
    v_add_u32 v160, 65536, v152
    v_mul_u32_u24 v175, 8, v171
    v_add_u32 v175, 1, v175
    v_xor_b32 v175, v175, v179
    v_lshl_add_u32 v153, v175, 5, v174
    v_add_u32 v161, 65536, v153
    v_mul_u32_u24 v175, 8, v171
    v_add_u32 v175, 2, v175
    v_xor_b32 v175, v175, v179
    v_lshl_add_u32 v154, v175, 5, v174
    v_add_u32 v162, 65536, v154
    v_mul_u32_u24 v175, 8, v171
    v_add_u32 v175, 3, v175
    v_xor_b32 v175, v175, v179
    buffer_load_dwordx4 v133, s[4:7], s16 offen lds
    s_add_u32 m0, s24, 67584
    v_lshl_add_u32 v155, v175, 5, v174
    v_add_u32 v163, 65536, v155
    v_mul_u32_u24 v175, 8, v171
    v_add_u32 v175, 4, v175
    v_xor_b32 v175, v175, v179
    v_lshl_add_u32 v156, v175, 5, v174
    v_add_u32 v164, 65536, v156
    v_mul_u32_u24 v175, 8, v171
    v_add_u32 v175, 5, v175
    v_xor_b32 v175, v175, v179
    v_lshl_add_u32 v157, v175, 5, v174
    v_add_u32 v165, 65536, v157
    v_mul_u32_u24 v175, 8, v171
    v_add_u32 v175, 6, v175
    v_xor_b32 v175, v175, v179
    v_lshl_add_u32 v158, v175, 5, v174
    v_add_u32 v166, 65536, v158
    v_mul_u32_u24 v175, 8, v171
    v_add_u32 v175, 7, v175
    v_xor_b32 v175, v175, v179
    buffer_load_dwordx4 v134, s[4:7], s16 offen lds
    s_add_u32 m0, s24, 68608
    v_lshl_add_u32 v159, v175, 5, v174
    v_add_u32 v167, 65536, v159
    v_accvgpr_write_b32 a0, 0
    v_accvgpr_write_b32 a1, 0
    v_accvgpr_write_b32 a2, 0
    v_accvgpr_write_b32 a3, 0
    v_accvgpr_write_b32 a4, 0
    v_accvgpr_write_b32 a5, 0
    v_accvgpr_write_b32 a6, 0
    v_accvgpr_write_b32 a7, 0
    v_accvgpr_write_b32 a8, 0
    v_accvgpr_write_b32 a9, 0
    v_accvgpr_write_b32 a10, 0
    v_accvgpr_write_b32 a11, 0
    v_accvgpr_write_b32 a12, 0
    v_accvgpr_write_b32 a13, 0
    v_accvgpr_write_b32 a14, 0
    v_accvgpr_write_b32 a15, 0
    v_accvgpr_write_b32 a16, 0
    v_accvgpr_write_b32 a17, 0
    buffer_load_dwordx4 v135, s[4:7], s16 offen lds
    s_add_u32 m0, s24, 69632
    v_accvgpr_write_b32 a18, 0
    v_accvgpr_write_b32 a19, 0
    v_accvgpr_write_b32 a20, 0
    v_accvgpr_write_b32 a21, 0
    v_accvgpr_write_b32 a22, 0
    v_accvgpr_write_b32 a23, 0
    v_accvgpr_write_b32 a24, 0
    v_accvgpr_write_b32 a25, 0
    v_accvgpr_write_b32 a26, 0
    v_accvgpr_write_b32 a27, 0
    v_accvgpr_write_b32 a28, 0
    v_accvgpr_write_b32 a29, 0
    v_accvgpr_write_b32 a30, 0
    v_accvgpr_write_b32 a31, 0
    v_accvgpr_write_b32 a32, 0
    v_accvgpr_write_b32 a33, 0
    v_accvgpr_write_b32 a34, 0
    v_accvgpr_write_b32 a35, 0
    v_accvgpr_write_b32 a36, 0
    v_accvgpr_write_b32 a37, 0
    buffer_load_dwordx4 v136, s[4:7], s16 offen lds
    s_add_u32 m0, s24, 70656
    v_accvgpr_write_b32 a38, 0
    v_accvgpr_write_b32 a39, 0
    v_accvgpr_write_b32 a40, 0
    v_accvgpr_write_b32 a41, 0
    v_accvgpr_write_b32 a42, 0
    v_accvgpr_write_b32 a43, 0
    v_accvgpr_write_b32 a44, 0
    v_accvgpr_write_b32 a45, 0
    v_accvgpr_write_b32 a46, 0
    v_accvgpr_write_b32 a47, 0
    v_accvgpr_write_b32 a48, 0
    v_accvgpr_write_b32 a49, 0
    v_accvgpr_write_b32 a50, 0
    v_accvgpr_write_b32 a51, 0
    v_accvgpr_write_b32 a52, 0
    v_accvgpr_write_b32 a53, 0
    v_accvgpr_write_b32 a54, 0
    v_accvgpr_write_b32 a55, 0
    v_accvgpr_write_b32 a56, 0
    v_accvgpr_write_b32 a57, 0
    buffer_load_dwordx4 v137, s[4:7], s16 offen lds
    s_add_u32 m0, s24, 71680
    v_accvgpr_write_b32 a58, 0
    v_accvgpr_write_b32 a59, 0
    v_accvgpr_write_b32 a60, 0
    v_accvgpr_write_b32 a61, 0
    v_accvgpr_write_b32 a62, 0
    v_accvgpr_write_b32 a63, 0
    v_accvgpr_write_b32 a64, 0
    v_accvgpr_write_b32 a65, 0
    v_accvgpr_write_b32 a66, 0
    v_accvgpr_write_b32 a67, 0
    v_accvgpr_write_b32 a68, 0
    v_accvgpr_write_b32 a69, 0
    v_accvgpr_write_b32 a70, 0
    v_accvgpr_write_b32 a71, 0
    v_accvgpr_write_b32 a72, 0
    v_accvgpr_write_b32 a73, 0
    v_accvgpr_write_b32 a74, 0
    v_accvgpr_write_b32 a75, 0
    v_accvgpr_write_b32 a76, 0
    v_accvgpr_write_b32 a77, 0
    buffer_load_dwordx4 v138, s[4:7], s16 offen lds
    s_add_u32 m0, s24, 72704
    v_accvgpr_write_b32 a78, 0
    v_accvgpr_write_b32 a79, 0
    v_accvgpr_write_b32 a80, 0
    v_accvgpr_write_b32 a81, 0
    v_accvgpr_write_b32 a82, 0
    v_accvgpr_write_b32 a83, 0
    v_accvgpr_write_b32 a84, 0
    v_accvgpr_write_b32 a85, 0
    v_accvgpr_write_b32 a86, 0
    v_accvgpr_write_b32 a87, 0
    v_accvgpr_write_b32 a88, 0
    v_accvgpr_write_b32 a89, 0
    v_accvgpr_write_b32 a90, 0
    v_accvgpr_write_b32 a91, 0
    v_accvgpr_write_b32 a92, 0
    v_accvgpr_write_b32 a93, 0
    v_accvgpr_write_b32 a94, 0
    v_accvgpr_write_b32 a95, 0
    v_accvgpr_write_b32 a96, 0
    v_accvgpr_write_b32 a97, 0
    buffer_load_dwordx4 v139, s[4:7], s16 offen lds
    s_add_u32 m0, s25, 98304
    v_accvgpr_write_b32 a98, 0
    v_accvgpr_write_b32 a99, 0
    v_accvgpr_write_b32 a100, 0
    v_accvgpr_write_b32 a101, 0
    v_accvgpr_write_b32 a102, 0
    v_accvgpr_write_b32 a103, 0
    v_accvgpr_write_b32 a104, 0
    v_accvgpr_write_b32 a105, 0
    v_accvgpr_write_b32 a106, 0
    v_accvgpr_write_b32 a107, 0
    v_accvgpr_write_b32 a108, 0
    v_accvgpr_write_b32 a109, 0
    v_accvgpr_write_b32 a110, 0
    v_accvgpr_write_b32 a111, 0
    v_accvgpr_write_b32 a112, 0
    v_accvgpr_write_b32 a113, 0
    v_accvgpr_write_b32 a114, 0
    v_accvgpr_write_b32 a115, 0
    v_accvgpr_write_b32 a116, 0
    v_accvgpr_write_b32 a117, 0
    buffer_load_dwordx4 v140, s[8:11], s17 offen lds
    s_add_u32 m0, s25, 99328
    v_accvgpr_write_b32 a118, 0
    v_accvgpr_write_b32 a119, 0
    v_accvgpr_write_b32 a120, 0
    v_accvgpr_write_b32 a121, 0
    v_accvgpr_write_b32 a122, 0
    v_accvgpr_write_b32 a123, 0
    v_accvgpr_write_b32 a124, 0
    v_accvgpr_write_b32 a125, 0
    v_accvgpr_write_b32 a126, 0
    v_accvgpr_write_b32 a127, 0
    v_accvgpr_write_b32 a128, 0
    v_accvgpr_write_b32 a129, 0
    v_accvgpr_write_b32 a130, 0
    v_accvgpr_write_b32 a131, 0
    v_accvgpr_write_b32 a132, 0
    v_accvgpr_write_b32 a133, 0
    v_accvgpr_write_b32 a134, 0
    v_accvgpr_write_b32 a135, 0
    v_accvgpr_write_b32 a136, 0
    v_accvgpr_write_b32 a137, 0
    buffer_load_dwordx4 v141, s[8:11], s17 offen lds
    s_add_u32 m0, s25, 100352
    v_accvgpr_write_b32 a138, 0
    v_accvgpr_write_b32 a139, 0
    v_accvgpr_write_b32 a140, 0
    v_accvgpr_write_b32 a141, 0
    v_accvgpr_write_b32 a142, 0
    v_accvgpr_write_b32 a143, 0
    v_accvgpr_write_b32 a144, 0
    v_accvgpr_write_b32 a145, 0
    v_accvgpr_write_b32 a146, 0
    v_accvgpr_write_b32 a147, 0
    v_accvgpr_write_b32 a148, 0
    v_accvgpr_write_b32 a149, 0
    v_accvgpr_write_b32 a150, 0
    v_accvgpr_write_b32 a151, 0
    v_accvgpr_write_b32 a152, 0
    v_accvgpr_write_b32 a153, 0
    v_accvgpr_write_b32 a154, 0
    v_accvgpr_write_b32 a155, 0
    v_accvgpr_write_b32 a156, 0
    v_accvgpr_write_b32 a157, 0
    buffer_load_dwordx4 v142, s[8:11], s17 offen lds
    s_add_u32 m0, s25, 101376
    v_accvgpr_write_b32 a158, 0
    v_accvgpr_write_b32 a159, 0
    v_accvgpr_write_b32 a160, 0
    v_accvgpr_write_b32 a161, 0
    v_accvgpr_write_b32 a162, 0
    v_accvgpr_write_b32 a163, 0
    v_accvgpr_write_b32 a164, 0
    v_accvgpr_write_b32 a165, 0
    v_accvgpr_write_b32 a166, 0
    v_accvgpr_write_b32 a167, 0
    v_accvgpr_write_b32 a168, 0
    v_accvgpr_write_b32 a169, 0
    v_accvgpr_write_b32 a170, 0
    v_accvgpr_write_b32 a171, 0
    v_accvgpr_write_b32 a172, 0
    v_accvgpr_write_b32 a173, 0
    v_accvgpr_write_b32 a174, 0
    v_accvgpr_write_b32 a175, 0
    v_accvgpr_write_b32 a176, 0
    v_accvgpr_write_b32 a177, 0
    buffer_load_dwordx4 v143, s[8:11], s17 offen lds
    s_add_u32 m0, s25, 102400
    v_accvgpr_write_b32 a178, 0
    v_accvgpr_write_b32 a179, 0
    v_accvgpr_write_b32 a180, 0
    v_accvgpr_write_b32 a181, 0
    v_accvgpr_write_b32 a182, 0
    v_accvgpr_write_b32 a183, 0
    v_accvgpr_write_b32 a184, 0
    v_accvgpr_write_b32 a185, 0
    v_accvgpr_write_b32 a186, 0
    v_accvgpr_write_b32 a187, 0
    v_accvgpr_write_b32 a188, 0
    v_accvgpr_write_b32 a189, 0
    v_accvgpr_write_b32 a190, 0
    v_accvgpr_write_b32 a191, 0
    v_accvgpr_write_b32 a192, 0
    v_accvgpr_write_b32 a193, 0
    v_accvgpr_write_b32 a194, 0
    v_accvgpr_write_b32 a195, 0
    v_accvgpr_write_b32 a196, 0
    v_accvgpr_write_b32 a197, 0
    buffer_load_dwordx4 v144, s[8:11], s17 offen lds
    s_add_u32 m0, s25, 103424
    v_accvgpr_write_b32 a198, 0
    v_accvgpr_write_b32 a199, 0
    v_accvgpr_write_b32 a200, 0
    v_accvgpr_write_b32 a201, 0
    v_accvgpr_write_b32 a202, 0
    v_accvgpr_write_b32 a203, 0
    v_accvgpr_write_b32 a204, 0
    v_accvgpr_write_b32 a205, 0
    v_accvgpr_write_b32 a206, 0
    v_accvgpr_write_b32 a207, 0
    v_accvgpr_write_b32 a208, 0
    v_accvgpr_write_b32 a209, 0
    v_accvgpr_write_b32 a210, 0
    v_accvgpr_write_b32 a211, 0
    v_accvgpr_write_b32 a212, 0
    v_accvgpr_write_b32 a213, 0
    v_accvgpr_write_b32 a214, 0
    v_accvgpr_write_b32 a215, 0
    v_accvgpr_write_b32 a216, 0
    v_accvgpr_write_b32 a217, 0
    buffer_load_dwordx4 v145, s[8:11], s17 offen lds
    s_add_u32 m0, s25, 104448
    v_accvgpr_write_b32 a218, 0
    v_accvgpr_write_b32 a219, 0
    v_accvgpr_write_b32 a220, 0
    v_accvgpr_write_b32 a221, 0
    v_accvgpr_write_b32 a222, 0
    v_accvgpr_write_b32 a223, 0
    v_accvgpr_write_b32 a224, 0
    v_accvgpr_write_b32 a225, 0
    v_accvgpr_write_b32 a226, 0
    v_accvgpr_write_b32 a227, 0
    v_accvgpr_write_b32 a228, 0
    v_accvgpr_write_b32 a229, 0
    v_accvgpr_write_b32 a230, 0
    v_accvgpr_write_b32 a231, 0
    v_accvgpr_write_b32 a232, 0
    v_accvgpr_write_b32 a233, 0
    v_accvgpr_write_b32 a234, 0
    v_accvgpr_write_b32 a235, 0
    v_accvgpr_write_b32 a236, 0
    v_accvgpr_write_b32 a237, 0
    buffer_load_dwordx4 v146, s[8:11], s17 offen lds
    s_add_u32 m0, s25, 105472
    v_accvgpr_write_b32 a238, 0
    v_accvgpr_write_b32 a239, 0
    v_accvgpr_write_b32 a240, 0
    v_accvgpr_write_b32 a241, 0
    v_accvgpr_write_b32 a242, 0
    v_accvgpr_write_b32 a243, 0
    v_accvgpr_write_b32 a244, 0
    v_accvgpr_write_b32 a245, 0
    v_accvgpr_write_b32 a246, 0
    v_accvgpr_write_b32 a247, 0
    v_accvgpr_write_b32 a248, 0
    v_accvgpr_write_b32 a249, 0
    v_accvgpr_write_b32 a250, 0
    v_accvgpr_write_b32 a251, 0
    v_accvgpr_write_b32 a252, 0
    v_accvgpr_write_b32 a253, 0
    v_accvgpr_write_b32 a254, 0
    v_accvgpr_write_b32 a255, 0
    buffer_load_dwordx4 v147, s[8:11], s17 offen lds
    s_add_u32 s16, s16, 128
    s_add_u32 s17, s17, s18
    s_waitcnt vmcnt(16)
    s_barrier
    ds_read_b64_tr_b16 v[4:5], v152
    ds_read_b64_tr_b16 v[6:7], v152 offset:2048
    ds_read_b128 v[36:39], v148
    ds_read_b64_tr_b16 v[8:9], v153
    ds_read_b64_tr_b16 v[10:11], v153 offset:2048
    ds_read_b128 v[40:43], v148 offset:2048
    ds_read_b64_tr_b16 v[12:13], v154
    ds_read_b64_tr_b16 v[14:15], v154 offset:2048
    ds_read_b128 v[44:47], v148 offset:4096
    ds_read_b64_tr_b16 v[16:17], v155
    ds_read_b64_tr_b16 v[18:19], v155 offset:2048
    ds_read_b128 v[48:51], v148 offset:6144
    ds_read_b64_tr_b16 v[20:21], v156
    ds_read_b64_tr_b16 v[22:23], v156 offset:2048
    ds_read_b128 v[52:55], v148 offset:8192
    ds_read_b64_tr_b16 v[24:25], v157
    ds_read_b64_tr_b16 v[26:27], v157 offset:2048
    ds_read_b128 v[56:59], v148 offset:10240
    ds_read_b64_tr_b16 v[28:29], v158
    ds_read_b64_tr_b16 v[30:31], v158 offset:2048
    ds_read_b128 v[60:63], v148 offset:12288
    ds_read_b64_tr_b16 v[32:33], v159
    ds_read_b64_tr_b16 v[34:35], v159 offset:2048
    ds_read_b128 v[64:67], v148 offset:14336
gemm1_kernel_loop:
    v_mfma_f32_16x16x32_bf16 a[0:3], v[4:7], v[36:39], a[0:3]
    ds_read_b64_tr_b16 v[68:69], v152 offset:16384
    v_mfma_f32_16x16x32_bf16 a[4:7], v[4:7], v[40:43], a[4:7]
    v_mfma_f32_16x16x32_bf16 a[8:11], v[4:7], v[44:47], a[8:11]
    ds_read_b64_tr_b16 v[70:71], v152 offset:18432
    s_waitcnt lgkmcnt(14)
    v_mfma_f32_16x16x32_bf16 a[12:15], v[4:7], v[48:51], a[12:15]
    s_waitcnt lgkmcnt(11)
    v_mfma_f32_16x16x32_bf16 a[16:19], v[4:7], v[52:55], a[16:19]
    ds_read_b128 v[100:103], v149
    s_waitcnt lgkmcnt(9)
    v_mfma_f32_16x16x32_bf16 a[20:23], v[4:7], v[56:59], a[20:23]
    s_waitcnt lgkmcnt(6)
    v_mfma_f32_16x16x32_bf16 a[24:27], v[4:7], v[60:63], a[24:27]
    ds_read_b64_tr_b16 v[72:73], v153 offset:16384
    s_waitcnt lgkmcnt(4)
    v_mfma_f32_16x16x32_bf16 a[28:31], v[4:7], v[64:67], a[28:31]
    v_mfma_f32_16x16x32_bf16 a[32:35], v[8:11], v[36:39], a[32:35]
    ds_read_b64_tr_b16 v[74:75], v153 offset:18432
    v_mfma_f32_16x16x32_bf16 a[36:39], v[8:11], v[40:43], a[36:39]
    v_mfma_f32_16x16x32_bf16 a[40:43], v[8:11], v[44:47], a[40:43]
    ds_read_b128 v[104:107], v149 offset:2048
    v_mfma_f32_16x16x32_bf16 a[44:47], v[8:11], v[48:51], a[44:47]
    v_mfma_f32_16x16x32_bf16 a[48:51], v[8:11], v[52:55], a[48:51]
    ds_read_b64_tr_b16 v[76:77], v154 offset:16384
    v_mfma_f32_16x16x32_bf16 a[52:55], v[8:11], v[56:59], a[52:55]
    v_mfma_f32_16x16x32_bf16 a[56:59], v[8:11], v[60:63], a[56:59]
    ds_read_b64_tr_b16 v[78:79], v154 offset:18432
    v_mfma_f32_16x16x32_bf16 a[60:63], v[8:11], v[64:67], a[60:63]
    v_mfma_f32_16x16x32_bf16 a[64:67], v[12:15], v[36:39], a[64:67]
    ds_read_b128 v[108:111], v149 offset:4096
    v_mfma_f32_16x16x32_bf16 a[68:71], v[12:15], v[40:43], a[68:71]
    v_mfma_f32_16x16x32_bf16 a[72:75], v[12:15], v[44:47], a[72:75]
    ds_read_b64_tr_b16 v[80:81], v155 offset:16384
    v_mfma_f32_16x16x32_bf16 a[76:79], v[12:15], v[48:51], a[76:79]
    v_mfma_f32_16x16x32_bf16 a[80:83], v[12:15], v[52:55], a[80:83]
    ds_read_b64_tr_b16 v[82:83], v155 offset:18432
    v_mfma_f32_16x16x32_bf16 a[84:87], v[12:15], v[56:59], a[84:87]
    v_mfma_f32_16x16x32_bf16 a[88:91], v[12:15], v[60:63], a[88:91]
    ds_read_b128 v[112:115], v149 offset:6144
    v_mfma_f32_16x16x32_bf16 a[92:95], v[12:15], v[64:67], a[92:95]
    v_mfma_f32_16x16x32_bf16 a[96:99], v[16:19], v[36:39], a[96:99]
    ds_read_b64_tr_b16 v[84:85], v156 offset:16384
    v_mfma_f32_16x16x32_bf16 a[100:103], v[16:19], v[40:43], a[100:103]
    v_mfma_f32_16x16x32_bf16 a[104:107], v[16:19], v[44:47], a[104:107]
    ds_read_b64_tr_b16 v[86:87], v156 offset:18432
    v_mfma_f32_16x16x32_bf16 a[108:111], v[16:19], v[48:51], a[108:111]
    v_mfma_f32_16x16x32_bf16 a[112:115], v[16:19], v[52:55], a[112:115]
    ds_read_b128 v[116:119], v149 offset:8192
    v_mfma_f32_16x16x32_bf16 a[116:119], v[16:19], v[56:59], a[116:119]
    v_mfma_f32_16x16x32_bf16 a[120:123], v[16:19], v[60:63], a[120:123]
    ds_read_b64_tr_b16 v[88:89], v157 offset:16384
    v_mfma_f32_16x16x32_bf16 a[124:127], v[16:19], v[64:67], a[124:127]
    v_mfma_f32_16x16x32_bf16 a[128:131], v[20:23], v[36:39], a[128:131]
    ds_read_b64_tr_b16 v[90:91], v157 offset:18432
    v_mfma_f32_16x16x32_bf16 a[132:135], v[20:23], v[40:43], a[132:135]
    v_mfma_f32_16x16x32_bf16 a[136:139], v[20:23], v[44:47], a[136:139]
    ds_read_b128 v[120:123], v149 offset:10240
    v_mfma_f32_16x16x32_bf16 a[140:143], v[20:23], v[48:51], a[140:143]
    v_mfma_f32_16x16x32_bf16 a[144:147], v[20:23], v[52:55], a[144:147]
    ds_read_b64_tr_b16 v[92:93], v158 offset:16384
    v_mfma_f32_16x16x32_bf16 a[148:151], v[20:23], v[56:59], a[148:151]
    v_mfma_f32_16x16x32_bf16 a[152:155], v[20:23], v[60:63], a[152:155]
    ds_read_b64_tr_b16 v[94:95], v158 offset:18432
    v_mfma_f32_16x16x32_bf16 a[156:159], v[20:23], v[64:67], a[156:159]
    v_mfma_f32_16x16x32_bf16 a[160:163], v[24:27], v[36:39], a[160:163]
    ds_read_b128 v[124:127], v149 offset:12288
    v_mfma_f32_16x16x32_bf16 a[164:167], v[24:27], v[40:43], a[164:167]
    v_mfma_f32_16x16x32_bf16 a[168:171], v[24:27], v[44:47], a[168:171]
    ds_read_b64_tr_b16 v[96:97], v159 offset:16384
    v_mfma_f32_16x16x32_bf16 a[172:175], v[24:27], v[48:51], a[172:175]
    v_mfma_f32_16x16x32_bf16 a[176:179], v[24:27], v[52:55], a[176:179]
    ds_read_b64_tr_b16 v[98:99], v159 offset:18432
    v_mfma_f32_16x16x32_bf16 a[180:183], v[24:27], v[56:59], a[180:183]
    v_mfma_f32_16x16x32_bf16 a[184:187], v[24:27], v[60:63], a[184:187]
    ds_read_b128 v[128:131], v149 offset:14336
    v_mfma_f32_16x16x32_bf16 a[188:191], v[24:27], v[64:67], a[188:191]
    v_mfma_f32_16x16x32_bf16 a[192:195], v[28:31], v[36:39], a[192:195]
    v_mfma_f32_16x16x32_bf16 a[196:199], v[28:31], v[40:43], a[196:199]
    v_mfma_f32_16x16x32_bf16 a[200:203], v[28:31], v[44:47], a[200:203]
    v_mfma_f32_16x16x32_bf16 a[204:207], v[28:31], v[48:51], a[204:207]
    v_mfma_f32_16x16x32_bf16 a[208:211], v[28:31], v[52:55], a[208:211]
    v_mfma_f32_16x16x32_bf16 a[212:215], v[28:31], v[56:59], a[212:215]
    v_mfma_f32_16x16x32_bf16 a[216:219], v[28:31], v[60:63], a[216:219]
    v_mfma_f32_16x16x32_bf16 a[220:223], v[28:31], v[64:67], a[220:223]
    v_mfma_f32_16x16x32_bf16 a[224:227], v[32:35], v[36:39], a[224:227]
    v_mfma_f32_16x16x32_bf16 a[228:231], v[32:35], v[40:43], a[228:231]
    v_mfma_f32_16x16x32_bf16 a[232:235], v[32:35], v[44:47], a[232:235]
    v_mfma_f32_16x16x32_bf16 a[236:239], v[32:35], v[48:51], a[236:239]
    v_mfma_f32_16x16x32_bf16 a[240:243], v[32:35], v[52:55], a[240:243]
    v_mfma_f32_16x16x32_bf16 a[244:247], v[32:35], v[56:59], a[244:247]
    v_mfma_f32_16x16x32_bf16 a[248:251], v[32:35], v[60:63], a[248:251]
    v_mfma_f32_16x16x32_bf16 a[252:255], v[32:35], v[64:67], a[252:255]
    s_waitcnt vmcnt(0) lgkmcnt(0)
    s_barrier
    v_mfma_f32_16x16x32_bf16 a[0:3], v[68:71], v[100:103], a[0:3]
    ds_read_b64_tr_b16 v[4:5], v160
    v_mfma_f32_16x16x32_bf16 a[4:7], v[68:71], v[104:107], a[4:7]
    s_add_u32 m0, s24, 0
    v_mfma_f32_16x16x32_bf16 a[8:11], v[68:71], v[108:111], a[8:11]
    ds_read_b64_tr_b16 v[6:7], v160 offset:2048
    buffer_load_dwordx4 v132, s[4:7], s16 offen lds
    v_mfma_f32_16x16x32_bf16 a[12:15], v[68:71], v[112:115], a[12:15]
    v_mfma_f32_16x16x32_bf16 a[16:19], v[68:71], v[116:119], a[16:19]
    ds_read_b128 v[36:39], v150
    s_add_u32 m0, s24, 1024
    v_mfma_f32_16x16x32_bf16 a[20:23], v[68:71], v[120:123], a[20:23]
    v_mfma_f32_16x16x32_bf16 a[24:27], v[68:71], v[124:127], a[24:27]
    ds_read_b64_tr_b16 v[8:9], v161
    buffer_load_dwordx4 v133, s[4:7], s16 offen lds
    v_mfma_f32_16x16x32_bf16 a[28:31], v[68:71], v[128:131], a[28:31]
    v_mfma_f32_16x16x32_bf16 a[32:35], v[72:75], v[100:103], a[32:35]
    ds_read_b64_tr_b16 v[10:11], v161 offset:2048
    s_add_u32 m0, s24, 2048
    v_mfma_f32_16x16x32_bf16 a[36:39], v[72:75], v[104:107], a[36:39]
    v_mfma_f32_16x16x32_bf16 a[40:43], v[72:75], v[108:111], a[40:43]
    ds_read_b128 v[40:43], v150 offset:2048
    buffer_load_dwordx4 v134, s[4:7], s16 offen lds
    v_mfma_f32_16x16x32_bf16 a[44:47], v[72:75], v[112:115], a[44:47]
    v_mfma_f32_16x16x32_bf16 a[48:51], v[72:75], v[116:119], a[48:51]
    ds_read_b64_tr_b16 v[12:13], v162
    s_add_u32 m0, s24, 3072
    v_mfma_f32_16x16x32_bf16 a[52:55], v[72:75], v[120:123], a[52:55]
    v_mfma_f32_16x16x32_bf16 a[56:59], v[72:75], v[124:127], a[56:59]
    ds_read_b64_tr_b16 v[14:15], v162 offset:2048
    buffer_load_dwordx4 v135, s[4:7], s16 offen lds
    v_mfma_f32_16x16x32_bf16 a[60:63], v[72:75], v[128:131], a[60:63]
    v_mfma_f32_16x16x32_bf16 a[64:67], v[76:79], v[100:103], a[64:67]
    ds_read_b128 v[44:47], v150 offset:4096
    s_add_u32 m0, s24, 4096
    v_mfma_f32_16x16x32_bf16 a[68:71], v[76:79], v[104:107], a[68:71]
    v_mfma_f32_16x16x32_bf16 a[72:75], v[76:79], v[108:111], a[72:75]
    ds_read_b64_tr_b16 v[16:17], v163
    buffer_load_dwordx4 v136, s[4:7], s16 offen lds
    v_mfma_f32_16x16x32_bf16 a[76:79], v[76:79], v[112:115], a[76:79]
    v_mfma_f32_16x16x32_bf16 a[80:83], v[76:79], v[116:119], a[80:83]
    ds_read_b64_tr_b16 v[18:19], v163 offset:2048
    s_add_u32 m0, s24, 5120
    v_mfma_f32_16x16x32_bf16 a[84:87], v[76:79], v[120:123], a[84:87]
    v_mfma_f32_16x16x32_bf16 a[88:91], v[76:79], v[124:127], a[88:91]
    ds_read_b128 v[48:51], v150 offset:6144
    buffer_load_dwordx4 v137, s[4:7], s16 offen lds
    v_mfma_f32_16x16x32_bf16 a[92:95], v[76:79], v[128:131], a[92:95]
    v_mfma_f32_16x16x32_bf16 a[96:99], v[80:83], v[100:103], a[96:99]
    ds_read_b64_tr_b16 v[20:21], v164
    s_add_u32 m0, s24, 6144
    v_mfma_f32_16x16x32_bf16 a[100:103], v[80:83], v[104:107], a[100:103]
    v_mfma_f32_16x16x32_bf16 a[104:107], v[80:83], v[108:111], a[104:107]
    ds_read_b64_tr_b16 v[22:23], v164 offset:2048
    buffer_load_dwordx4 v138, s[4:7], s16 offen lds
    v_mfma_f32_16x16x32_bf16 a[108:111], v[80:83], v[112:115], a[108:111]
    v_mfma_f32_16x16x32_bf16 a[112:115], v[80:83], v[116:119], a[112:115]
    ds_read_b128 v[52:55], v150 offset:8192
    s_add_u32 m0, s24, 7168
    v_mfma_f32_16x16x32_bf16 a[116:119], v[80:83], v[120:123], a[116:119]
    v_mfma_f32_16x16x32_bf16 a[120:123], v[80:83], v[124:127], a[120:123]
    ds_read_b64_tr_b16 v[24:25], v165
    buffer_load_dwordx4 v139, s[4:7], s16 offen lds
    v_mfma_f32_16x16x32_bf16 a[124:127], v[80:83], v[128:131], a[124:127]
    v_mfma_f32_16x16x32_bf16 a[128:131], v[84:87], v[100:103], a[128:131]
    ds_read_b64_tr_b16 v[26:27], v165 offset:2048
    s_add_u32 m0, s25, 32768
    v_mfma_f32_16x16x32_bf16 a[132:135], v[84:87], v[104:107], a[132:135]
    v_mfma_f32_16x16x32_bf16 a[136:139], v[84:87], v[108:111], a[136:139]
    ds_read_b128 v[56:59], v150 offset:10240
    buffer_load_dwordx4 v140, s[8:11], s17 offen lds
    v_mfma_f32_16x16x32_bf16 a[140:143], v[84:87], v[112:115], a[140:143]
    v_mfma_f32_16x16x32_bf16 a[144:147], v[84:87], v[116:119], a[144:147]
    ds_read_b64_tr_b16 v[28:29], v166
    s_add_u32 m0, s25, 33792
    v_mfma_f32_16x16x32_bf16 a[148:151], v[84:87], v[120:123], a[148:151]
    v_mfma_f32_16x16x32_bf16 a[152:155], v[84:87], v[124:127], a[152:155]
    ds_read_b64_tr_b16 v[30:31], v166 offset:2048
    buffer_load_dwordx4 v141, s[8:11], s17 offen lds
    v_mfma_f32_16x16x32_bf16 a[156:159], v[84:87], v[128:131], a[156:159]
    v_mfma_f32_16x16x32_bf16 a[160:163], v[88:91], v[100:103], a[160:163]
    ds_read_b128 v[60:63], v150 offset:12288
    s_add_u32 m0, s25, 34816
    v_mfma_f32_16x16x32_bf16 a[164:167], v[88:91], v[104:107], a[164:167]
    v_mfma_f32_16x16x32_bf16 a[168:171], v[88:91], v[108:111], a[168:171]
    ds_read_b64_tr_b16 v[32:33], v167
    buffer_load_dwordx4 v142, s[8:11], s17 offen lds
    v_mfma_f32_16x16x32_bf16 a[172:175], v[88:91], v[112:115], a[172:175]
    v_mfma_f32_16x16x32_bf16 a[176:179], v[88:91], v[116:119], a[176:179]
    ds_read_b64_tr_b16 v[34:35], v167 offset:2048
    s_add_u32 m0, s25, 35840
    v_mfma_f32_16x16x32_bf16 a[180:183], v[88:91], v[120:123], a[180:183]
    v_mfma_f32_16x16x32_bf16 a[184:187], v[88:91], v[124:127], a[184:187]
    ds_read_b128 v[64:67], v150 offset:14336
    buffer_load_dwordx4 v143, s[8:11], s17 offen lds
    v_mfma_f32_16x16x32_bf16 a[188:191], v[88:91], v[128:131], a[188:191]
    v_mfma_f32_16x16x32_bf16 a[192:195], v[92:95], v[100:103], a[192:195]
    s_add_u32 m0, s25, 36864
    v_mfma_f32_16x16x32_bf16 a[196:199], v[92:95], v[104:107], a[196:199]
    v_mfma_f32_16x16x32_bf16 a[200:203], v[92:95], v[108:111], a[200:203]
    buffer_load_dwordx4 v144, s[8:11], s17 offen lds
    v_mfma_f32_16x16x32_bf16 a[204:207], v[92:95], v[112:115], a[204:207]
    v_mfma_f32_16x16x32_bf16 a[208:211], v[92:95], v[116:119], a[208:211]
    s_add_u32 m0, s25, 37888
    v_mfma_f32_16x16x32_bf16 a[212:215], v[92:95], v[120:123], a[212:215]
    v_mfma_f32_16x16x32_bf16 a[216:219], v[92:95], v[124:127], a[216:219]
    buffer_load_dwordx4 v145, s[8:11], s17 offen lds
    v_mfma_f32_16x16x32_bf16 a[220:223], v[92:95], v[128:131], a[220:223]
    v_mfma_f32_16x16x32_bf16 a[224:227], v[96:99], v[100:103], a[224:227]
    s_add_u32 m0, s25, 38912
    v_mfma_f32_16x16x32_bf16 a[228:231], v[96:99], v[104:107], a[228:231]
    v_mfma_f32_16x16x32_bf16 a[232:235], v[96:99], v[108:111], a[232:235]
    buffer_load_dwordx4 v146, s[8:11], s17 offen lds
    v_mfma_f32_16x16x32_bf16 a[236:239], v[96:99], v[112:115], a[236:239]
    v_mfma_f32_16x16x32_bf16 a[240:243], v[96:99], v[116:119], a[240:243]
    s_add_u32 m0, s25, 39936
    v_mfma_f32_16x16x32_bf16 a[244:247], v[96:99], v[120:123], a[244:247]
    v_mfma_f32_16x16x32_bf16 a[248:251], v[96:99], v[124:127], a[248:251]
    buffer_load_dwordx4 v147, s[8:11], s17 offen lds
    v_mfma_f32_16x16x32_bf16 a[252:255], v[96:99], v[128:131], a[252:255]
    s_add_u32 s16, s16, 128
    s_add_u32 s17, s17, s18
    v_mfma_f32_16x16x32_bf16 a[0:3], v[4:7], v[36:39], a[0:3]
    ds_read_b64_tr_b16 v[68:69], v160 offset:16384
    v_mfma_f32_16x16x32_bf16 a[4:7], v[4:7], v[40:43], a[4:7]
    v_mfma_f32_16x16x32_bf16 a[8:11], v[4:7], v[44:47], a[8:11]
    ds_read_b64_tr_b16 v[70:71], v160 offset:18432
    s_waitcnt lgkmcnt(14)
    v_mfma_f32_16x16x32_bf16 a[12:15], v[4:7], v[48:51], a[12:15]
    s_waitcnt lgkmcnt(11)
    v_mfma_f32_16x16x32_bf16 a[16:19], v[4:7], v[52:55], a[16:19]
    ds_read_b128 v[100:103], v151
    s_waitcnt lgkmcnt(9)
    v_mfma_f32_16x16x32_bf16 a[20:23], v[4:7], v[56:59], a[20:23]
    s_waitcnt lgkmcnt(6)
    v_mfma_f32_16x16x32_bf16 a[24:27], v[4:7], v[60:63], a[24:27]
    ds_read_b64_tr_b16 v[72:73], v161 offset:16384
    s_waitcnt lgkmcnt(4)
    v_mfma_f32_16x16x32_bf16 a[28:31], v[4:7], v[64:67], a[28:31]
    v_mfma_f32_16x16x32_bf16 a[32:35], v[8:11], v[36:39], a[32:35]
    ds_read_b64_tr_b16 v[74:75], v161 offset:18432
    v_mfma_f32_16x16x32_bf16 a[36:39], v[8:11], v[40:43], a[36:39]
    v_mfma_f32_16x16x32_bf16 a[40:43], v[8:11], v[44:47], a[40:43]
    ds_read_b128 v[104:107], v151 offset:2048
    v_mfma_f32_16x16x32_bf16 a[44:47], v[8:11], v[48:51], a[44:47]
    v_mfma_f32_16x16x32_bf16 a[48:51], v[8:11], v[52:55], a[48:51]
    ds_read_b64_tr_b16 v[76:77], v162 offset:16384
    v_mfma_f32_16x16x32_bf16 a[52:55], v[8:11], v[56:59], a[52:55]
    v_mfma_f32_16x16x32_bf16 a[56:59], v[8:11], v[60:63], a[56:59]
    ds_read_b64_tr_b16 v[78:79], v162 offset:18432
    v_mfma_f32_16x16x32_bf16 a[60:63], v[8:11], v[64:67], a[60:63]
    v_mfma_f32_16x16x32_bf16 a[64:67], v[12:15], v[36:39], a[64:67]
    ds_read_b128 v[108:111], v151 offset:4096
    v_mfma_f32_16x16x32_bf16 a[68:71], v[12:15], v[40:43], a[68:71]
    v_mfma_f32_16x16x32_bf16 a[72:75], v[12:15], v[44:47], a[72:75]
    ds_read_b64_tr_b16 v[80:81], v163 offset:16384
    v_mfma_f32_16x16x32_bf16 a[76:79], v[12:15], v[48:51], a[76:79]
    v_mfma_f32_16x16x32_bf16 a[80:83], v[12:15], v[52:55], a[80:83]
    ds_read_b64_tr_b16 v[82:83], v163 offset:18432
    v_mfma_f32_16x16x32_bf16 a[84:87], v[12:15], v[56:59], a[84:87]
    v_mfma_f32_16x16x32_bf16 a[88:91], v[12:15], v[60:63], a[88:91]
    ds_read_b128 v[112:115], v151 offset:6144
    v_mfma_f32_16x16x32_bf16 a[92:95], v[12:15], v[64:67], a[92:95]
    v_mfma_f32_16x16x32_bf16 a[96:99], v[16:19], v[36:39], a[96:99]
    ds_read_b64_tr_b16 v[84:85], v164 offset:16384
    v_mfma_f32_16x16x32_bf16 a[100:103], v[16:19], v[40:43], a[100:103]
    v_mfma_f32_16x16x32_bf16 a[104:107], v[16:19], v[44:47], a[104:107]
    ds_read_b64_tr_b16 v[86:87], v164 offset:18432
    v_mfma_f32_16x16x32_bf16 a[108:111], v[16:19], v[48:51], a[108:111]
    v_mfma_f32_16x16x32_bf16 a[112:115], v[16:19], v[52:55], a[112:115]
    ds_read_b128 v[116:119], v151 offset:8192
    v_mfma_f32_16x16x32_bf16 a[116:119], v[16:19], v[56:59], a[116:119]
    v_mfma_f32_16x16x32_bf16 a[120:123], v[16:19], v[60:63], a[120:123]
    ds_read_b64_tr_b16 v[88:89], v165 offset:16384
    v_mfma_f32_16x16x32_bf16 a[124:127], v[16:19], v[64:67], a[124:127]
    v_mfma_f32_16x16x32_bf16 a[128:131], v[20:23], v[36:39], a[128:131]
    ds_read_b64_tr_b16 v[90:91], v165 offset:18432
    v_mfma_f32_16x16x32_bf16 a[132:135], v[20:23], v[40:43], a[132:135]
    v_mfma_f32_16x16x32_bf16 a[136:139], v[20:23], v[44:47], a[136:139]
    ds_read_b128 v[120:123], v151 offset:10240
    v_mfma_f32_16x16x32_bf16 a[140:143], v[20:23], v[48:51], a[140:143]
    v_mfma_f32_16x16x32_bf16 a[144:147], v[20:23], v[52:55], a[144:147]
    ds_read_b64_tr_b16 v[92:93], v166 offset:16384
    v_mfma_f32_16x16x32_bf16 a[148:151], v[20:23], v[56:59], a[148:151]
    v_mfma_f32_16x16x32_bf16 a[152:155], v[20:23], v[60:63], a[152:155]
    ds_read_b64_tr_b16 v[94:95], v166 offset:18432
    v_mfma_f32_16x16x32_bf16 a[156:159], v[20:23], v[64:67], a[156:159]
    v_mfma_f32_16x16x32_bf16 a[160:163], v[24:27], v[36:39], a[160:163]
    ds_read_b128 v[124:127], v151 offset:12288
    v_mfma_f32_16x16x32_bf16 a[164:167], v[24:27], v[40:43], a[164:167]
    v_mfma_f32_16x16x32_bf16 a[168:171], v[24:27], v[44:47], a[168:171]
    ds_read_b64_tr_b16 v[96:97], v167 offset:16384
    v_mfma_f32_16x16x32_bf16 a[172:175], v[24:27], v[48:51], a[172:175]
    v_mfma_f32_16x16x32_bf16 a[176:179], v[24:27], v[52:55], a[176:179]
    ds_read_b64_tr_b16 v[98:99], v167 offset:18432
    v_mfma_f32_16x16x32_bf16 a[180:183], v[24:27], v[56:59], a[180:183]
    v_mfma_f32_16x16x32_bf16 a[184:187], v[24:27], v[60:63], a[184:187]
    ds_read_b128 v[128:131], v151 offset:14336
    v_mfma_f32_16x16x32_bf16 a[188:191], v[24:27], v[64:67], a[188:191]
    v_mfma_f32_16x16x32_bf16 a[192:195], v[28:31], v[36:39], a[192:195]
    v_mfma_f32_16x16x32_bf16 a[196:199], v[28:31], v[40:43], a[196:199]
    v_mfma_f32_16x16x32_bf16 a[200:203], v[28:31], v[44:47], a[200:203]
    v_mfma_f32_16x16x32_bf16 a[204:207], v[28:31], v[48:51], a[204:207]
    v_mfma_f32_16x16x32_bf16 a[208:211], v[28:31], v[52:55], a[208:211]
    v_mfma_f32_16x16x32_bf16 a[212:215], v[28:31], v[56:59], a[212:215]
    v_mfma_f32_16x16x32_bf16 a[216:219], v[28:31], v[60:63], a[216:219]
    v_mfma_f32_16x16x32_bf16 a[220:223], v[28:31], v[64:67], a[220:223]
    v_mfma_f32_16x16x32_bf16 a[224:227], v[32:35], v[36:39], a[224:227]
    v_mfma_f32_16x16x32_bf16 a[228:231], v[32:35], v[40:43], a[228:231]
    v_mfma_f32_16x16x32_bf16 a[232:235], v[32:35], v[44:47], a[232:235]
    v_mfma_f32_16x16x32_bf16 a[236:239], v[32:35], v[48:51], a[236:239]
    v_mfma_f32_16x16x32_bf16 a[240:243], v[32:35], v[52:55], a[240:243]
    v_mfma_f32_16x16x32_bf16 a[244:247], v[32:35], v[56:59], a[244:247]
    v_mfma_f32_16x16x32_bf16 a[248:251], v[32:35], v[60:63], a[248:251]
    v_mfma_f32_16x16x32_bf16 a[252:255], v[32:35], v[64:67], a[252:255]
    s_waitcnt vmcnt(0) lgkmcnt(0)
    s_barrier
    v_mfma_f32_16x16x32_bf16 a[0:3], v[68:71], v[100:103], a[0:3]
    ds_read_b64_tr_b16 v[4:5], v152
    v_mfma_f32_16x16x32_bf16 a[4:7], v[68:71], v[104:107], a[4:7]
    s_add_u32 m0, s24, 65536
    v_mfma_f32_16x16x32_bf16 a[8:11], v[68:71], v[108:111], a[8:11]
    ds_read_b64_tr_b16 v[6:7], v152 offset:2048
    buffer_load_dwordx4 v132, s[4:7], s16 offen lds
    v_mfma_f32_16x16x32_bf16 a[12:15], v[68:71], v[112:115], a[12:15]
    v_mfma_f32_16x16x32_bf16 a[16:19], v[68:71], v[116:119], a[16:19]
    ds_read_b128 v[36:39], v148
    s_add_u32 m0, s24, 66560
    v_mfma_f32_16x16x32_bf16 a[20:23], v[68:71], v[120:123], a[20:23]
    v_mfma_f32_16x16x32_bf16 a[24:27], v[68:71], v[124:127], a[24:27]
    ds_read_b64_tr_b16 v[8:9], v153
    buffer_load_dwordx4 v133, s[4:7], s16 offen lds
    v_mfma_f32_16x16x32_bf16 a[28:31], v[68:71], v[128:131], a[28:31]
    v_mfma_f32_16x16x32_bf16 a[32:35], v[72:75], v[100:103], a[32:35]
    ds_read_b64_tr_b16 v[10:11], v153 offset:2048
    s_add_u32 m0, s24, 67584
    v_mfma_f32_16x16x32_bf16 a[36:39], v[72:75], v[104:107], a[36:39]
    v_mfma_f32_16x16x32_bf16 a[40:43], v[72:75], v[108:111], a[40:43]
    ds_read_b128 v[40:43], v148 offset:2048
    buffer_load_dwordx4 v134, s[4:7], s16 offen lds
    v_mfma_f32_16x16x32_bf16 a[44:47], v[72:75], v[112:115], a[44:47]
    v_mfma_f32_16x16x32_bf16 a[48:51], v[72:75], v[116:119], a[48:51]
    ds_read_b64_tr_b16 v[12:13], v154
    s_add_u32 m0, s24, 68608
    v_mfma_f32_16x16x32_bf16 a[52:55], v[72:75], v[120:123], a[52:55]
    v_mfma_f32_16x16x32_bf16 a[56:59], v[72:75], v[124:127], a[56:59]
    ds_read_b64_tr_b16 v[14:15], v154 offset:2048
    buffer_load_dwordx4 v135, s[4:7], s16 offen lds
    v_mfma_f32_16x16x32_bf16 a[60:63], v[72:75], v[128:131], a[60:63]
    v_mfma_f32_16x16x32_bf16 a[64:67], v[76:79], v[100:103], a[64:67]
    ds_read_b128 v[44:47], v148 offset:4096
    s_add_u32 m0, s24, 69632
    v_mfma_f32_16x16x32_bf16 a[68:71], v[76:79], v[104:107], a[68:71]
    v_mfma_f32_16x16x32_bf16 a[72:75], v[76:79], v[108:111], a[72:75]
    ds_read_b64_tr_b16 v[16:17], v155
    buffer_load_dwordx4 v136, s[4:7], s16 offen lds
    v_mfma_f32_16x16x32_bf16 a[76:79], v[76:79], v[112:115], a[76:79]
    v_mfma_f32_16x16x32_bf16 a[80:83], v[76:79], v[116:119], a[80:83]
    ds_read_b64_tr_b16 v[18:19], v155 offset:2048
    s_add_u32 m0, s24, 70656
    v_mfma_f32_16x16x32_bf16 a[84:87], v[76:79], v[120:123], a[84:87]
    v_mfma_f32_16x16x32_bf16 a[88:91], v[76:79], v[124:127], a[88:91]
    ds_read_b128 v[48:51], v148 offset:6144
    buffer_load_dwordx4 v137, s[4:7], s16 offen lds
    v_mfma_f32_16x16x32_bf16 a[92:95], v[76:79], v[128:131], a[92:95]
    v_mfma_f32_16x16x32_bf16 a[96:99], v[80:83], v[100:103], a[96:99]
    ds_read_b64_tr_b16 v[20:21], v156
    s_add_u32 m0, s24, 71680
    v_mfma_f32_16x16x32_bf16 a[100:103], v[80:83], v[104:107], a[100:103]
    v_mfma_f32_16x16x32_bf16 a[104:107], v[80:83], v[108:111], a[104:107]
    ds_read_b64_tr_b16 v[22:23], v156 offset:2048
    buffer_load_dwordx4 v138, s[4:7], s16 offen lds
    v_mfma_f32_16x16x32_bf16 a[108:111], v[80:83], v[112:115], a[108:111]
    v_mfma_f32_16x16x32_bf16 a[112:115], v[80:83], v[116:119], a[112:115]
    ds_read_b128 v[52:55], v148 offset:8192
    s_add_u32 m0, s24, 72704
    v_mfma_f32_16x16x32_bf16 a[116:119], v[80:83], v[120:123], a[116:119]
    v_mfma_f32_16x16x32_bf16 a[120:123], v[80:83], v[124:127], a[120:123]
    ds_read_b64_tr_b16 v[24:25], v157
    buffer_load_dwordx4 v139, s[4:7], s16 offen lds
    v_mfma_f32_16x16x32_bf16 a[124:127], v[80:83], v[128:131], a[124:127]
    v_mfma_f32_16x16x32_bf16 a[128:131], v[84:87], v[100:103], a[128:131]
    ds_read_b64_tr_b16 v[26:27], v157 offset:2048
    s_add_u32 m0, s25, 98304
    v_mfma_f32_16x16x32_bf16 a[132:135], v[84:87], v[104:107], a[132:135]
    v_mfma_f32_16x16x32_bf16 a[136:139], v[84:87], v[108:111], a[136:139]
    ds_read_b128 v[56:59], v148 offset:10240
    buffer_load_dwordx4 v140, s[8:11], s17 offen lds
    v_mfma_f32_16x16x32_bf16 a[140:143], v[84:87], v[112:115], a[140:143]
    v_mfma_f32_16x16x32_bf16 a[144:147], v[84:87], v[116:119], a[144:147]
    ds_read_b64_tr_b16 v[28:29], v158
    s_add_u32 m0, s25, 99328
    v_mfma_f32_16x16x32_bf16 a[148:151], v[84:87], v[120:123], a[148:151]
    v_mfma_f32_16x16x32_bf16 a[152:155], v[84:87], v[124:127], a[152:155]
    ds_read_b64_tr_b16 v[30:31], v158 offset:2048
    buffer_load_dwordx4 v141, s[8:11], s17 offen lds
    v_mfma_f32_16x16x32_bf16 a[156:159], v[84:87], v[128:131], a[156:159]
    v_mfma_f32_16x16x32_bf16 a[160:163], v[88:91], v[100:103], a[160:163]
    ds_read_b128 v[60:63], v148 offset:12288
    s_add_u32 m0, s25, 100352
    v_mfma_f32_16x16x32_bf16 a[164:167], v[88:91], v[104:107], a[164:167]
    v_mfma_f32_16x16x32_bf16 a[168:171], v[88:91], v[108:111], a[168:171]
    ds_read_b64_tr_b16 v[32:33], v159
    buffer_load_dwordx4 v142, s[8:11], s17 offen lds
    v_mfma_f32_16x16x32_bf16 a[172:175], v[88:91], v[112:115], a[172:175]
    v_mfma_f32_16x16x32_bf16 a[176:179], v[88:91], v[116:119], a[176:179]
    ds_read_b64_tr_b16 v[34:35], v159 offset:2048
    s_add_u32 m0, s25, 101376
    v_mfma_f32_16x16x32_bf16 a[180:183], v[88:91], v[120:123], a[180:183]
    v_mfma_f32_16x16x32_bf16 a[184:187], v[88:91], v[124:127], a[184:187]
    ds_read_b128 v[64:67], v148 offset:14336
    buffer_load_dwordx4 v143, s[8:11], s17 offen lds
    v_mfma_f32_16x16x32_bf16 a[188:191], v[88:91], v[128:131], a[188:191]
    v_mfma_f32_16x16x32_bf16 a[192:195], v[92:95], v[100:103], a[192:195]
    s_add_u32 m0, s25, 102400
    v_mfma_f32_16x16x32_bf16 a[196:199], v[92:95], v[104:107], a[196:199]
    v_mfma_f32_16x16x32_bf16 a[200:203], v[92:95], v[108:111], a[200:203]
    buffer_load_dwordx4 v144, s[8:11], s17 offen lds
    v_mfma_f32_16x16x32_bf16 a[204:207], v[92:95], v[112:115], a[204:207]
    v_mfma_f32_16x16x32_bf16 a[208:211], v[92:95], v[116:119], a[208:211]
    s_add_u32 m0, s25, 103424
    v_mfma_f32_16x16x32_bf16 a[212:215], v[92:95], v[120:123], a[212:215]
    v_mfma_f32_16x16x32_bf16 a[216:219], v[92:95], v[124:127], a[216:219]
    buffer_load_dwordx4 v145, s[8:11], s17 offen lds
    v_mfma_f32_16x16x32_bf16 a[220:223], v[92:95], v[128:131], a[220:223]
    v_mfma_f32_16x16x32_bf16 a[224:227], v[96:99], v[100:103], a[224:227]
    s_add_u32 m0, s25, 104448
    v_mfma_f32_16x16x32_bf16 a[228:231], v[96:99], v[104:107], a[228:231]
    v_mfma_f32_16x16x32_bf16 a[232:235], v[96:99], v[108:111], a[232:235]
    buffer_load_dwordx4 v146, s[8:11], s17 offen lds
    v_mfma_f32_16x16x32_bf16 a[236:239], v[96:99], v[112:115], a[236:239]
    v_mfma_f32_16x16x32_bf16 a[240:243], v[96:99], v[116:119], a[240:243]
    s_add_u32 m0, s25, 105472
    v_mfma_f32_16x16x32_bf16 a[244:247], v[96:99], v[120:123], a[244:247]
    v_mfma_f32_16x16x32_bf16 a[248:251], v[96:99], v[124:127], a[248:251]
    buffer_load_dwordx4 v147, s[8:11], s17 offen lds
    v_mfma_f32_16x16x32_bf16 a[252:255], v[96:99], v[128:131], a[252:255]
    s_add_u32 s16, s16, 128
    s_add_u32 s17, s17, s18
    s_sub_u32 s19, s19, 1
    s_cmp_lg_u32 s19, 0
    s_cbranch_scc1 gemm1_kernel_loop
    v_mfma_f32_16x16x32_bf16 a[0:3], v[4:7], v[36:39], a[0:3]
    ds_read_b64_tr_b16 v[68:69], v152 offset:16384
    v_mfma_f32_16x16x32_bf16 a[4:7], v[4:7], v[40:43], a[4:7]
    v_mfma_f32_16x16x32_bf16 a[8:11], v[4:7], v[44:47], a[8:11]
    ds_read_b64_tr_b16 v[70:71], v152 offset:18432
    s_waitcnt lgkmcnt(14)
    v_mfma_f32_16x16x32_bf16 a[12:15], v[4:7], v[48:51], a[12:15]
    s_waitcnt lgkmcnt(11)
    v_mfma_f32_16x16x32_bf16 a[16:19], v[4:7], v[52:55], a[16:19]
    ds_read_b128 v[100:103], v149
    s_waitcnt lgkmcnt(9)
    v_mfma_f32_16x16x32_bf16 a[20:23], v[4:7], v[56:59], a[20:23]
    s_waitcnt lgkmcnt(6)
    v_mfma_f32_16x16x32_bf16 a[24:27], v[4:7], v[60:63], a[24:27]
    ds_read_b64_tr_b16 v[72:73], v153 offset:16384
    s_waitcnt lgkmcnt(4)
    v_mfma_f32_16x16x32_bf16 a[28:31], v[4:7], v[64:67], a[28:31]
    v_mfma_f32_16x16x32_bf16 a[32:35], v[8:11], v[36:39], a[32:35]
    ds_read_b64_tr_b16 v[74:75], v153 offset:18432
    v_mfma_f32_16x16x32_bf16 a[36:39], v[8:11], v[40:43], a[36:39]
    v_mfma_f32_16x16x32_bf16 a[40:43], v[8:11], v[44:47], a[40:43]
    ds_read_b128 v[104:107], v149 offset:2048
    v_mfma_f32_16x16x32_bf16 a[44:47], v[8:11], v[48:51], a[44:47]
    v_mfma_f32_16x16x32_bf16 a[48:51], v[8:11], v[52:55], a[48:51]
    ds_read_b64_tr_b16 v[76:77], v154 offset:16384
    v_mfma_f32_16x16x32_bf16 a[52:55], v[8:11], v[56:59], a[52:55]
    v_mfma_f32_16x16x32_bf16 a[56:59], v[8:11], v[60:63], a[56:59]
    ds_read_b64_tr_b16 v[78:79], v154 offset:18432
    v_mfma_f32_16x16x32_bf16 a[60:63], v[8:11], v[64:67], a[60:63]
    v_mfma_f32_16x16x32_bf16 a[64:67], v[12:15], v[36:39], a[64:67]
    ds_read_b128 v[108:111], v149 offset:4096
    v_mfma_f32_16x16x32_bf16 a[68:71], v[12:15], v[40:43], a[68:71]
    v_mfma_f32_16x16x32_bf16 a[72:75], v[12:15], v[44:47], a[72:75]
    ds_read_b64_tr_b16 v[80:81], v155 offset:16384
    v_mfma_f32_16x16x32_bf16 a[76:79], v[12:15], v[48:51], a[76:79]
    v_mfma_f32_16x16x32_bf16 a[80:83], v[12:15], v[52:55], a[80:83]
    ds_read_b64_tr_b16 v[82:83], v155 offset:18432
    v_mfma_f32_16x16x32_bf16 a[84:87], v[12:15], v[56:59], a[84:87]
    v_mfma_f32_16x16x32_bf16 a[88:91], v[12:15], v[60:63], a[88:91]
    ds_read_b128 v[112:115], v149 offset:6144
    v_mfma_f32_16x16x32_bf16 a[92:95], v[12:15], v[64:67], a[92:95]
    v_mfma_f32_16x16x32_bf16 a[96:99], v[16:19], v[36:39], a[96:99]
    ds_read_b64_tr_b16 v[84:85], v156 offset:16384
    v_mfma_f32_16x16x32_bf16 a[100:103], v[16:19], v[40:43], a[100:103]
    v_mfma_f32_16x16x32_bf16 a[104:107], v[16:19], v[44:47], a[104:107]
    ds_read_b64_tr_b16 v[86:87], v156 offset:18432
    v_mfma_f32_16x16x32_bf16 a[108:111], v[16:19], v[48:51], a[108:111]
    v_mfma_f32_16x16x32_bf16 a[112:115], v[16:19], v[52:55], a[112:115]
    ds_read_b128 v[116:119], v149 offset:8192
    v_mfma_f32_16x16x32_bf16 a[116:119], v[16:19], v[56:59], a[116:119]
    v_mfma_f32_16x16x32_bf16 a[120:123], v[16:19], v[60:63], a[120:123]
    ds_read_b64_tr_b16 v[88:89], v157 offset:16384
    v_mfma_f32_16x16x32_bf16 a[124:127], v[16:19], v[64:67], a[124:127]
    v_mfma_f32_16x16x32_bf16 a[128:131], v[20:23], v[36:39], a[128:131]
    ds_read_b64_tr_b16 v[90:91], v157 offset:18432
    v_mfma_f32_16x16x32_bf16 a[132:135], v[20:23], v[40:43], a[132:135]
    v_mfma_f32_16x16x32_bf16 a[136:139], v[20:23], v[44:47], a[136:139]
    ds_read_b128 v[120:123], v149 offset:10240
    v_mfma_f32_16x16x32_bf16 a[140:143], v[20:23], v[48:51], a[140:143]
    v_mfma_f32_16x16x32_bf16 a[144:147], v[20:23], v[52:55], a[144:147]
    ds_read_b64_tr_b16 v[92:93], v158 offset:16384
    v_mfma_f32_16x16x32_bf16 a[148:151], v[20:23], v[56:59], a[148:151]
    v_mfma_f32_16x16x32_bf16 a[152:155], v[20:23], v[60:63], a[152:155]
    ds_read_b64_tr_b16 v[94:95], v158 offset:18432
    v_mfma_f32_16x16x32_bf16 a[156:159], v[20:23], v[64:67], a[156:159]
    v_mfma_f32_16x16x32_bf16 a[160:163], v[24:27], v[36:39], a[160:163]
    ds_read_b128 v[124:127], v149 offset:12288
    v_mfma_f32_16x16x32_bf16 a[164:167], v[24:27], v[40:43], a[164:167]
    v_mfma_f32_16x16x32_bf16 a[168:171], v[24:27], v[44:47], a[168:171]
    ds_read_b64_tr_b16 v[96:97], v159 offset:16384
    v_mfma_f32_16x16x32_bf16 a[172:175], v[24:27], v[48:51], a[172:175]
    v_mfma_f32_16x16x32_bf16 a[176:179], v[24:27], v[52:55], a[176:179]
    ds_read_b64_tr_b16 v[98:99], v159 offset:18432
    v_mfma_f32_16x16x32_bf16 a[180:183], v[24:27], v[56:59], a[180:183]
    v_mfma_f32_16x16x32_bf16 a[184:187], v[24:27], v[60:63], a[184:187]
    ds_read_b128 v[128:131], v149 offset:14336
    v_mfma_f32_16x16x32_bf16 a[188:191], v[24:27], v[64:67], a[188:191]
    v_mfma_f32_16x16x32_bf16 a[192:195], v[28:31], v[36:39], a[192:195]
    v_mfma_f32_16x16x32_bf16 a[196:199], v[28:31], v[40:43], a[196:199]
    v_mfma_f32_16x16x32_bf16 a[200:203], v[28:31], v[44:47], a[200:203]
    v_mfma_f32_16x16x32_bf16 a[204:207], v[28:31], v[48:51], a[204:207]
    v_mfma_f32_16x16x32_bf16 a[208:211], v[28:31], v[52:55], a[208:211]
    v_mfma_f32_16x16x32_bf16 a[212:215], v[28:31], v[56:59], a[212:215]
    v_mfma_f32_16x16x32_bf16 a[216:219], v[28:31], v[60:63], a[216:219]
    v_mfma_f32_16x16x32_bf16 a[220:223], v[28:31], v[64:67], a[220:223]
    v_mfma_f32_16x16x32_bf16 a[224:227], v[32:35], v[36:39], a[224:227]
    v_mfma_f32_16x16x32_bf16 a[228:231], v[32:35], v[40:43], a[228:231]
    v_mfma_f32_16x16x32_bf16 a[232:235], v[32:35], v[44:47], a[232:235]
    v_mfma_f32_16x16x32_bf16 a[236:239], v[32:35], v[48:51], a[236:239]
    v_mfma_f32_16x16x32_bf16 a[240:243], v[32:35], v[52:55], a[240:243]
    v_mfma_f32_16x16x32_bf16 a[244:247], v[32:35], v[56:59], a[244:247]
    v_mfma_f32_16x16x32_bf16 a[248:251], v[32:35], v[60:63], a[248:251]
    v_mfma_f32_16x16x32_bf16 a[252:255], v[32:35], v[64:67], a[252:255]
    s_waitcnt vmcnt(0) lgkmcnt(0)
    s_barrier
    v_mfma_f32_16x16x32_bf16 a[0:3], v[68:71], v[100:103], a[0:3]
    ds_read_b64_tr_b16 v[4:5], v160
    v_mfma_f32_16x16x32_bf16 a[4:7], v[68:71], v[104:107], a[4:7]
    v_mfma_f32_16x16x32_bf16 a[8:11], v[68:71], v[108:111], a[8:11]
    ds_read_b64_tr_b16 v[6:7], v160 offset:2048
    v_mfma_f32_16x16x32_bf16 a[12:15], v[68:71], v[112:115], a[12:15]
    v_mfma_f32_16x16x32_bf16 a[16:19], v[68:71], v[116:119], a[16:19]
    ds_read_b128 v[36:39], v150
    v_mfma_f32_16x16x32_bf16 a[20:23], v[68:71], v[120:123], a[20:23]
    v_mfma_f32_16x16x32_bf16 a[24:27], v[68:71], v[124:127], a[24:27]
    ds_read_b64_tr_b16 v[8:9], v161
    v_mfma_f32_16x16x32_bf16 a[28:31], v[68:71], v[128:131], a[28:31]
    v_mfma_f32_16x16x32_bf16 a[32:35], v[72:75], v[100:103], a[32:35]
    ds_read_b64_tr_b16 v[10:11], v161 offset:2048
    v_mfma_f32_16x16x32_bf16 a[36:39], v[72:75], v[104:107], a[36:39]
    v_mfma_f32_16x16x32_bf16 a[40:43], v[72:75], v[108:111], a[40:43]
    ds_read_b128 v[40:43], v150 offset:2048
    v_mfma_f32_16x16x32_bf16 a[44:47], v[72:75], v[112:115], a[44:47]
    v_mfma_f32_16x16x32_bf16 a[48:51], v[72:75], v[116:119], a[48:51]
    ds_read_b64_tr_b16 v[12:13], v162
    v_mfma_f32_16x16x32_bf16 a[52:55], v[72:75], v[120:123], a[52:55]
    v_mfma_f32_16x16x32_bf16 a[56:59], v[72:75], v[124:127], a[56:59]
    ds_read_b64_tr_b16 v[14:15], v162 offset:2048
    v_mfma_f32_16x16x32_bf16 a[60:63], v[72:75], v[128:131], a[60:63]
    v_mfma_f32_16x16x32_bf16 a[64:67], v[76:79], v[100:103], a[64:67]
    ds_read_b128 v[44:47], v150 offset:4096
    v_mfma_f32_16x16x32_bf16 a[68:71], v[76:79], v[104:107], a[68:71]
    v_mfma_f32_16x16x32_bf16 a[72:75], v[76:79], v[108:111], a[72:75]
    ds_read_b64_tr_b16 v[16:17], v163
    v_mfma_f32_16x16x32_bf16 a[76:79], v[76:79], v[112:115], a[76:79]
    v_mfma_f32_16x16x32_bf16 a[80:83], v[76:79], v[116:119], a[80:83]
    ds_read_b64_tr_b16 v[18:19], v163 offset:2048
    v_mfma_f32_16x16x32_bf16 a[84:87], v[76:79], v[120:123], a[84:87]
    v_mfma_f32_16x16x32_bf16 a[88:91], v[76:79], v[124:127], a[88:91]
    ds_read_b128 v[48:51], v150 offset:6144
    v_mfma_f32_16x16x32_bf16 a[92:95], v[76:79], v[128:131], a[92:95]
    v_mfma_f32_16x16x32_bf16 a[96:99], v[80:83], v[100:103], a[96:99]
    ds_read_b64_tr_b16 v[20:21], v164
    v_mfma_f32_16x16x32_bf16 a[100:103], v[80:83], v[104:107], a[100:103]
    v_mfma_f32_16x16x32_bf16 a[104:107], v[80:83], v[108:111], a[104:107]
    ds_read_b64_tr_b16 v[22:23], v164 offset:2048
    v_mfma_f32_16x16x32_bf16 a[108:111], v[80:83], v[112:115], a[108:111]
    v_mfma_f32_16x16x32_bf16 a[112:115], v[80:83], v[116:119], a[112:115]
    ds_read_b128 v[52:55], v150 offset:8192
    v_mfma_f32_16x16x32_bf16 a[116:119], v[80:83], v[120:123], a[116:119]
    v_mfma_f32_16x16x32_bf16 a[120:123], v[80:83], v[124:127], a[120:123]
    ds_read_b64_tr_b16 v[24:25], v165
    v_mfma_f32_16x16x32_bf16 a[124:127], v[80:83], v[128:131], a[124:127]
    v_mfma_f32_16x16x32_bf16 a[128:131], v[84:87], v[100:103], a[128:131]
    ds_read_b64_tr_b16 v[26:27], v165 offset:2048
    v_mfma_f32_16x16x32_bf16 a[132:135], v[84:87], v[104:107], a[132:135]
    v_mfma_f32_16x16x32_bf16 a[136:139], v[84:87], v[108:111], a[136:139]
    ds_read_b128 v[56:59], v150 offset:10240
    v_mfma_f32_16x16x32_bf16 a[140:143], v[84:87], v[112:115], a[140:143]
    v_mfma_f32_16x16x32_bf16 a[144:147], v[84:87], v[116:119], a[144:147]
    ds_read_b64_tr_b16 v[28:29], v166
    v_mfma_f32_16x16x32_bf16 a[148:151], v[84:87], v[120:123], a[148:151]
    v_mfma_f32_16x16x32_bf16 a[152:155], v[84:87], v[124:127], a[152:155]
    ds_read_b64_tr_b16 v[30:31], v166 offset:2048
    v_mfma_f32_16x16x32_bf16 a[156:159], v[84:87], v[128:131], a[156:159]
    v_mfma_f32_16x16x32_bf16 a[160:163], v[88:91], v[100:103], a[160:163]
    ds_read_b128 v[60:63], v150 offset:12288
    v_mfma_f32_16x16x32_bf16 a[164:167], v[88:91], v[104:107], a[164:167]
    v_mfma_f32_16x16x32_bf16 a[168:171], v[88:91], v[108:111], a[168:171]
    ds_read_b64_tr_b16 v[32:33], v167
    v_mfma_f32_16x16x32_bf16 a[172:175], v[88:91], v[112:115], a[172:175]
    v_mfma_f32_16x16x32_bf16 a[176:179], v[88:91], v[116:119], a[176:179]
    ds_read_b64_tr_b16 v[34:35], v167 offset:2048
    v_mfma_f32_16x16x32_bf16 a[180:183], v[88:91], v[120:123], a[180:183]
    v_mfma_f32_16x16x32_bf16 a[184:187], v[88:91], v[124:127], a[184:187]
    ds_read_b128 v[64:67], v150 offset:14336
    v_mfma_f32_16x16x32_bf16 a[188:191], v[88:91], v[128:131], a[188:191]
    v_mfma_f32_16x16x32_bf16 a[192:195], v[92:95], v[100:103], a[192:195]
    v_mfma_f32_16x16x32_bf16 a[196:199], v[92:95], v[104:107], a[196:199]
    v_mfma_f32_16x16x32_bf16 a[200:203], v[92:95], v[108:111], a[200:203]
    v_mfma_f32_16x16x32_bf16 a[204:207], v[92:95], v[112:115], a[204:207]
    v_mfma_f32_16x16x32_bf16 a[208:211], v[92:95], v[116:119], a[208:211]
    v_mfma_f32_16x16x32_bf16 a[212:215], v[92:95], v[120:123], a[212:215]
    v_mfma_f32_16x16x32_bf16 a[216:219], v[92:95], v[124:127], a[216:219]
    v_mfma_f32_16x16x32_bf16 a[220:223], v[92:95], v[128:131], a[220:223]
    v_mfma_f32_16x16x32_bf16 a[224:227], v[96:99], v[100:103], a[224:227]
    v_mfma_f32_16x16x32_bf16 a[228:231], v[96:99], v[104:107], a[228:231]
    v_mfma_f32_16x16x32_bf16 a[232:235], v[96:99], v[108:111], a[232:235]
    v_mfma_f32_16x16x32_bf16 a[236:239], v[96:99], v[112:115], a[236:239]
    v_mfma_f32_16x16x32_bf16 a[240:243], v[96:99], v[116:119], a[240:243]
    v_mfma_f32_16x16x32_bf16 a[244:247], v[96:99], v[120:123], a[244:247]
    v_mfma_f32_16x16x32_bf16 a[248:251], v[96:99], v[124:127], a[248:251]
    v_mfma_f32_16x16x32_bf16 a[252:255], v[96:99], v[128:131], a[252:255]
    v_mfma_f32_16x16x32_bf16 a[0:3], v[4:7], v[36:39], a[0:3]
    ds_read_b64_tr_b16 v[68:69], v160 offset:16384
    v_mfma_f32_16x16x32_bf16 a[4:7], v[4:7], v[40:43], a[4:7]
    v_mfma_f32_16x16x32_bf16 a[8:11], v[4:7], v[44:47], a[8:11]
    ds_read_b64_tr_b16 v[70:71], v160 offset:18432
    s_waitcnt lgkmcnt(14)
    v_mfma_f32_16x16x32_bf16 a[12:15], v[4:7], v[48:51], a[12:15]
    s_waitcnt lgkmcnt(11)
    v_mfma_f32_16x16x32_bf16 a[16:19], v[4:7], v[52:55], a[16:19]
    ds_read_b128 v[100:103], v151
    s_waitcnt lgkmcnt(9)
    v_mfma_f32_16x16x32_bf16 a[20:23], v[4:7], v[56:59], a[20:23]
    s_waitcnt lgkmcnt(6)
    v_mfma_f32_16x16x32_bf16 a[24:27], v[4:7], v[60:63], a[24:27]
    ds_read_b64_tr_b16 v[72:73], v161 offset:16384
    s_waitcnt lgkmcnt(4)
    v_mfma_f32_16x16x32_bf16 a[28:31], v[4:7], v[64:67], a[28:31]
    v_mfma_f32_16x16x32_bf16 a[32:35], v[8:11], v[36:39], a[32:35]
    ds_read_b64_tr_b16 v[74:75], v161 offset:18432
    v_mfma_f32_16x16x32_bf16 a[36:39], v[8:11], v[40:43], a[36:39]
    v_mfma_f32_16x16x32_bf16 a[40:43], v[8:11], v[44:47], a[40:43]
    ds_read_b128 v[104:107], v151 offset:2048
    v_mfma_f32_16x16x32_bf16 a[44:47], v[8:11], v[48:51], a[44:47]
    v_mfma_f32_16x16x32_bf16 a[48:51], v[8:11], v[52:55], a[48:51]
    ds_read_b64_tr_b16 v[76:77], v162 offset:16384
    v_mfma_f32_16x16x32_bf16 a[52:55], v[8:11], v[56:59], a[52:55]
    v_mfma_f32_16x16x32_bf16 a[56:59], v[8:11], v[60:63], a[56:59]
    ds_read_b64_tr_b16 v[78:79], v162 offset:18432
    v_mfma_f32_16x16x32_bf16 a[60:63], v[8:11], v[64:67], a[60:63]
    v_mfma_f32_16x16x32_bf16 a[64:67], v[12:15], v[36:39], a[64:67]
    ds_read_b128 v[108:111], v151 offset:4096
    v_mfma_f32_16x16x32_bf16 a[68:71], v[12:15], v[40:43], a[68:71]
    v_mfma_f32_16x16x32_bf16 a[72:75], v[12:15], v[44:47], a[72:75]
    ds_read_b64_tr_b16 v[80:81], v163 offset:16384
    v_mfma_f32_16x16x32_bf16 a[76:79], v[12:15], v[48:51], a[76:79]
    v_mfma_f32_16x16x32_bf16 a[80:83], v[12:15], v[52:55], a[80:83]
    ds_read_b64_tr_b16 v[82:83], v163 offset:18432
    v_mfma_f32_16x16x32_bf16 a[84:87], v[12:15], v[56:59], a[84:87]
    v_mfma_f32_16x16x32_bf16 a[88:91], v[12:15], v[60:63], a[88:91]
    ds_read_b128 v[112:115], v151 offset:6144
    v_mfma_f32_16x16x32_bf16 a[92:95], v[12:15], v[64:67], a[92:95]
    v_mfma_f32_16x16x32_bf16 a[96:99], v[16:19], v[36:39], a[96:99]
    ds_read_b64_tr_b16 v[84:85], v164 offset:16384
    v_mfma_f32_16x16x32_bf16 a[100:103], v[16:19], v[40:43], a[100:103]
    v_mfma_f32_16x16x32_bf16 a[104:107], v[16:19], v[44:47], a[104:107]
    ds_read_b64_tr_b16 v[86:87], v164 offset:18432
    v_mfma_f32_16x16x32_bf16 a[108:111], v[16:19], v[48:51], a[108:111]
    v_mfma_f32_16x16x32_bf16 a[112:115], v[16:19], v[52:55], a[112:115]
    ds_read_b128 v[116:119], v151 offset:8192
    v_mfma_f32_16x16x32_bf16 a[116:119], v[16:19], v[56:59], a[116:119]
    v_mfma_f32_16x16x32_bf16 a[120:123], v[16:19], v[60:63], a[120:123]
    ds_read_b64_tr_b16 v[88:89], v165 offset:16384
    v_mfma_f32_16x16x32_bf16 a[124:127], v[16:19], v[64:67], a[124:127]
    v_mfma_f32_16x16x32_bf16 a[128:131], v[20:23], v[36:39], a[128:131]
    ds_read_b64_tr_b16 v[90:91], v165 offset:18432
    v_mfma_f32_16x16x32_bf16 a[132:135], v[20:23], v[40:43], a[132:135]
    v_mfma_f32_16x16x32_bf16 a[136:139], v[20:23], v[44:47], a[136:139]
    ds_read_b128 v[120:123], v151 offset:10240
    v_mfma_f32_16x16x32_bf16 a[140:143], v[20:23], v[48:51], a[140:143]
    v_mfma_f32_16x16x32_bf16 a[144:147], v[20:23], v[52:55], a[144:147]
    ds_read_b64_tr_b16 v[92:93], v166 offset:16384
    v_mfma_f32_16x16x32_bf16 a[148:151], v[20:23], v[56:59], a[148:151]
    v_mfma_f32_16x16x32_bf16 a[152:155], v[20:23], v[60:63], a[152:155]
    ds_read_b64_tr_b16 v[94:95], v166 offset:18432
    v_mfma_f32_16x16x32_bf16 a[156:159], v[20:23], v[64:67], a[156:159]
    v_mfma_f32_16x16x32_bf16 a[160:163], v[24:27], v[36:39], a[160:163]
    ds_read_b128 v[124:127], v151 offset:12288
    v_mfma_f32_16x16x32_bf16 a[164:167], v[24:27], v[40:43], a[164:167]
    v_mfma_f32_16x16x32_bf16 a[168:171], v[24:27], v[44:47], a[168:171]
    ds_read_b64_tr_b16 v[96:97], v167 offset:16384
    v_mfma_f32_16x16x32_bf16 a[172:175], v[24:27], v[48:51], a[172:175]
    v_mfma_f32_16x16x32_bf16 a[176:179], v[24:27], v[52:55], a[176:179]
    ds_read_b64_tr_b16 v[98:99], v167 offset:18432
    v_mfma_f32_16x16x32_bf16 a[180:183], v[24:27], v[56:59], a[180:183]
    v_mfma_f32_16x16x32_bf16 a[184:187], v[24:27], v[60:63], a[184:187]
    ds_read_b128 v[128:131], v151 offset:14336
    v_mfma_f32_16x16x32_bf16 a[188:191], v[24:27], v[64:67], a[188:191]
    v_mfma_f32_16x16x32_bf16 a[192:195], v[28:31], v[36:39], a[192:195]
    v_mfma_f32_16x16x32_bf16 a[196:199], v[28:31], v[40:43], a[196:199]
    v_mfma_f32_16x16x32_bf16 a[200:203], v[28:31], v[44:47], a[200:203]
    v_mfma_f32_16x16x32_bf16 a[204:207], v[28:31], v[48:51], a[204:207]
    v_mfma_f32_16x16x32_bf16 a[208:211], v[28:31], v[52:55], a[208:211]
    v_mfma_f32_16x16x32_bf16 a[212:215], v[28:31], v[56:59], a[212:215]
    v_mfma_f32_16x16x32_bf16 a[216:219], v[28:31], v[60:63], a[216:219]
    v_mfma_f32_16x16x32_bf16 a[220:223], v[28:31], v[64:67], a[220:223]
    v_mfma_f32_16x16x32_bf16 a[224:227], v[32:35], v[36:39], a[224:227]
    v_mfma_f32_16x16x32_bf16 a[228:231], v[32:35], v[40:43], a[228:231]
    v_mfma_f32_16x16x32_bf16 a[232:235], v[32:35], v[44:47], a[232:235]
    v_mfma_f32_16x16x32_bf16 a[236:239], v[32:35], v[48:51], a[236:239]
    v_mfma_f32_16x16x32_bf16 a[240:243], v[32:35], v[52:55], a[240:243]
    v_mfma_f32_16x16x32_bf16 a[244:247], v[32:35], v[56:59], a[244:247]
    v_mfma_f32_16x16x32_bf16 a[248:251], v[32:35], v[60:63], a[248:251]
    v_mfma_f32_16x16x32_bf16 a[252:255], v[32:35], v[64:67], a[252:255]
    v_mfma_f32_16x16x32_bf16 a[0:3], v[68:71], v[100:103], a[0:3]
    v_mfma_f32_16x16x32_bf16 a[4:7], v[68:71], v[104:107], a[4:7]
    v_mfma_f32_16x16x32_bf16 a[8:11], v[68:71], v[108:111], a[8:11]
    s_waitcnt lgkmcnt(12)
    v_mfma_f32_16x16x32_bf16 a[12:15], v[68:71], v[112:115], a[12:15]
    s_waitcnt lgkmcnt(9)
    v_mfma_f32_16x16x32_bf16 a[16:19], v[68:71], v[116:119], a[16:19]
    s_waitcnt lgkmcnt(6)
    v_mfma_f32_16x16x32_bf16 a[20:23], v[68:71], v[120:123], a[20:23]
    s_waitcnt lgkmcnt(3)
    v_mfma_f32_16x16x32_bf16 a[24:27], v[68:71], v[124:127], a[24:27]
    s_waitcnt lgkmcnt(0)
    v_mfma_f32_16x16x32_bf16 a[28:31], v[68:71], v[128:131], a[28:31]
    v_mfma_f32_16x16x32_bf16 a[32:35], v[72:75], v[100:103], a[32:35]
    v_mfma_f32_16x16x32_bf16 a[36:39], v[72:75], v[104:107], a[36:39]
    v_mfma_f32_16x16x32_bf16 a[40:43], v[72:75], v[108:111], a[40:43]
    v_mfma_f32_16x16x32_bf16 a[44:47], v[72:75], v[112:115], a[44:47]
    v_mfma_f32_16x16x32_bf16 a[48:51], v[72:75], v[116:119], a[48:51]
    v_mfma_f32_16x16x32_bf16 a[52:55], v[72:75], v[120:123], a[52:55]
    v_mfma_f32_16x16x32_bf16 a[56:59], v[72:75], v[124:127], a[56:59]
    v_mfma_f32_16x16x32_bf16 a[60:63], v[72:75], v[128:131], a[60:63]
    v_mfma_f32_16x16x32_bf16 a[64:67], v[76:79], v[100:103], a[64:67]
    v_mfma_f32_16x16x32_bf16 a[68:71], v[76:79], v[104:107], a[68:71]
    v_mfma_f32_16x16x32_bf16 a[72:75], v[76:79], v[108:111], a[72:75]
    v_mfma_f32_16x16x32_bf16 a[76:79], v[76:79], v[112:115], a[76:79]
    v_mfma_f32_16x16x32_bf16 a[80:83], v[76:79], v[116:119], a[80:83]
    v_mfma_f32_16x16x32_bf16 a[84:87], v[76:79], v[120:123], a[84:87]
    v_mfma_f32_16x16x32_bf16 a[88:91], v[76:79], v[124:127], a[88:91]
    v_mfma_f32_16x16x32_bf16 a[92:95], v[76:79], v[128:131], a[92:95]
    v_mfma_f32_16x16x32_bf16 a[96:99], v[80:83], v[100:103], a[96:99]
    v_mfma_f32_16x16x32_bf16 a[100:103], v[80:83], v[104:107], a[100:103]
    v_mfma_f32_16x16x32_bf16 a[104:107], v[80:83], v[108:111], a[104:107]
    v_mfma_f32_16x16x32_bf16 a[108:111], v[80:83], v[112:115], a[108:111]
    v_mfma_f32_16x16x32_bf16 a[112:115], v[80:83], v[116:119], a[112:115]
    v_mfma_f32_16x16x32_bf16 a[116:119], v[80:83], v[120:123], a[116:119]
    v_mfma_f32_16x16x32_bf16 a[120:123], v[80:83], v[124:127], a[120:123]
    v_mfma_f32_16x16x32_bf16 a[124:127], v[80:83], v[128:131], a[124:127]
    v_mfma_f32_16x16x32_bf16 a[128:131], v[84:87], v[100:103], a[128:131]
    v_mfma_f32_16x16x32_bf16 a[132:135], v[84:87], v[104:107], a[132:135]
    v_mfma_f32_16x16x32_bf16 a[136:139], v[84:87], v[108:111], a[136:139]
    v_mfma_f32_16x16x32_bf16 a[140:143], v[84:87], v[112:115], a[140:143]
    v_mfma_f32_16x16x32_bf16 a[144:147], v[84:87], v[116:119], a[144:147]
    v_mfma_f32_16x16x32_bf16 a[148:151], v[84:87], v[120:123], a[148:151]
    v_mfma_f32_16x16x32_bf16 a[152:155], v[84:87], v[124:127], a[152:155]
    v_mfma_f32_16x16x32_bf16 a[156:159], v[84:87], v[128:131], a[156:159]
    v_mfma_f32_16x16x32_bf16 a[160:163], v[88:91], v[100:103], a[160:163]
    v_mfma_f32_16x16x32_bf16 a[164:167], v[88:91], v[104:107], a[164:167]
    v_mfma_f32_16x16x32_bf16 a[168:171], v[88:91], v[108:111], a[168:171]
    v_mfma_f32_16x16x32_bf16 a[172:175], v[88:91], v[112:115], a[172:175]
    v_mfma_f32_16x16x32_bf16 a[176:179], v[88:91], v[116:119], a[176:179]
    v_mfma_f32_16x16x32_bf16 a[180:183], v[88:91], v[120:123], a[180:183]
    v_mfma_f32_16x16x32_bf16 a[184:187], v[88:91], v[124:127], a[184:187]
    v_mfma_f32_16x16x32_bf16 a[188:191], v[88:91], v[128:131], a[188:191]
    v_mfma_f32_16x16x32_bf16 a[192:195], v[92:95], v[100:103], a[192:195]
    v_mfma_f32_16x16x32_bf16 a[196:199], v[92:95], v[104:107], a[196:199]
    v_mfma_f32_16x16x32_bf16 a[200:203], v[92:95], v[108:111], a[200:203]
    v_mfma_f32_16x16x32_bf16 a[204:207], v[92:95], v[112:115], a[204:207]
    v_mfma_f32_16x16x32_bf16 a[208:211], v[92:95], v[116:119], a[208:211]
    v_mfma_f32_16x16x32_bf16 a[212:215], v[92:95], v[120:123], a[212:215]
    v_mfma_f32_16x16x32_bf16 a[216:219], v[92:95], v[124:127], a[216:219]
    v_mfma_f32_16x16x32_bf16 a[220:223], v[92:95], v[128:131], a[220:223]
    v_mfma_f32_16x16x32_bf16 a[224:227], v[96:99], v[100:103], a[224:227]
    v_mfma_f32_16x16x32_bf16 a[228:231], v[96:99], v[104:107], a[228:231]
    v_mfma_f32_16x16x32_bf16 a[232:235], v[96:99], v[108:111], a[232:235]
    v_mfma_f32_16x16x32_bf16 a[236:239], v[96:99], v[112:115], a[236:239]
    v_mfma_f32_16x16x32_bf16 a[240:243], v[96:99], v[116:119], a[240:243]
    v_mfma_f32_16x16x32_bf16 a[244:247], v[96:99], v[120:123], a[244:247]
    v_mfma_f32_16x16x32_bf16 a[248:251], v[96:99], v[124:127], a[248:251]
    v_mfma_f32_16x16x32_bf16 a[252:255], v[96:99], v[128:131], a[252:255]
    v_and_b32 v172, 15, v0
    v_lshrrev_b32 v169, 6, v0
    v_lshrrev_b32 v170, 1, v169
    v_and_b32 v171, 1, v169
    v_mul_u32_u24 v174, 128, v170
    v_add_u32 v174, v174, v172
    v_mul_u32_u24 v175, 256, v171
    v_mad_u32_u24 v168, v174, s22, v175
    v_bfe_u32 v173, v0, 4, 2
    v_and_b32 v174, 1, v173
    v_lshlrev_b32 v174, 5, v174
    v_lshrrev_b32 v175, 1, v173
    v_lshl_or_b32 v174, v175, 4, v174
    v_add_u32 v168, v168, v174
    s_cmp_eq_u32 s23, 0
    s_cbranch_scc1 gemm1_kernel_epi_plain
    s_mov_b32 s27, 0
    v_accvgpr_read_b32 v4, a0
    v_accvgpr_read_b32 v5, a1
    v_accvgpr_read_b32 v6, a2
    v_accvgpr_read_b32 v7, a3
    v_accvgpr_read_b32 v8, a32
    v_accvgpr_read_b32 v9, a33
    v_accvgpr_read_b32 v10, a34
    v_accvgpr_read_b32 v11, a35
    v_cvt_pk_bf16_f32 v12, v4, v5
    v_cvt_pk_bf16_f32 v13, v6, v7
    v_cvt_pk_bf16_f32 v14, v8, v9
    v_cvt_pk_bf16_f32 v15, v10, v11
    s_nop 0
    v_permlane16_swap_b32 v12, v14
    v_permlane16_swap_b32 v13, v15
    v_pk_max_i16 v12, v12, 0
    v_pk_max_i16 v13, v13, 0
    v_pk_max_i16 v14, v14, 0
    v_pk_max_i16 v15, v15, 0
    buffer_store_dwordx4 v[12:15], v168, s[12:15], s27 offen
    v_accvgpr_read_b32 v16, a64
    v_accvgpr_read_b32 v17, a65
    v_accvgpr_read_b32 v18, a66
    v_accvgpr_read_b32 v19, a67
    v_accvgpr_read_b32 v20, a96
    v_accvgpr_read_b32 v21, a97
    v_accvgpr_read_b32 v22, a98
    v_accvgpr_read_b32 v23, a99
    v_cvt_pk_bf16_f32 v24, v16, v17
    v_cvt_pk_bf16_f32 v25, v18, v19
    v_cvt_pk_bf16_f32 v26, v20, v21
    v_cvt_pk_bf16_f32 v27, v22, v23
    s_nop 0
    v_permlane16_swap_b32 v24, v26
    v_permlane16_swap_b32 v25, v27
    v_pk_max_i16 v24, v24, 0
    v_pk_max_i16 v25, v25, 0
    v_pk_max_i16 v26, v26, 0
    v_pk_max_i16 v27, v27, 0
    buffer_store_dwordx4 v[24:27], v168, s[12:15], s27 offen offset:64
    v_accvgpr_read_b32 v28, a128
    v_accvgpr_read_b32 v29, a129
    v_accvgpr_read_b32 v30, a130
    v_accvgpr_read_b32 v31, a131
    v_accvgpr_read_b32 v32, a160
    v_accvgpr_read_b32 v33, a161
    v_accvgpr_read_b32 v34, a162
    v_accvgpr_read_b32 v35, a163
    v_cvt_pk_bf16_f32 v36, v28, v29
    v_cvt_pk_bf16_f32 v37, v30, v31
    v_cvt_pk_bf16_f32 v38, v32, v33
    v_cvt_pk_bf16_f32 v39, v34, v35
    s_nop 0
    v_permlane16_swap_b32 v36, v38
    v_permlane16_swap_b32 v37, v39
    v_pk_max_i16 v36, v36, 0
    v_pk_max_i16 v37, v37, 0
    v_pk_max_i16 v38, v38, 0
    v_pk_max_i16 v39, v39, 0
    buffer_store_dwordx4 v[36:39], v168, s[12:15], s27 offen offset:128
    v_accvgpr_read_b32 v40, a192
    v_accvgpr_read_b32 v41, a193
    v_accvgpr_read_b32 v42, a194
    v_accvgpr_read_b32 v43, a195
    v_accvgpr_read_b32 v44, a224
    v_accvgpr_read_b32 v45, a225
    v_accvgpr_read_b32 v46, a226
    v_accvgpr_read_b32 v47, a227
    v_cvt_pk_bf16_f32 v48, v40, v41
    v_cvt_pk_bf16_f32 v49, v42, v43
    v_cvt_pk_bf16_f32 v50, v44, v45
    v_cvt_pk_bf16_f32 v51, v46, v47
    s_nop 0
    v_permlane16_swap_b32 v48, v50
    v_permlane16_swap_b32 v49, v51
    v_pk_max_i16 v48, v48, 0
    v_pk_max_i16 v49, v49, 0
    v_pk_max_i16 v50, v50, 0
    v_pk_max_i16 v51, v51, 0
    buffer_store_dwordx4 v[48:51], v168, s[12:15], s27 offen offset:192
    s_lshl_b32 s28, s22, 4
    s_add_u32 s27, s27, s28
    v_accvgpr_read_b32 v4, a4
    v_accvgpr_read_b32 v5, a5
    v_accvgpr_read_b32 v6, a6
    v_accvgpr_read_b32 v7, a7
    v_accvgpr_read_b32 v8, a36
    v_accvgpr_read_b32 v9, a37
    v_accvgpr_read_b32 v10, a38
    v_accvgpr_read_b32 v11, a39
    v_cvt_pk_bf16_f32 v12, v4, v5
    v_cvt_pk_bf16_f32 v13, v6, v7
    v_cvt_pk_bf16_f32 v14, v8, v9
    v_cvt_pk_bf16_f32 v15, v10, v11
    s_nop 0
    v_permlane16_swap_b32 v12, v14
    v_permlane16_swap_b32 v13, v15
    v_pk_max_i16 v12, v12, 0
    v_pk_max_i16 v13, v13, 0
    v_pk_max_i16 v14, v14, 0
    v_pk_max_i16 v15, v15, 0
    buffer_store_dwordx4 v[12:15], v168, s[12:15], s27 offen
    v_accvgpr_read_b32 v16, a68
    v_accvgpr_read_b32 v17, a69
    v_accvgpr_read_b32 v18, a70
    v_accvgpr_read_b32 v19, a71
    v_accvgpr_read_b32 v20, a100
    v_accvgpr_read_b32 v21, a101
    v_accvgpr_read_b32 v22, a102
    v_accvgpr_read_b32 v23, a103
    v_cvt_pk_bf16_f32 v24, v16, v17
    v_cvt_pk_bf16_f32 v25, v18, v19
    v_cvt_pk_bf16_f32 v26, v20, v21
    v_cvt_pk_bf16_f32 v27, v22, v23
    s_nop 0
    v_permlane16_swap_b32 v24, v26
    v_permlane16_swap_b32 v25, v27
    v_pk_max_i16 v24, v24, 0
    v_pk_max_i16 v25, v25, 0
    v_pk_max_i16 v26, v26, 0
    v_pk_max_i16 v27, v27, 0
    buffer_store_dwordx4 v[24:27], v168, s[12:15], s27 offen offset:64
    v_accvgpr_read_b32 v28, a132
    v_accvgpr_read_b32 v29, a133
    v_accvgpr_read_b32 v30, a134
    v_accvgpr_read_b32 v31, a135
    v_accvgpr_read_b32 v32, a164
    v_accvgpr_read_b32 v33, a165
    v_accvgpr_read_b32 v34, a166
    v_accvgpr_read_b32 v35, a167
    v_cvt_pk_bf16_f32 v36, v28, v29
    v_cvt_pk_bf16_f32 v37, v30, v31
    v_cvt_pk_bf16_f32 v38, v32, v33
    v_cvt_pk_bf16_f32 v39, v34, v35
    s_nop 0
    v_permlane16_swap_b32 v36, v38
    v_permlane16_swap_b32 v37, v39
    v_pk_max_i16 v36, v36, 0
    v_pk_max_i16 v37, v37, 0
    v_pk_max_i16 v38, v38, 0
    v_pk_max_i16 v39, v39, 0
    buffer_store_dwordx4 v[36:39], v168, s[12:15], s27 offen offset:128
    v_accvgpr_read_b32 v40, a196
    v_accvgpr_read_b32 v41, a197
    v_accvgpr_read_b32 v42, a198
    v_accvgpr_read_b32 v43, a199
    v_accvgpr_read_b32 v44, a228
    v_accvgpr_read_b32 v45, a229
    v_accvgpr_read_b32 v46, a230
    v_accvgpr_read_b32 v47, a231
    v_cvt_pk_bf16_f32 v48, v40, v41
    v_cvt_pk_bf16_f32 v49, v42, v43
    v_cvt_pk_bf16_f32 v50, v44, v45
    v_cvt_pk_bf16_f32 v51, v46, v47
    s_nop 0
    v_permlane16_swap_b32 v48, v50
    v_permlane16_swap_b32 v49, v51
    v_pk_max_i16 v48, v48, 0
    v_pk_max_i16 v49, v49, 0
    v_pk_max_i16 v50, v50, 0
    v_pk_max_i16 v51, v51, 0
    buffer_store_dwordx4 v[48:51], v168, s[12:15], s27 offen offset:192
    s_lshl_b32 s28, s22, 4
    s_add_u32 s27, s27, s28
    v_accvgpr_read_b32 v4, a8
    v_accvgpr_read_b32 v5, a9
    v_accvgpr_read_b32 v6, a10
    v_accvgpr_read_b32 v7, a11
    v_accvgpr_read_b32 v8, a40
    v_accvgpr_read_b32 v9, a41
    v_accvgpr_read_b32 v10, a42
    v_accvgpr_read_b32 v11, a43
    v_cvt_pk_bf16_f32 v12, v4, v5
    v_cvt_pk_bf16_f32 v13, v6, v7
    v_cvt_pk_bf16_f32 v14, v8, v9
    v_cvt_pk_bf16_f32 v15, v10, v11
    s_nop 0
    v_permlane16_swap_b32 v12, v14
    v_permlane16_swap_b32 v13, v15
    v_pk_max_i16 v12, v12, 0
    v_pk_max_i16 v13, v13, 0
    v_pk_max_i16 v14, v14, 0
    v_pk_max_i16 v15, v15, 0
    buffer_store_dwordx4 v[12:15], v168, s[12:15], s27 offen
    v_accvgpr_read_b32 v16, a72
    v_accvgpr_read_b32 v17, a73
    v_accvgpr_read_b32 v18, a74
    v_accvgpr_read_b32 v19, a75
    v_accvgpr_read_b32 v20, a104
    v_accvgpr_read_b32 v21, a105
    v_accvgpr_read_b32 v22, a106
    v_accvgpr_read_b32 v23, a107
    v_cvt_pk_bf16_f32 v24, v16, v17
    v_cvt_pk_bf16_f32 v25, v18, v19
    v_cvt_pk_bf16_f32 v26, v20, v21
    v_cvt_pk_bf16_f32 v27, v22, v23
    s_nop 0
    v_permlane16_swap_b32 v24, v26
    v_permlane16_swap_b32 v25, v27
    v_pk_max_i16 v24, v24, 0
    v_pk_max_i16 v25, v25, 0
    v_pk_max_i16 v26, v26, 0
    v_pk_max_i16 v27, v27, 0
    buffer_store_dwordx4 v[24:27], v168, s[12:15], s27 offen offset:64
    v_accvgpr_read_b32 v28, a136
    v_accvgpr_read_b32 v29, a137
    v_accvgpr_read_b32 v30, a138
    v_accvgpr_read_b32 v31, a139
    v_accvgpr_read_b32 v32, a168
    v_accvgpr_read_b32 v33, a169
    v_accvgpr_read_b32 v34, a170
    v_accvgpr_read_b32 v35, a171
    v_cvt_pk_bf16_f32 v36, v28, v29
    v_cvt_pk_bf16_f32 v37, v30, v31
    v_cvt_pk_bf16_f32 v38, v32, v33
    v_cvt_pk_bf16_f32 v39, v34, v35
    s_nop 0
    v_permlane16_swap_b32 v36, v38
    v_permlane16_swap_b32 v37, v39
    v_pk_max_i16 v36, v36, 0
    v_pk_max_i16 v37, v37, 0
    v_pk_max_i16 v38, v38, 0
    v_pk_max_i16 v39, v39, 0
    buffer_store_dwordx4 v[36:39], v168, s[12:15], s27 offen offset:128
    v_accvgpr_read_b32 v40, a200
    v_accvgpr_read_b32 v41, a201
    v_accvgpr_read_b32 v42, a202
    v_accvgpr_read_b32 v43, a203
    v_accvgpr_read_b32 v44, a232
    v_accvgpr_read_b32 v45, a233
    v_accvgpr_read_b32 v46, a234
    v_accvgpr_read_b32 v47, a235
    v_cvt_pk_bf16_f32 v48, v40, v41
    v_cvt_pk_bf16_f32 v49, v42, v43
    v_cvt_pk_bf16_f32 v50, v44, v45
    v_cvt_pk_bf16_f32 v51, v46, v47
    s_nop 0
    v_permlane16_swap_b32 v48, v50
    v_permlane16_swap_b32 v49, v51
    v_pk_max_i16 v48, v48, 0
    v_pk_max_i16 v49, v49, 0
    v_pk_max_i16 v50, v50, 0
    v_pk_max_i16 v51, v51, 0
    buffer_store_dwordx4 v[48:51], v168, s[12:15], s27 offen offset:192
    s_lshl_b32 s28, s22, 4
    s_add_u32 s27, s27, s28
    v_accvgpr_read_b32 v4, a12
    v_accvgpr_read_b32 v5, a13
    v_accvgpr_read_b32 v6, a14
    v_accvgpr_read_b32 v7, a15
    v_accvgpr_read_b32 v8, a44
    v_accvgpr_read_b32 v9, a45
    v_accvgpr_read_b32 v10, a46
    v_accvgpr_read_b32 v11, a47
    v_cvt_pk_bf16_f32 v12, v4, v5
    v_cvt_pk_bf16_f32 v13, v6, v7
    v_cvt_pk_bf16_f32 v14, v8, v9
    v_cvt_pk_bf16_f32 v15, v10, v11
    s_nop 0
    v_permlane16_swap_b32 v12, v14
    v_permlane16_swap_b32 v13, v15
    v_pk_max_i16 v12, v12, 0
    v_pk_max_i16 v13, v13, 0
    v_pk_max_i16 v14, v14, 0
    v_pk_max_i16 v15, v15, 0
    buffer_store_dwordx4 v[12:15], v168, s[12:15], s27 offen
    v_accvgpr_read_b32 v16, a76
    v_accvgpr_read_b32 v17, a77
    v_accvgpr_read_b32 v18, a78
    v_accvgpr_read_b32 v19, a79
    v_accvgpr_read_b32 v20, a108
    v_accvgpr_read_b32 v21, a109
    v_accvgpr_read_b32 v22, a110
    v_accvgpr_read_b32 v23, a111
    v_cvt_pk_bf16_f32 v24, v16, v17
    v_cvt_pk_bf16_f32 v25, v18, v19
    v_cvt_pk_bf16_f32 v26, v20, v21
    v_cvt_pk_bf16_f32 v27, v22, v23
    s_nop 0
    v_permlane16_swap_b32 v24, v26
    v_permlane16_swap_b32 v25, v27
    v_pk_max_i16 v24, v24, 0
    v_pk_max_i16 v25, v25, 0
    v_pk_max_i16 v26, v26, 0
    v_pk_max_i16 v27, v27, 0
    buffer_store_dwordx4 v[24:27], v168, s[12:15], s27 offen offset:64
    v_accvgpr_read_b32 v28, a140
    v_accvgpr_read_b32 v29, a141
    v_accvgpr_read_b32 v30, a142
    v_accvgpr_read_b32 v31, a143
    v_accvgpr_read_b32 v32, a172
    v_accvgpr_read_b32 v33, a173
    v_accvgpr_read_b32 v34, a174
    v_accvgpr_read_b32 v35, a175
    v_cvt_pk_bf16_f32 v36, v28, v29
    v_cvt_pk_bf16_f32 v37, v30, v31
    v_cvt_pk_bf16_f32 v38, v32, v33
    v_cvt_pk_bf16_f32 v39, v34, v35
    s_nop 0
    v_permlane16_swap_b32 v36, v38
    v_permlane16_swap_b32 v37, v39
    v_pk_max_i16 v36, v36, 0
    v_pk_max_i16 v37, v37, 0
    v_pk_max_i16 v38, v38, 0
    v_pk_max_i16 v39, v39, 0
    buffer_store_dwordx4 v[36:39], v168, s[12:15], s27 offen offset:128
    v_accvgpr_read_b32 v40, a204
    v_accvgpr_read_b32 v41, a205
    v_accvgpr_read_b32 v42, a206
    v_accvgpr_read_b32 v43, a207
    v_accvgpr_read_b32 v44, a236
    v_accvgpr_read_b32 v45, a237
    v_accvgpr_read_b32 v46, a238
    v_accvgpr_read_b32 v47, a239
    v_cvt_pk_bf16_f32 v48, v40, v41
    v_cvt_pk_bf16_f32 v49, v42, v43
    v_cvt_pk_bf16_f32 v50, v44, v45
    v_cvt_pk_bf16_f32 v51, v46, v47
    s_nop 0
    v_permlane16_swap_b32 v48, v50
    v_permlane16_swap_b32 v49, v51
    v_pk_max_i16 v48, v48, 0
    v_pk_max_i16 v49, v49, 0
    v_pk_max_i16 v50, v50, 0
    v_pk_max_i16 v51, v51, 0
    buffer_store_dwordx4 v[48:51], v168, s[12:15], s27 offen offset:192
    s_lshl_b32 s28, s22, 4
    s_add_u32 s27, s27, s28
    v_accvgpr_read_b32 v4, a16
    v_accvgpr_read_b32 v5, a17
    v_accvgpr_read_b32 v6, a18
    v_accvgpr_read_b32 v7, a19
    v_accvgpr_read_b32 v8, a48
    v_accvgpr_read_b32 v9, a49
    v_accvgpr_read_b32 v10, a50
    v_accvgpr_read_b32 v11, a51
    v_cvt_pk_bf16_f32 v12, v4, v5
    v_cvt_pk_bf16_f32 v13, v6, v7
    v_cvt_pk_bf16_f32 v14, v8, v9
    v_cvt_pk_bf16_f32 v15, v10, v11
    s_nop 0
    v_permlane16_swap_b32 v12, v14
    v_permlane16_swap_b32 v13, v15
    v_pk_max_i16 v12, v12, 0
    v_pk_max_i16 v13, v13, 0
    v_pk_max_i16 v14, v14, 0
    v_pk_max_i16 v15, v15, 0
    buffer_store_dwordx4 v[12:15], v168, s[12:15], s27 offen
    v_accvgpr_read_b32 v16, a80
    v_accvgpr_read_b32 v17, a81
    v_accvgpr_read_b32 v18, a82
    v_accvgpr_read_b32 v19, a83
    v_accvgpr_read_b32 v20, a112
    v_accvgpr_read_b32 v21, a113
    v_accvgpr_read_b32 v22, a114
    v_accvgpr_read_b32 v23, a115
    v_cvt_pk_bf16_f32 v24, v16, v17
    v_cvt_pk_bf16_f32 v25, v18, v19
    v_cvt_pk_bf16_f32 v26, v20, v21
    v_cvt_pk_bf16_f32 v27, v22, v23
    s_nop 0
    v_permlane16_swap_b32 v24, v26
    v_permlane16_swap_b32 v25, v27
    v_pk_max_i16 v24, v24, 0
    v_pk_max_i16 v25, v25, 0
    v_pk_max_i16 v26, v26, 0
    v_pk_max_i16 v27, v27, 0
    buffer_store_dwordx4 v[24:27], v168, s[12:15], s27 offen offset:64
    v_accvgpr_read_b32 v28, a144
    v_accvgpr_read_b32 v29, a145
    v_accvgpr_read_b32 v30, a146
    v_accvgpr_read_b32 v31, a147
    v_accvgpr_read_b32 v32, a176
    v_accvgpr_read_b32 v33, a177
    v_accvgpr_read_b32 v34, a178
    v_accvgpr_read_b32 v35, a179
    v_cvt_pk_bf16_f32 v36, v28, v29
    v_cvt_pk_bf16_f32 v37, v30, v31
    v_cvt_pk_bf16_f32 v38, v32, v33
    v_cvt_pk_bf16_f32 v39, v34, v35
    s_nop 0
    v_permlane16_swap_b32 v36, v38
    v_permlane16_swap_b32 v37, v39
    v_pk_max_i16 v36, v36, 0
    v_pk_max_i16 v37, v37, 0
    v_pk_max_i16 v38, v38, 0
    v_pk_max_i16 v39, v39, 0
    buffer_store_dwordx4 v[36:39], v168, s[12:15], s27 offen offset:128
    v_accvgpr_read_b32 v40, a208
    v_accvgpr_read_b32 v41, a209
    v_accvgpr_read_b32 v42, a210
    v_accvgpr_read_b32 v43, a211
    v_accvgpr_read_b32 v44, a240
    v_accvgpr_read_b32 v45, a241
    v_accvgpr_read_b32 v46, a242
    v_accvgpr_read_b32 v47, a243
    v_cvt_pk_bf16_f32 v48, v40, v41
    v_cvt_pk_bf16_f32 v49, v42, v43
    v_cvt_pk_bf16_f32 v50, v44, v45
    v_cvt_pk_bf16_f32 v51, v46, v47
    s_nop 0
    v_permlane16_swap_b32 v48, v50
    v_permlane16_swap_b32 v49, v51
    v_pk_max_i16 v48, v48, 0
    v_pk_max_i16 v49, v49, 0
    v_pk_max_i16 v50, v50, 0
    v_pk_max_i16 v51, v51, 0
    buffer_store_dwordx4 v[48:51], v168, s[12:15], s27 offen offset:192
    s_lshl_b32 s28, s22, 4
    s_add_u32 s27, s27, s28
    v_accvgpr_read_b32 v4, a20
    v_accvgpr_read_b32 v5, a21
    v_accvgpr_read_b32 v6, a22
    v_accvgpr_read_b32 v7, a23
    v_accvgpr_read_b32 v8, a52
    v_accvgpr_read_b32 v9, a53
    v_accvgpr_read_b32 v10, a54
    v_accvgpr_read_b32 v11, a55
    v_cvt_pk_bf16_f32 v12, v4, v5
    v_cvt_pk_bf16_f32 v13, v6, v7
    v_cvt_pk_bf16_f32 v14, v8, v9
    v_cvt_pk_bf16_f32 v15, v10, v11
    s_nop 0
    v_permlane16_swap_b32 v12, v14
    v_permlane16_swap_b32 v13, v15
    v_pk_max_i16 v12, v12, 0
    v_pk_max_i16 v13, v13, 0
    v_pk_max_i16 v14, v14, 0
    v_pk_max_i16 v15, v15, 0
    buffer_store_dwordx4 v[12:15], v168, s[12:15], s27 offen
    v_accvgpr_read_b32 v16, a84
    v_accvgpr_read_b32 v17, a85
    v_accvgpr_read_b32 v18, a86
    v_accvgpr_read_b32 v19, a87
    v_accvgpr_read_b32 v20, a116
    v_accvgpr_read_b32 v21, a117
    v_accvgpr_read_b32 v22, a118
    v_accvgpr_read_b32 v23, a119
    v_cvt_pk_bf16_f32 v24, v16, v17
    v_cvt_pk_bf16_f32 v25, v18, v19
    v_cvt_pk_bf16_f32 v26, v20, v21
    v_cvt_pk_bf16_f32 v27, v22, v23
    s_nop 0
    v_permlane16_swap_b32 v24, v26
    v_permlane16_swap_b32 v25, v27
    v_pk_max_i16 v24, v24, 0
    v_pk_max_i16 v25, v25, 0
    v_pk_max_i16 v26, v26, 0
    v_pk_max_i16 v27, v27, 0
    buffer_store_dwordx4 v[24:27], v168, s[12:15], s27 offen offset:64
    v_accvgpr_read_b32 v28, a148
    v_accvgpr_read_b32 v29, a149
    v_accvgpr_read_b32 v30, a150
    v_accvgpr_read_b32 v31, a151
    v_accvgpr_read_b32 v32, a180
    v_accvgpr_read_b32 v33, a181
    v_accvgpr_read_b32 v34, a182
    v_accvgpr_read_b32 v35, a183
    v_cvt_pk_bf16_f32 v36, v28, v29
    v_cvt_pk_bf16_f32 v37, v30, v31
    v_cvt_pk_bf16_f32 v38, v32, v33
    v_cvt_pk_bf16_f32 v39, v34, v35
    s_nop 0
    v_permlane16_swap_b32 v36, v38
    v_permlane16_swap_b32 v37, v39
    v_pk_max_i16 v36, v36, 0
    v_pk_max_i16 v37, v37, 0
    v_pk_max_i16 v38, v38, 0
    v_pk_max_i16 v39, v39, 0
    buffer_store_dwordx4 v[36:39], v168, s[12:15], s27 offen offset:128
    v_accvgpr_read_b32 v40, a212
    v_accvgpr_read_b32 v41, a213
    v_accvgpr_read_b32 v42, a214
    v_accvgpr_read_b32 v43, a215
    v_accvgpr_read_b32 v44, a244
    v_accvgpr_read_b32 v45, a245
    v_accvgpr_read_b32 v46, a246
    v_accvgpr_read_b32 v47, a247
    v_cvt_pk_bf16_f32 v48, v40, v41
    v_cvt_pk_bf16_f32 v49, v42, v43
    v_cvt_pk_bf16_f32 v50, v44, v45
    v_cvt_pk_bf16_f32 v51, v46, v47
    s_nop 0
    v_permlane16_swap_b32 v48, v50
    v_permlane16_swap_b32 v49, v51
    v_pk_max_i16 v48, v48, 0
    v_pk_max_i16 v49, v49, 0
    v_pk_max_i16 v50, v50, 0
    v_pk_max_i16 v51, v51, 0
    buffer_store_dwordx4 v[48:51], v168, s[12:15], s27 offen offset:192
    s_lshl_b32 s28, s22, 4
    s_add_u32 s27, s27, s28
    v_accvgpr_read_b32 v4, a24
    v_accvgpr_read_b32 v5, a25
    v_accvgpr_read_b32 v6, a26
    v_accvgpr_read_b32 v7, a27
    v_accvgpr_read_b32 v8, a56
    v_accvgpr_read_b32 v9, a57
    v_accvgpr_read_b32 v10, a58
    v_accvgpr_read_b32 v11, a59
    v_cvt_pk_bf16_f32 v12, v4, v5
    v_cvt_pk_bf16_f32 v13, v6, v7
    v_cvt_pk_bf16_f32 v14, v8, v9
    v_cvt_pk_bf16_f32 v15, v10, v11
    s_nop 0
    v_permlane16_swap_b32 v12, v14
    v_permlane16_swap_b32 v13, v15
    v_pk_max_i16 v12, v12, 0
    v_pk_max_i16 v13, v13, 0
    v_pk_max_i16 v14, v14, 0
    v_pk_max_i16 v15, v15, 0
    buffer_store_dwordx4 v[12:15], v168, s[12:15], s27 offen
    v_accvgpr_read_b32 v16, a88
    v_accvgpr_read_b32 v17, a89
    v_accvgpr_read_b32 v18, a90
    v_accvgpr_read_b32 v19, a91
    v_accvgpr_read_b32 v20, a120
    v_accvgpr_read_b32 v21, a121
    v_accvgpr_read_b32 v22, a122
    v_accvgpr_read_b32 v23, a123
    v_cvt_pk_bf16_f32 v24, v16, v17
    v_cvt_pk_bf16_f32 v25, v18, v19
    v_cvt_pk_bf16_f32 v26, v20, v21
    v_cvt_pk_bf16_f32 v27, v22, v23
    s_nop 0
    v_permlane16_swap_b32 v24, v26
    v_permlane16_swap_b32 v25, v27
    v_pk_max_i16 v24, v24, 0
    v_pk_max_i16 v25, v25, 0
    v_pk_max_i16 v26, v26, 0
    v_pk_max_i16 v27, v27, 0
    buffer_store_dwordx4 v[24:27], v168, s[12:15], s27 offen offset:64
    v_accvgpr_read_b32 v28, a152
    v_accvgpr_read_b32 v29, a153
    v_accvgpr_read_b32 v30, a154
    v_accvgpr_read_b32 v31, a155
    v_accvgpr_read_b32 v32, a184
    v_accvgpr_read_b32 v33, a185
    v_accvgpr_read_b32 v34, a186
    v_accvgpr_read_b32 v35, a187
    v_cvt_pk_bf16_f32 v36, v28, v29
    v_cvt_pk_bf16_f32 v37, v30, v31
    v_cvt_pk_bf16_f32 v38, v32, v33
    v_cvt_pk_bf16_f32 v39, v34, v35
    s_nop 0
    v_permlane16_swap_b32 v36, v38
    v_permlane16_swap_b32 v37, v39
    v_pk_max_i16 v36, v36, 0
    v_pk_max_i16 v37, v37, 0
    v_pk_max_i16 v38, v38, 0
    v_pk_max_i16 v39, v39, 0
    buffer_store_dwordx4 v[36:39], v168, s[12:15], s27 offen offset:128
    v_accvgpr_read_b32 v40, a216
    v_accvgpr_read_b32 v41, a217
    v_accvgpr_read_b32 v42, a218
    v_accvgpr_read_b32 v43, a219
    v_accvgpr_read_b32 v44, a248
    v_accvgpr_read_b32 v45, a249
    v_accvgpr_read_b32 v46, a250
    v_accvgpr_read_b32 v47, a251
    v_cvt_pk_bf16_f32 v48, v40, v41
    v_cvt_pk_bf16_f32 v49, v42, v43
    v_cvt_pk_bf16_f32 v50, v44, v45
    v_cvt_pk_bf16_f32 v51, v46, v47
    s_nop 0
    v_permlane16_swap_b32 v48, v50
    v_permlane16_swap_b32 v49, v51
    v_pk_max_i16 v48, v48, 0
    v_pk_max_i16 v49, v49, 0
    v_pk_max_i16 v50, v50, 0
    v_pk_max_i16 v51, v51, 0
    buffer_store_dwordx4 v[48:51], v168, s[12:15], s27 offen offset:192
    s_lshl_b32 s28, s22, 4
    s_add_u32 s27, s27, s28
    v_accvgpr_read_b32 v4, a28
    v_accvgpr_read_b32 v5, a29
    v_accvgpr_read_b32 v6, a30
    v_accvgpr_read_b32 v7, a31
    v_accvgpr_read_b32 v8, a60
    v_accvgpr_read_b32 v9, a61
    v_accvgpr_read_b32 v10, a62
    v_accvgpr_read_b32 v11, a63
    v_cvt_pk_bf16_f32 v12, v4, v5
    v_cvt_pk_bf16_f32 v13, v6, v7
    v_cvt_pk_bf16_f32 v14, v8, v9
    v_cvt_pk_bf16_f32 v15, v10, v11
    s_nop 0
    v_permlane16_swap_b32 v12, v14
    v_permlane16_swap_b32 v13, v15
    v_pk_max_i16 v12, v12, 0
    v_pk_max_i16 v13, v13, 0
    v_pk_max_i16 v14, v14, 0
    v_pk_max_i16 v15, v15, 0
    buffer_store_dwordx4 v[12:15], v168, s[12:15], s27 offen
    v_accvgpr_read_b32 v16, a92
    v_accvgpr_read_b32 v17, a93
    v_accvgpr_read_b32 v18, a94
    v_accvgpr_read_b32 v19, a95
    v_accvgpr_read_b32 v20, a124
    v_accvgpr_read_b32 v21, a125
    v_accvgpr_read_b32 v22, a126
    v_accvgpr_read_b32 v23, a127
    v_cvt_pk_bf16_f32 v24, v16, v17
    v_cvt_pk_bf16_f32 v25, v18, v19
    v_cvt_pk_bf16_f32 v26, v20, v21
    v_cvt_pk_bf16_f32 v27, v22, v23
    s_nop 0
    v_permlane16_swap_b32 v24, v26
    v_permlane16_swap_b32 v25, v27
    v_pk_max_i16 v24, v24, 0
    v_pk_max_i16 v25, v25, 0
    v_pk_max_i16 v26, v26, 0
    v_pk_max_i16 v27, v27, 0
    buffer_store_dwordx4 v[24:27], v168, s[12:15], s27 offen offset:64
    v_accvgpr_read_b32 v28, a156
    v_accvgpr_read_b32 v29, a157
    v_accvgpr_read_b32 v30, a158
    v_accvgpr_read_b32 v31, a159
    v_accvgpr_read_b32 v32, a188
    v_accvgpr_read_b32 v33, a189
    v_accvgpr_read_b32 v34, a190
    v_accvgpr_read_b32 v35, a191
    v_cvt_pk_bf16_f32 v36, v28, v29
    v_cvt_pk_bf16_f32 v37, v30, v31
    v_cvt_pk_bf16_f32 v38, v32, v33
    v_cvt_pk_bf16_f32 v39, v34, v35
    s_nop 0
    v_permlane16_swap_b32 v36, v38
    v_permlane16_swap_b32 v37, v39
    v_pk_max_i16 v36, v36, 0
    v_pk_max_i16 v37, v37, 0
    v_pk_max_i16 v38, v38, 0
    v_pk_max_i16 v39, v39, 0
    buffer_store_dwordx4 v[36:39], v168, s[12:15], s27 offen offset:128
    v_accvgpr_read_b32 v40, a220
    v_accvgpr_read_b32 v41, a221
    v_accvgpr_read_b32 v42, a222
    v_accvgpr_read_b32 v43, a223
    v_accvgpr_read_b32 v44, a252
    v_accvgpr_read_b32 v45, a253
    v_accvgpr_read_b32 v46, a254
    v_accvgpr_read_b32 v47, a255
    v_cvt_pk_bf16_f32 v48, v40, v41
    v_cvt_pk_bf16_f32 v49, v42, v43
    v_cvt_pk_bf16_f32 v50, v44, v45
    v_cvt_pk_bf16_f32 v51, v46, v47
    s_nop 0
    v_permlane16_swap_b32 v48, v50
    v_permlane16_swap_b32 v49, v51
    v_pk_max_i16 v48, v48, 0
    v_pk_max_i16 v49, v49, 0
    v_pk_max_i16 v50, v50, 0
    v_pk_max_i16 v51, v51, 0
    buffer_store_dwordx4 v[48:51], v168, s[12:15], s27 offen offset:192
    s_branch gemm1_kernel_end
gemm1_kernel_epi_plain:
    s_waitcnt vmcnt(0) lgkmcnt(0)
    s_nop 15
    s_nop 7
    s_mov_b32 s27, 0
    v_accvgpr_read_b32 v4, a0
    v_accvgpr_read_b32 v5, a1
    v_accvgpr_read_b32 v6, a2
    v_accvgpr_read_b32 v7, a3
    v_accvgpr_read_b32 v8, a32
    v_accvgpr_read_b32 v9, a33
    v_accvgpr_read_b32 v10, a34
    v_accvgpr_read_b32 v11, a35
    v_cvt_pk_bf16_f32 v12, v4, v5
    v_cvt_pk_bf16_f32 v13, v6, v7
    v_cvt_pk_bf16_f32 v14, v8, v9
    v_cvt_pk_bf16_f32 v15, v10, v11
    s_nop 0
    v_permlane16_swap_b32 v12, v14
    v_permlane16_swap_b32 v13, v15
    buffer_store_dwordx4 v[12:15], v168, s[12:15], s27 offen
    v_accvgpr_read_b32 v16, a64
    v_accvgpr_read_b32 v17, a65
    v_accvgpr_read_b32 v18, a66
    v_accvgpr_read_b32 v19, a67
    v_accvgpr_read_b32 v20, a96
    v_accvgpr_read_b32 v21, a97
    v_accvgpr_read_b32 v22, a98
    v_accvgpr_read_b32 v23, a99
    v_cvt_pk_bf16_f32 v24, v16, v17
    v_cvt_pk_bf16_f32 v25, v18, v19
    v_cvt_pk_bf16_f32 v26, v20, v21
    v_cvt_pk_bf16_f32 v27, v22, v23
    s_nop 0
    v_permlane16_swap_b32 v24, v26
    v_permlane16_swap_b32 v25, v27
    buffer_store_dwordx4 v[24:27], v168, s[12:15], s27 offen offset:64
    v_accvgpr_read_b32 v28, a128
    v_accvgpr_read_b32 v29, a129
    v_accvgpr_read_b32 v30, a130
    v_accvgpr_read_b32 v31, a131
    v_accvgpr_read_b32 v32, a160
    v_accvgpr_read_b32 v33, a161
    v_accvgpr_read_b32 v34, a162
    v_accvgpr_read_b32 v35, a163
    v_cvt_pk_bf16_f32 v36, v28, v29
    v_cvt_pk_bf16_f32 v37, v30, v31
    v_cvt_pk_bf16_f32 v38, v32, v33
    v_cvt_pk_bf16_f32 v39, v34, v35
    s_nop 0
    v_permlane16_swap_b32 v36, v38
    v_permlane16_swap_b32 v37, v39
    buffer_store_dwordx4 v[36:39], v168, s[12:15], s27 offen offset:128
    v_accvgpr_read_b32 v40, a192
    v_accvgpr_read_b32 v41, a193
    v_accvgpr_read_b32 v42, a194
    v_accvgpr_read_b32 v43, a195
    v_accvgpr_read_b32 v44, a224
    v_accvgpr_read_b32 v45, a225
    v_accvgpr_read_b32 v46, a226
    v_accvgpr_read_b32 v47, a227
    v_cvt_pk_bf16_f32 v48, v40, v41
    v_cvt_pk_bf16_f32 v49, v42, v43
    v_cvt_pk_bf16_f32 v50, v44, v45
    v_cvt_pk_bf16_f32 v51, v46, v47
    s_nop 0
    v_permlane16_swap_b32 v48, v50
    v_permlane16_swap_b32 v49, v51
    buffer_store_dwordx4 v[48:51], v168, s[12:15], s27 offen offset:192
    s_lshl_b32 s28, s22, 4
    s_add_u32 s27, s27, s28
    v_accvgpr_read_b32 v4, a4
    v_accvgpr_read_b32 v5, a5
    v_accvgpr_read_b32 v6, a6
    v_accvgpr_read_b32 v7, a7
    v_accvgpr_read_b32 v8, a36
    v_accvgpr_read_b32 v9, a37
    v_accvgpr_read_b32 v10, a38
    v_accvgpr_read_b32 v11, a39
    v_cvt_pk_bf16_f32 v12, v4, v5
    v_cvt_pk_bf16_f32 v13, v6, v7
    v_cvt_pk_bf16_f32 v14, v8, v9
    v_cvt_pk_bf16_f32 v15, v10, v11
    s_nop 0
    v_permlane16_swap_b32 v12, v14
    v_permlane16_swap_b32 v13, v15
    buffer_store_dwordx4 v[12:15], v168, s[12:15], s27 offen
    v_accvgpr_read_b32 v16, a68
    v_accvgpr_read_b32 v17, a69
    v_accvgpr_read_b32 v18, a70
    v_accvgpr_read_b32 v19, a71
    v_accvgpr_read_b32 v20, a100
    v_accvgpr_read_b32 v21, a101
    v_accvgpr_read_b32 v22, a102
    v_accvgpr_read_b32 v23, a103
    v_cvt_pk_bf16_f32 v24, v16, v17
    v_cvt_pk_bf16_f32 v25, v18, v19
    v_cvt_pk_bf16_f32 v26, v20, v21
    v_cvt_pk_bf16_f32 v27, v22, v23
    s_nop 0
    v_permlane16_swap_b32 v24, v26
    v_permlane16_swap_b32 v25, v27
    buffer_store_dwordx4 v[24:27], v168, s[12:15], s27 offen offset:64
    v_accvgpr_read_b32 v28, a132
    v_accvgpr_read_b32 v29, a133
    v_accvgpr_read_b32 v30, a134
    v_accvgpr_read_b32 v31, a135
    v_accvgpr_read_b32 v32, a164
    v_accvgpr_read_b32 v33, a165
    v_accvgpr_read_b32 v34, a166
    v_accvgpr_read_b32 v35, a167
    v_cvt_pk_bf16_f32 v36, v28, v29
    v_cvt_pk_bf16_f32 v37, v30, v31
    v_cvt_pk_bf16_f32 v38, v32, v33
    v_cvt_pk_bf16_f32 v39, v34, v35
    s_nop 0
    v_permlane16_swap_b32 v36, v38
    v_permlane16_swap_b32 v37, v39
    buffer_store_dwordx4 v[36:39], v168, s[12:15], s27 offen offset:128
    v_accvgpr_read_b32 v40, a196
    v_accvgpr_read_b32 v41, a197
    v_accvgpr_read_b32 v42, a198
    v_accvgpr_read_b32 v43, a199
    v_accvgpr_read_b32 v44, a228
    v_accvgpr_read_b32 v45, a229
    v_accvgpr_read_b32 v46, a230
    v_accvgpr_read_b32 v47, a231
    v_cvt_pk_bf16_f32 v48, v40, v41
    v_cvt_pk_bf16_f32 v49, v42, v43
    v_cvt_pk_bf16_f32 v50, v44, v45
    v_cvt_pk_bf16_f32 v51, v46, v47
    s_nop 0
    v_permlane16_swap_b32 v48, v50
    v_permlane16_swap_b32 v49, v51
    buffer_store_dwordx4 v[48:51], v168, s[12:15], s27 offen offset:192
    s_lshl_b32 s28, s22, 4
    s_add_u32 s27, s27, s28
    v_accvgpr_read_b32 v4, a8
    v_accvgpr_read_b32 v5, a9
    v_accvgpr_read_b32 v6, a10
    v_accvgpr_read_b32 v7, a11
    v_accvgpr_read_b32 v8, a40
    v_accvgpr_read_b32 v9, a41
    v_accvgpr_read_b32 v10, a42
    v_accvgpr_read_b32 v11, a43
    v_cvt_pk_bf16_f32 v12, v4, v5
    v_cvt_pk_bf16_f32 v13, v6, v7
    v_cvt_pk_bf16_f32 v14, v8, v9
    v_cvt_pk_bf16_f32 v15, v10, v11
    s_nop 0
    v_permlane16_swap_b32 v12, v14
    v_permlane16_swap_b32 v13, v15
    buffer_store_dwordx4 v[12:15], v168, s[12:15], s27 offen
    v_accvgpr_read_b32 v16, a72
    v_accvgpr_read_b32 v17, a73
    v_accvgpr_read_b32 v18, a74
    v_accvgpr_read_b32 v19, a75
    v_accvgpr_read_b32 v20, a104
    v_accvgpr_read_b32 v21, a105
    v_accvgpr_read_b32 v22, a106
    v_accvgpr_read_b32 v23, a107
    v_cvt_pk_bf16_f32 v24, v16, v17
    v_cvt_pk_bf16_f32 v25, v18, v19
    v_cvt_pk_bf16_f32 v26, v20, v21
    v_cvt_pk_bf16_f32 v27, v22, v23
    s_nop 0
    v_permlane16_swap_b32 v24, v26
    v_permlane16_swap_b32 v25, v27
    buffer_store_dwordx4 v[24:27], v168, s[12:15], s27 offen offset:64
    v_accvgpr_read_b32 v28, a136
    v_accvgpr_read_b32 v29, a137
    v_accvgpr_read_b32 v30, a138
    v_accvgpr_read_b32 v31, a139
    v_accvgpr_read_b32 v32, a168
    v_accvgpr_read_b32 v33, a169
    v_accvgpr_read_b32 v34, a170
    v_accvgpr_read_b32 v35, a171
    v_cvt_pk_bf16_f32 v36, v28, v29
    v_cvt_pk_bf16_f32 v37, v30, v31
    v_cvt_pk_bf16_f32 v38, v32, v33
    v_cvt_pk_bf16_f32 v39, v34, v35
    s_nop 0
    v_permlane16_swap_b32 v36, v38
    v_permlane16_swap_b32 v37, v39
    buffer_store_dwordx4 v[36:39], v168, s[12:15], s27 offen offset:128
    v_accvgpr_read_b32 v40, a200
    v_accvgpr_read_b32 v41, a201
    v_accvgpr_read_b32 v42, a202
    v_accvgpr_read_b32 v43, a203
    v_accvgpr_read_b32 v44, a232
    v_accvgpr_read_b32 v45, a233
    v_accvgpr_read_b32 v46, a234
    v_accvgpr_read_b32 v47, a235
    v_cvt_pk_bf16_f32 v48, v40, v41
    v_cvt_pk_bf16_f32 v49, v42, v43
    v_cvt_pk_bf16_f32 v50, v44, v45
    v_cvt_pk_bf16_f32 v51, v46, v47
    s_nop 0
    v_permlane16_swap_b32 v48, v50
    v_permlane16_swap_b32 v49, v51
    buffer_store_dwordx4 v[48:51], v168, s[12:15], s27 offen offset:192
    s_lshl_b32 s28, s22, 4
    s_add_u32 s27, s27, s28
    v_accvgpr_read_b32 v4, a12
    v_accvgpr_read_b32 v5, a13
    v_accvgpr_read_b32 v6, a14
    v_accvgpr_read_b32 v7, a15
    v_accvgpr_read_b32 v8, a44
    v_accvgpr_read_b32 v9, a45
    v_accvgpr_read_b32 v10, a46
    v_accvgpr_read_b32 v11, a47
    v_cvt_pk_bf16_f32 v12, v4, v5
    v_cvt_pk_bf16_f32 v13, v6, v7
    v_cvt_pk_bf16_f32 v14, v8, v9
    v_cvt_pk_bf16_f32 v15, v10, v11
    s_nop 0
    v_permlane16_swap_b32 v12, v14
    v_permlane16_swap_b32 v13, v15
    buffer_store_dwordx4 v[12:15], v168, s[12:15], s27 offen
    v_accvgpr_read_b32 v16, a76
    v_accvgpr_read_b32 v17, a77
    v_accvgpr_read_b32 v18, a78
    v_accvgpr_read_b32 v19, a79
    v_accvgpr_read_b32 v20, a108
    v_accvgpr_read_b32 v21, a109
    v_accvgpr_read_b32 v22, a110
    v_accvgpr_read_b32 v23, a111
    v_cvt_pk_bf16_f32 v24, v16, v17
    v_cvt_pk_bf16_f32 v25, v18, v19
    v_cvt_pk_bf16_f32 v26, v20, v21
    v_cvt_pk_bf16_f32 v27, v22, v23
    s_nop 0
    v_permlane16_swap_b32 v24, v26
    v_permlane16_swap_b32 v25, v27
    buffer_store_dwordx4 v[24:27], v168, s[12:15], s27 offen offset:64
    v_accvgpr_read_b32 v28, a140
    v_accvgpr_read_b32 v29, a141
    v_accvgpr_read_b32 v30, a142
    v_accvgpr_read_b32 v31, a143
    v_accvgpr_read_b32 v32, a172
    v_accvgpr_read_b32 v33, a173
    v_accvgpr_read_b32 v34, a174
    v_accvgpr_read_b32 v35, a175
    v_cvt_pk_bf16_f32 v36, v28, v29
    v_cvt_pk_bf16_f32 v37, v30, v31
    v_cvt_pk_bf16_f32 v38, v32, v33
    v_cvt_pk_bf16_f32 v39, v34, v35
    s_nop 0
    v_permlane16_swap_b32 v36, v38
    v_permlane16_swap_b32 v37, v39
    buffer_store_dwordx4 v[36:39], v168, s[12:15], s27 offen offset:128
    v_accvgpr_read_b32 v40, a204
    v_accvgpr_read_b32 v41, a205
    v_accvgpr_read_b32 v42, a206
    v_accvgpr_read_b32 v43, a207
    v_accvgpr_read_b32 v44, a236
    v_accvgpr_read_b32 v45, a237
    v_accvgpr_read_b32 v46, a238
    v_accvgpr_read_b32 v47, a239
    v_cvt_pk_bf16_f32 v48, v40, v41
    v_cvt_pk_bf16_f32 v49, v42, v43
    v_cvt_pk_bf16_f32 v50, v44, v45
    v_cvt_pk_bf16_f32 v51, v46, v47
    s_nop 0
    v_permlane16_swap_b32 v48, v50
    v_permlane16_swap_b32 v49, v51
    buffer_store_dwordx4 v[48:51], v168, s[12:15], s27 offen offset:192
    s_lshl_b32 s28, s22, 4
    s_add_u32 s27, s27, s28
    v_accvgpr_read_b32 v4, a16
    v_accvgpr_read_b32 v5, a17
    v_accvgpr_read_b32 v6, a18
    v_accvgpr_read_b32 v7, a19
    v_accvgpr_read_b32 v8, a48
    v_accvgpr_read_b32 v9, a49
    v_accvgpr_read_b32 v10, a50
    v_accvgpr_read_b32 v11, a51
    v_cvt_pk_bf16_f32 v12, v4, v5
    v_cvt_pk_bf16_f32 v13, v6, v7
    v_cvt_pk_bf16_f32 v14, v8, v9
    v_cvt_pk_bf16_f32 v15, v10, v11
    s_nop 0
    v_permlane16_swap_b32 v12, v14
    v_permlane16_swap_b32 v13, v15
    buffer_store_dwordx4 v[12:15], v168, s[12:15], s27 offen
    v_accvgpr_read_b32 v16, a80
    v_accvgpr_read_b32 v17, a81
    v_accvgpr_read_b32 v18, a82
    v_accvgpr_read_b32 v19, a83
    v_accvgpr_read_b32 v20, a112
    v_accvgpr_read_b32 v21, a113
    v_accvgpr_read_b32 v22, a114
    v_accvgpr_read_b32 v23, a115
    v_cvt_pk_bf16_f32 v24, v16, v17
    v_cvt_pk_bf16_f32 v25, v18, v19
    v_cvt_pk_bf16_f32 v26, v20, v21
    v_cvt_pk_bf16_f32 v27, v22, v23
    s_nop 0
    v_permlane16_swap_b32 v24, v26
    v_permlane16_swap_b32 v25, v27
    buffer_store_dwordx4 v[24:27], v168, s[12:15], s27 offen offset:64
    v_accvgpr_read_b32 v28, a144
    v_accvgpr_read_b32 v29, a145
    v_accvgpr_read_b32 v30, a146
    v_accvgpr_read_b32 v31, a147
    v_accvgpr_read_b32 v32, a176
    v_accvgpr_read_b32 v33, a177
    v_accvgpr_read_b32 v34, a178
    v_accvgpr_read_b32 v35, a179
    v_cvt_pk_bf16_f32 v36, v28, v29
    v_cvt_pk_bf16_f32 v37, v30, v31
    v_cvt_pk_bf16_f32 v38, v32, v33
    v_cvt_pk_bf16_f32 v39, v34, v35
    s_nop 0
    v_permlane16_swap_b32 v36, v38
    v_permlane16_swap_b32 v37, v39
    buffer_store_dwordx4 v[36:39], v168, s[12:15], s27 offen offset:128
    v_accvgpr_read_b32 v40, a208
    v_accvgpr_read_b32 v41, a209
    v_accvgpr_read_b32 v42, a210
    v_accvgpr_read_b32 v43, a211
    v_accvgpr_read_b32 v44, a240
    v_accvgpr_read_b32 v45, a241
    v_accvgpr_read_b32 v46, a242
    v_accvgpr_read_b32 v47, a243
    v_cvt_pk_bf16_f32 v48, v40, v41
    v_cvt_pk_bf16_f32 v49, v42, v43
    v_cvt_pk_bf16_f32 v50, v44, v45
    v_cvt_pk_bf16_f32 v51, v46, v47
    s_nop 0
    v_permlane16_swap_b32 v48, v50
    v_permlane16_swap_b32 v49, v51
    buffer_store_dwordx4 v[48:51], v168, s[12:15], s27 offen offset:192
    s_lshl_b32 s28, s22, 4
    s_add_u32 s27, s27, s28
    v_accvgpr_read_b32 v4, a20
    v_accvgpr_read_b32 v5, a21
    v_accvgpr_read_b32 v6, a22
    v_accvgpr_read_b32 v7, a23
    v_accvgpr_read_b32 v8, a52
    v_accvgpr_read_b32 v9, a53
    v_accvgpr_read_b32 v10, a54
    v_accvgpr_read_b32 v11, a55
    v_cvt_pk_bf16_f32 v12, v4, v5
    v_cvt_pk_bf16_f32 v13, v6, v7
    v_cvt_pk_bf16_f32 v14, v8, v9
    v_cvt_pk_bf16_f32 v15, v10, v11
    s_nop 0
    v_permlane16_swap_b32 v12, v14
    v_permlane16_swap_b32 v13, v15
    buffer_store_dwordx4 v[12:15], v168, s[12:15], s27 offen
    v_accvgpr_read_b32 v16, a84
    v_accvgpr_read_b32 v17, a85
    v_accvgpr_read_b32 v18, a86
    v_accvgpr_read_b32 v19, a87
    v_accvgpr_read_b32 v20, a116
    v_accvgpr_read_b32 v21, a117
    v_accvgpr_read_b32 v22, a118
    v_accvgpr_read_b32 v23, a119
    v_cvt_pk_bf16_f32 v24, v16, v17
    v_cvt_pk_bf16_f32 v25, v18, v19
    v_cvt_pk_bf16_f32 v26, v20, v21
    v_cvt_pk_bf16_f32 v27, v22, v23
    s_nop 0
    v_permlane16_swap_b32 v24, v26
    v_permlane16_swap_b32 v25, v27
    buffer_store_dwordx4 v[24:27], v168, s[12:15], s27 offen offset:64
    v_accvgpr_read_b32 v28, a148
    v_accvgpr_read_b32 v29, a149
    v_accvgpr_read_b32 v30, a150
    v_accvgpr_read_b32 v31, a151
    v_accvgpr_read_b32 v32, a180
    v_accvgpr_read_b32 v33, a181
    v_accvgpr_read_b32 v34, a182
    v_accvgpr_read_b32 v35, a183
    v_cvt_pk_bf16_f32 v36, v28, v29
    v_cvt_pk_bf16_f32 v37, v30, v31
    v_cvt_pk_bf16_f32 v38, v32, v33
    v_cvt_pk_bf16_f32 v39, v34, v35
    s_nop 0
    v_permlane16_swap_b32 v36, v38
    v_permlane16_swap_b32 v37, v39
    buffer_store_dwordx4 v[36:39], v168, s[12:15], s27 offen offset:128
    v_accvgpr_read_b32 v40, a212
    v_accvgpr_read_b32 v41, a213
    v_accvgpr_read_b32 v42, a214
    v_accvgpr_read_b32 v43, a215
    v_accvgpr_read_b32 v44, a244
    v_accvgpr_read_b32 v45, a245
    v_accvgpr_read_b32 v46, a246
    v_accvgpr_read_b32 v47, a247
    v_cvt_pk_bf16_f32 v48, v40, v41
    v_cvt_pk_bf16_f32 v49, v42, v43
    v_cvt_pk_bf16_f32 v50, v44, v45
    v_cvt_pk_bf16_f32 v51, v46, v47
    s_nop 0
    v_permlane16_swap_b32 v48, v50
    v_permlane16_swap_b32 v49, v51
    buffer_store_dwordx4 v[48:51], v168, s[12:15], s27 offen offset:192
    s_lshl_b32 s28, s22, 4
    s_add_u32 s27, s27, s28
    v_accvgpr_read_b32 v4, a24
    v_accvgpr_read_b32 v5, a25
    v_accvgpr_read_b32 v6, a26
    v_accvgpr_read_b32 v7, a27
    v_accvgpr_read_b32 v8, a56
    v_accvgpr_read_b32 v9, a57
    v_accvgpr_read_b32 v10, a58
    v_accvgpr_read_b32 v11, a59
    v_cvt_pk_bf16_f32 v12, v4, v5
    v_cvt_pk_bf16_f32 v13, v6, v7
    v_cvt_pk_bf16_f32 v14, v8, v9
    v_cvt_pk_bf16_f32 v15, v10, v11
    s_nop 0
    v_permlane16_swap_b32 v12, v14
    v_permlane16_swap_b32 v13, v15
    buffer_store_dwordx4 v[12:15], v168, s[12:15], s27 offen
    v_accvgpr_read_b32 v16, a88
    v_accvgpr_read_b32 v17, a89
    v_accvgpr_read_b32 v18, a90
    v_accvgpr_read_b32 v19, a91
    v_accvgpr_read_b32 v20, a120
    v_accvgpr_read_b32 v21, a121
    v_accvgpr_read_b32 v22, a122
    v_accvgpr_read_b32 v23, a123
    v_cvt_pk_bf16_f32 v24, v16, v17
    v_cvt_pk_bf16_f32 v25, v18, v19
    v_cvt_pk_bf16_f32 v26, v20, v21
    v_cvt_pk_bf16_f32 v27, v22, v23
    s_nop 0
    v_permlane16_swap_b32 v24, v26
    v_permlane16_swap_b32 v25, v27
    buffer_store_dwordx4 v[24:27], v168, s[12:15], s27 offen offset:64
    v_accvgpr_read_b32 v28, a152
    v_accvgpr_read_b32 v29, a153
    v_accvgpr_read_b32 v30, a154
    v_accvgpr_read_b32 v31, a155
    v_accvgpr_read_b32 v32, a184
    v_accvgpr_read_b32 v33, a185
    v_accvgpr_read_b32 v34, a186
    v_accvgpr_read_b32 v35, a187
    v_cvt_pk_bf16_f32 v36, v28, v29
    v_cvt_pk_bf16_f32 v37, v30, v31
    v_cvt_pk_bf16_f32 v38, v32, v33
    v_cvt_pk_bf16_f32 v39, v34, v35
    s_nop 0
    v_permlane16_swap_b32 v36, v38
    v_permlane16_swap_b32 v37, v39
    buffer_store_dwordx4 v[36:39], v168, s[12:15], s27 offen offset:128
    v_accvgpr_read_b32 v40, a216
    v_accvgpr_read_b32 v41, a217
    v_accvgpr_read_b32 v42, a218
    v_accvgpr_read_b32 v43, a219
    v_accvgpr_read_b32 v44, a248
    v_accvgpr_read_b32 v45, a249
    v_accvgpr_read_b32 v46, a250
    v_accvgpr_read_b32 v47, a251
    v_cvt_pk_bf16_f32 v48, v40, v41
    v_cvt_pk_bf16_f32 v49, v42, v43
    v_cvt_pk_bf16_f32 v50, v44, v45
    v_cvt_pk_bf16_f32 v51, v46, v47
    s_nop 0
    v_permlane16_swap_b32 v48, v50
    v_permlane16_swap_b32 v49, v51
    buffer_store_dwordx4 v[48:51], v168, s[12:15], s27 offen offset:192
    s_lshl_b32 s28, s22, 4
    s_add_u32 s27, s27, s28
    v_accvgpr_read_b32 v4, a28
    v_accvgpr_read_b32 v5, a29
    v_accvgpr_read_b32 v6, a30
    v_accvgpr_read_b32 v7, a31
    v_accvgpr_read_b32 v8, a60
    v_accvgpr_read_b32 v9, a61
    v_accvgpr_read_b32 v10, a62
    v_accvgpr_read_b32 v11, a63
    v_cvt_pk_bf16_f32 v12, v4, v5
    v_cvt_pk_bf16_f32 v13, v6, v7
    v_cvt_pk_bf16_f32 v14, v8, v9
    v_cvt_pk_bf16_f32 v15, v10, v11
    s_nop 0
    v_permlane16_swap_b32 v12, v14
    v_permlane16_swap_b32 v13, v15
    buffer_store_dwordx4 v[12:15], v168, s[12:15], s27 offen
    v_accvgpr_read_b32 v16, a92
    v_accvgpr_read_b32 v17, a93
    v_accvgpr_read_b32 v18, a94
    v_accvgpr_read_b32 v19, a95
    v_accvgpr_read_b32 v20, a124
    v_accvgpr_read_b32 v21, a125
    v_accvgpr_read_b32 v22, a126
    v_accvgpr_read_b32 v23, a127
    v_cvt_pk_bf16_f32 v24, v16, v17
    v_cvt_pk_bf16_f32 v25, v18, v19
    v_cvt_pk_bf16_f32 v26, v20, v21
    v_cvt_pk_bf16_f32 v27, v22, v23
    s_nop 0
    v_permlane16_swap_b32 v24, v26
    v_permlane16_swap_b32 v25, v27
    buffer_store_dwordx4 v[24:27], v168, s[12:15], s27 offen offset:64
    v_accvgpr_read_b32 v28, a156
    v_accvgpr_read_b32 v29, a157
    v_accvgpr_read_b32 v30, a158
    v_accvgpr_read_b32 v31, a159
    v_accvgpr_read_b32 v32, a188
    v_accvgpr_read_b32 v33, a189
    v_accvgpr_read_b32 v34, a190
    v_accvgpr_read_b32 v35, a191
    v_cvt_pk_bf16_f32 v36, v28, v29
    v_cvt_pk_bf16_f32 v37, v30, v31
    v_cvt_pk_bf16_f32 v38, v32, v33
    v_cvt_pk_bf16_f32 v39, v34, v35
    s_nop 0
    v_permlane16_swap_b32 v36, v38
    v_permlane16_swap_b32 v37, v39
    buffer_store_dwordx4 v[36:39], v168, s[12:15], s27 offen offset:128
    v_accvgpr_read_b32 v40, a220
    v_accvgpr_read_b32 v41, a221
    v_accvgpr_read_b32 v42, a222
    v_accvgpr_read_b32 v43, a223
    v_accvgpr_read_b32 v44, a252
    v_accvgpr_read_b32 v45, a253
    v_accvgpr_read_b32 v46, a254
    v_accvgpr_read_b32 v47, a255
    v_cvt_pk_bf16_f32 v48, v40, v41
    v_cvt_pk_bf16_f32 v49, v42, v43
    v_cvt_pk_bf16_f32 v50, v44, v45
    v_cvt_pk_bf16_f32 v51, v46, v47
    s_nop 0
    v_permlane16_swap_b32 v48, v50
    v_permlane16_swap_b32 v49, v51
    buffer_store_dwordx4 v[48:51], v168, s[12:15], s27 offen offset:192
gemm1_kernel_end:
    s_endpgm
.globl attn_kernel
.p2align 8
.type attn_kernel,@function
attn_kernel:
    s_cmp_ge_u32 s2, 256
    s_cbranch_scc1 attn_kernel_end
    s_load_dwordx2 s[32:33], s[0:1], 80
    s_load_dwordx2 s[34:35], s[0:1], 8
    s_load_dwordx2 s[36:37], s[0:1], 16
    s_cmp_lg_u32 s2, 0
    s_cbranch_scc1 attn_kernel_noclr
    s_waitcnt lgkmcnt(0)
    s_add_u32 s40, s32, 67108864
    s_addc_u32 s41, s33, 0
    s_and_b32 s41, s41, 65535
    s_mov_b32 s42, 512
    s_mov_b32 s43, 131072
    v_lshlrev_b32 v245, 2, v0
    v_mov_b32 v246, 0
    buffer_store_dword v246, v245, s[40:43], 0 offen
attn_kernel_noclr:
    s_waitcnt vmcnt(0) lgkmcnt(0)
    s_nop 15
    s_nop 7
    s_and_b32 s24, s2, 7
    s_lshr_b32 s25, s2, 3
    s_lshr_b32 s26, s24, 1
    s_and_b32 s27, s24, 1
    s_lshl_b32 s27, s27, 5
    s_add_u32 s27, s27, s25
    s_lshr_b32 s28, s27, 3
    s_lshl_b32 s30, s26, 3
    s_add_u32 s28, s28, s30
    s_and_b32 s29, s27, 7
    s_mul_i32 s30, s29, 2162688
    s_lshl_b32 s31, s28, 8
    s_add_u32 s30, s30, s31
    s_add_u32 s31, s30, 4194304
    s_add_u32 s4, s32, s31
    s_addc_u32 s5, s33, 0
    s_and_b32 s5, s5, 65535
    s_mov_b32 s6, 0
    s_mov_b32 s7, 131072
    s_sub_u32 s6, 17301504, s30
    s_add_u32 s31, s30, 39845888
    s_add_u32 s16, s32, s31
    s_addc_u32 s17, s33, 0
    s_and_b32 s17, s17, 65535
    s_mov_b32 s18, 0
    s_mov_b32 s19, 131072
    s_sub_u32 s18, 17301504, s30
    s_lshl_b32 s31, s26, 19
    s_add_u32 s31, s31, 393216
    s_add_u32 s8, s34, s31
    s_addc_u32 s9, s35, 0
    s_and_b32 s9, s9, 65535
    s_mov_b32 s10, 131072
    s_mov_b32 s11, 131072
    s_add_u32 s12, s36, s31
    s_addc_u32 s13, s37, 0
    s_and_b32 s13, s13, 65535
    s_mov_b32 s14, 131072
    s_mov_b32 s15, 131072
    s_mov_b32 s20, 0x3e0293ee
    v_and_b32 v245, 63, v0
    v_lshrrev_b32 v246, 6, v0
    s_nop 0
    v_readfirstlane_b32 s24, v246
    s_lshl_b32 s21, s24, 11
    v_lshrrev_b32 v247, 4, v245
    v_lshl_add_u32 v247, v246, 3, v247
    v_add_u32 v247, 0, v247
    v_and_b32 v248, 15, v245
    v_and_b32 v249, 15, v247
    v_xor_b32 v249, v249, v248
    v_lshlrev_b32 v249, 4, v249
    v_lshl_add_u32 v240, v247, 8, v249
    v_and_b32 v249, 3, v247
    v_lshlrev_b32 v249, 2, v249
    v_xor_b32 v249, v249, v248
    v_lshlrev_b32 v249, 4, v249
    v_lshl_add_u32 v242, v247, 8, v249
    v_lshrrev_b32 v247, 4, v245
    v_lshl_add_u32 v247, v246, 3, v247
    v_add_u32 v247, 4, v247
    v_and_b32 v248, 15, v245
    v_and_b32 v249, 15, v247
    v_xor_b32 v249, v249, v248
    v_lshlrev_b32 v249, 4, v249
    v_lshl_add_u32 v241, v247, 8, v249
    v_and_b32 v249, 3, v247
    v_lshlrev_b32 v249, 2, v249
    v_xor_b32 v249, v249, v248
    v_lshlrev_b32 v249, 4, v249
    v_lshl_add_u32 v243, v247, 8, v249
    s_mov_b32 s22, 0
    s_add_u32 m0, s21, 0
    s_nop 0
    buffer_load_dwordx4 v240, s[8:11], s22 offen lds
    s_add_u32 m0, s21, 1024
    s_nop 0
    buffer_load_dwordx4 v241, s[8:11], s22 offen lds
    v_and_b32 v247, 31, v245
    v_lshl_add_u32 v247, v246, 5, v247
    v_lshrrev_b32 v248, 5, v245
    v_lshlrev_b32 v248, 4, v248
    s_mov_b32 s31, 8448
    v_mad_u32_u24 v244, v247, s31, v248
    buffer_load_dwordx4 v[4:7], v244, s[4:7], 0 offen
    buffer_load_dwordx4 v[8:11], v244, s[4:7], 0 offen offset:32
    buffer_load_dwordx4 v[12:15], v244, s[4:7], 0 offen offset:64
    buffer_load_dwordx4 v[16:19], v244, s[4:7], 0 offen offset:96
    buffer_load_dwordx4 v[20:23], v244, s[4:7], 0 offen offset:128
    buffer_load_dwordx4 v[24:27], v244, s[4:7], 0 offen offset:160
    buffer_load_dwordx4 v[28:31], v244, s[4:7], 0 offen offset:192
    buffer_load_dwordx4 v[32:35], v244, s[4:7], 0 offen offset:224
    s_mov_b32 s22, 0
    s_add_u32 m0, s21, 32768
    s_nop 0
    buffer_load_dwordx4 v242, s[12:15], s22 offen lds
    s_add_u32 m0, s21, 33792
    s_nop 0
    buffer_load_dwordx4 v243, s[12:15], s22 offen lds
    s_mov_b32 s22, 16384
    s_add_u32 m0, s21, 16384
    s_nop 0
    buffer_load_dwordx4 v240, s[8:11], s22 offen lds
    s_add_u32 m0, s21, 17408
    s_nop 0
    buffer_load_dwordx4 v241, s[8:11], s22 offen lds
    s_mov_b32 s22, 16384
    s_add_u32 m0, s21, 49152
    s_nop 0
    buffer_load_dwordx4 v242, s[12:15], s22 offen lds
    s_add_u32 m0, s21, 50176
    s_nop 0
    buffer_load_dwordx4 v243, s[12:15], s22 offen lds
    s_mov_b32 s22, 32768
    s_add_u32 m0, s21, 65536
    s_nop 0
    buffer_load_dwordx4 v242, s[12:15], s22 offen lds
    s_add_u32 m0, s21, 66560
    s_nop 0
    buffer_load_dwordx4 v243, s[12:15], s22 offen lds
    v_lshrrev_b32 v247, 5, v245
    v_and_b32 v248, 31, v245
    v_and_b32 v249, 15, v245
    v_add_u32 v250, 0, v247
    v_xor_b32 v250, v250, v249
    v_lshlrev_b32 v250, 4, v250
    v_lshl_add_u32 v228, v248, 8, v250
    v_add_u32 v250, 2, v247
    v_xor_b32 v250, v250, v249
    v_lshlrev_b32 v250, 4, v250
    v_lshl_add_u32 v229, v248, 8, v250
    v_add_u32 v250, 4, v247
    v_xor_b32 v250, v250, v249
    v_lshlrev_b32 v250, 4, v250
    v_lshl_add_u32 v230, v248, 8, v250
    v_add_u32 v250, 6, v247
    v_xor_b32 v250, v250, v249
    v_lshlrev_b32 v250, 4, v250
    v_lshl_add_u32 v231, v248, 8, v250
    v_add_u32 v250, 8, v247
    v_xor_b32 v250, v250, v249
    v_lshlrev_b32 v250, 4, v250
    v_lshl_add_u32 v232, v248, 8, v250
    v_add_u32 v250, 10, v247
    v_xor_b32 v250, v250, v249
    v_lshlrev_b32 v250, 4, v250
    v_lshl_add_u32 v233, v248, 8, v250
    v_add_u32 v250, 12, v247
    v_xor_b32 v250, v250, v249
    v_lshlrev_b32 v250, 4, v250
    v_lshl_add_u32 v234, v248, 8, v250
    v_add_u32 v250, 14, v247
    v_xor_b32 v250, v250, v249
    v_lshlrev_b32 v250, 4, v250
    v_lshl_add_u32 v235, v248, 8, v250
    v_bfe_u32 v247, v245, 2, 2
    v_and_b32 v248, 3, v245
    v_bfe_u32 v249, v245, 4, 1
    v_lshrrev_b32 v250, 5, v245
    v_lshl_add_u32 v250, v250, 2, v247
    v_lshlrev_b32 v250, 8, v250
    v_and_b32 v251, 1, v248
    v_lshl_add_u32 v250, v251, 3, v250
    v_lshrrev_b32 v251, 1, v248
    v_lshl_add_u32 v251, v249, 1, v251
    v_lshl_add_u32 v250, v251, 4, v250
    v_add_u32 v250, 32768, v250
    v_xor_b32 v251, 0, v247
    v_lshl_add_u32 v236, v251, 6, v250
    v_xor_b32 v251, 1, v247
    v_lshl_add_u32 v237, v251, 6, v250
    v_xor_b32 v251, 2, v247
    v_lshl_add_u32 v238, v251, 6, v250
    v_xor_b32 v251, 3, v247
    v_lshl_add_u32 v239, v251, 6, v250
    v_mov_b32 v36, 0
    v_mov_b32 v37, 0
    v_mov_b32 v38, 0
    v_mov_b32 v39, 0
    v_mov_b32 v40, 0
    v_mov_b32 v41, 0
    v_mov_b32 v42, 0
    v_mov_b32 v43, 0
    v_mov_b32 v44, 0
    v_mov_b32 v45, 0
    v_mov_b32 v46, 0
    v_mov_b32 v47, 0
    v_mov_b32 v48, 0
    v_mov_b32 v49, 0
    v_mov_b32 v50, 0
    v_mov_b32 v51, 0
    v_mov_b32 v52, 0
    v_mov_b32 v53, 0
    v_mov_b32 v54, 0
    v_mov_b32 v55, 0
    v_mov_b32 v56, 0
    v_mov_b32 v57, 0
    v_mov_b32 v58, 0
    v_mov_b32 v59, 0
    v_mov_b32 v60, 0
    v_mov_b32 v61, 0
    v_mov_b32 v62, 0
    v_mov_b32 v63, 0
    v_mov_b32 v64, 0
    v_mov_b32 v65, 0
    v_mov_b32 v66, 0
    v_mov_b32 v67, 0
    v_mov_b32 v68, 0
    v_mov_b32 v69, 0
    v_mov_b32 v70, 0
    v_mov_b32 v71, 0
    v_mov_b32 v72, 0
    v_mov_b32 v73, 0
    v_mov_b32 v74, 0
    v_mov_b32 v75, 0
    v_mov_b32 v76, 0
    v_mov_b32 v77, 0
    v_mov_b32 v78, 0
    v_mov_b32 v79, 0
    v_mov_b32 v80, 0
    v_mov_b32 v81, 0
    v_mov_b32 v82, 0
    v_mov_b32 v83, 0
    v_mov_b32 v84, 0
    v_mov_b32 v85, 0
    v_mov_b32 v86, 0
    v_mov_b32 v87, 0
    v_mov_b32 v88, 0
    v_mov_b32 v89, 0
    v_mov_b32 v90, 0
    v_mov_b32 v91, 0
    v_mov_b32 v92, 0
    v_mov_b32 v93, 0
    v_mov_b32 v94, 0
    v_mov_b32 v95, 0
    v_mov_b32 v96, 0
    v_mov_b32 v97, 0
    v_mov_b32 v98, 0
    v_mov_b32 v99, 0
    v_mov_b32 v221, 0
    v_mov_b32 v222, 0
    s_waitcnt vmcnt(16)
    s_barrier
    ds_read_b128 v[148:151], v228
    ds_read_b128 v[152:155], v229
    ds_read_b128 v[156:159], v230
    ds_read_b128 v[160:163], v231
    ds_read_b128 v[164:167], v232
    ds_read_b128 v[168:171], v233
    ds_read_b128 v[172:175], v234
    ds_read_b128 v[176:179], v235
    s_waitcnt vmcnt(15) lgkmcnt(7)
    v_mfma_f32_32x32x16_bf16 v[100:115], v[148:151], v[4:7], 0
    s_waitcnt vmcnt(14) lgkmcnt(6)
    v_mfma_f32_32x32x16_bf16 v[100:115], v[152:155], v[8:11], v[100:115]
    s_waitcnt vmcnt(13) lgkmcnt(5)
    v_mfma_f32_32x32x16_bf16 v[100:115], v[156:159], v[12:15], v[100:115]
    s_waitcnt vmcnt(12) lgkmcnt(4)
    v_mfma_f32_32x32x16_bf16 v[100:115], v[160:163], v[16:19], v[100:115]
    s_waitcnt vmcnt(11) lgkmcnt(3)
    v_mfma_f32_32x32x16_bf16 v[100:115], v[164:167], v[20:23], v[100:115]
    s_waitcnt vmcnt(10) lgkmcnt(2)
    v_mfma_f32_32x32x16_bf16 v[100:115], v[168:171], v[24:27], v[100:115]
    s_waitcnt vmcnt(9) lgkmcnt(1)
    v_mfma_f32_32x32x16_bf16 v[100:115], v[172:175], v[28:31], v[100:115]
    s_waitcnt vmcnt(8) lgkmcnt(0)
    v_mfma_f32_32x32x16_bf16 v[100:115], v[176:179], v[32:35], v[100:115]
    ds_read_b128 v[148:151], v228 offset:8192
    ds_read_b128 v[152:155], v229 offset:8192
    ds_read_b128 v[156:159], v230 offset:8192
    ds_read_b128 v[160:163], v231 offset:8192
    ds_read_b128 v[164:167], v232 offset:8192
    ds_read_b128 v[168:171], v233 offset:8192
    ds_read_b128 v[172:175], v234 offset:8192
    ds_read_b128 v[176:179], v235 offset:8192
    s_waitcnt vmcnt(0) lgkmcnt(0)
    s_barrier
    v_mfma_f32_32x32x16_bf16 v[116:131], v[148:151], v[4:7], 0
    s_nop 0
    v_max3_f32 v225, v100, v101, v102
    v_max3_f32 v225, v225, v103, v104
    v_max3_f32 v225, v225, v105, v106
    v_max3_f32 v225, v225, v107, v108
    v_max3_f32 v225, v225, v109, v110
    v_max3_f32 v225, v225, v111, v112
    v_max3_f32 v225, v225, v113, v114
    v_max_f32 v225, v225, v115
    v_mov_b32 v226, v225
    v_mfma_f32_32x32x16_bf16 v[116:131], v[152:155], v[8:11], v[116:131]
    s_nop 0
    v_permlane32_swap_b32 v225, v226
    v_max_f32 v225, v225, v226
    v_mul_f32 v220, s20, v225
    v_fma_f32 v212, v100, s20, -v220
    v_fma_f32 v213, v101, s20, -v220
    v_fma_f32 v214, v102, s20, -v220
    v_fma_f32 v215, v103, s20, -v220
    v_exp_f32 v212, v212
    v_mfma_f32_32x32x16_bf16 v[116:131], v[156:159], v[12:15], v[116:131]
    v_exp_f32 v213, v213
    v_exp_f32 v214, v214
    v_exp_f32 v215, v215
    v_fma_f32 v216, v104, s20, -v220
    v_fma_f32 v217, v105, s20, -v220
    v_fma_f32 v218, v106, s20, -v220
    v_fma_f32 v219, v107, s20, -v220
    v_exp_f32 v216, v216
    v_exp_f32 v217, v217
    v_mfma_f32_32x32x16_bf16 v[116:131], v[160:163], v[16:19], v[116:131]
    v_exp_f32 v218, v218
    v_exp_f32 v219, v219
    v_add_f32 v223, v212, v213
    v_add_f32 v224, v214, v215
    v_cvt_pk_bf16_f32 v132, v212, v213
    v_cvt_pk_bf16_f32 v133, v214, v215
    v_fma_f32 v212, v108, s20, -v220
    v_fma_f32 v213, v109, s20, -v220
    v_mfma_f32_32x32x16_bf16 v[116:131], v[164:167], v[20:23], v[116:131]
    v_fma_f32 v214, v110, s20, -v220
    v_fma_f32 v215, v111, s20, -v220
    v_exp_f32 v212, v212
    v_exp_f32 v213, v213
    v_exp_f32 v214, v214
    v_exp_f32 v215, v215
    v_add_f32 v223, v223, v216
    v_add_f32 v224, v224, v217
    v_mfma_f32_32x32x16_bf16 v[116:131], v[168:171], v[24:27], v[116:131]
    v_add_f32 v223, v223, v218
    v_add_f32 v224, v224, v219
    v_cvt_pk_bf16_f32 v134, v216, v217
    v_cvt_pk_bf16_f32 v135, v218, v219
    v_fma_f32 v216, v112, s20, -v220
    v_fma_f32 v217, v113, s20, -v220
    v_fma_f32 v218, v114, s20, -v220
    v_fma_f32 v219, v115, s20, -v220
    v_exp_f32 v216, v216
    v_mfma_f32_32x32x16_bf16 v[116:131], v[172:175], v[28:31], v[116:131]
    v_exp_f32 v217, v217
    v_exp_f32 v218, v218
    v_exp_f32 v219, v219
    v_add_f32 v223, v223, v212
    v_add_f32 v224, v224, v213
    v_add_f32 v223, v223, v214
    v_add_f32 v224, v224, v215
    v_cvt_pk_bf16_f32 v136, v212, v213
    v_mfma_f32_32x32x16_bf16 v[116:131], v[176:179], v[32:35], v[116:131]
    v_cvt_pk_bf16_f32 v137, v214, v215
    v_add_f32 v223, v223, v216
    v_add_f32 v224, v224, v217
    v_add_f32 v223, v223, v218
    v_add_f32 v224, v224, v219
    v_cvt_pk_bf16_f32 v138, v216, v217
    v_cvt_pk_bf16_f32 v139, v218, v219
    v_add_f32 v226, v223, v224
    ds_read_b128 v[148:151], v228 offset:16384
    ds_read_b128 v[152:155], v229 offset:16384
    ds_read_b128 v[156:159], v230 offset:16384
    ds_read_b128 v[160:163], v231 offset:16384
    ds_read_b128 v[164:167], v232 offset:16384
    ds_read_b128 v[168:171], v233 offset:16384
    ds_read_b128 v[172:175], v234 offset:16384
    ds_read_b128 v[176:179], v235 offset:16384
    s_mov_b32 s22, 32768
    s_add_u32 m0, s21, 0
    s_nop 0
    buffer_load_dwordx4 v240, s[8:11], s22 offen lds
    s_add_u32 m0, s21, 1024
    s_nop 0
    buffer_load_dwordx4 v241, s[8:11], s22 offen lds
    v_add_f32 v221, v221, v223
    v_add_f32 v222, v222, v224
    s_waitcnt lgkmcnt(7)
    v_mfma_f32_32x32x16_bf16 v[100:115], v[148:151], v[4:7], 0
    v_fma_f32 v212, v116, s20, -v220
    v_fma_f32 v213, v117, s20, -v220
    v_fma_f32 v214, v118, s20, -v220
    v_fma_f32 v215, v119, s20, -v220
    ds_read_b64_tr_b16 v[180:181], v236
    ds_read_b64_tr_b16 v[182:183], v236 offset:2048
    s_waitcnt lgkmcnt(8)
    v_mfma_f32_32x32x16_bf16 v[100:115], v[152:155], v[8:11], v[100:115]
    v_exp_f32 v212, v212
    v_exp_f32 v213, v213
    v_exp_f32 v214, v214
    ds_read_b64_tr_b16 v[184:185], v236 offset:4096
    ds_read_b64_tr_b16 v[186:187], v236 offset:6144
    s_waitcnt lgkmcnt(9)
    v_mfma_f32_32x32x16_bf16 v[100:115], v[156:159], v[12:15], v[100:115]
    v_exp_f32 v215, v215
    v_fma_f32 v216, v120, s20, -v220
    v_fma_f32 v217, v121, s20, -v220
    v_fma_f32 v218, v122, s20, -v220
    ds_read_b64_tr_b16 v[188:189], v237
    ds_read_b64_tr_b16 v[190:191], v237 offset:2048
    s_waitcnt lgkmcnt(10)
    v_mfma_f32_32x32x16_bf16 v[100:115], v[160:163], v[16:19], v[100:115]
    v_fma_f32 v219, v123, s20, -v220
    v_exp_f32 v216, v216
    v_exp_f32 v217, v217
    ds_read_b64_tr_b16 v[192:193], v237 offset:4096
    ds_read_b64_tr_b16 v[194:195], v237 offset:6144
    s_waitcnt lgkmcnt(11)
    v_mfma_f32_32x32x16_bf16 v[100:115], v[164:167], v[20:23], v[100:115]
    v_exp_f32 v218, v218
    v_exp_f32 v219, v219
    v_add_f32 v223, v212, v213
    v_add_f32 v224, v214, v215
    ds_read_b64_tr_b16 v[196:197], v238
    ds_read_b64_tr_b16 v[198:199], v238 offset:2048
    s_waitcnt lgkmcnt(12)
    v_mfma_f32_32x32x16_bf16 v[100:115], v[168:171], v[24:27], v[100:115]
    v_cvt_pk_bf16_f32 v140, v212, v213
    v_cvt_pk_bf16_f32 v141, v214, v215
    v_fma_f32 v212, v124, s20, -v220
    ds_read_b64_tr_b16 v[200:201], v238 offset:4096
    ds_read_b64_tr_b16 v[202:203], v238 offset:6144
    s_waitcnt lgkmcnt(13)
    v_mfma_f32_32x32x16_bf16 v[100:115], v[172:175], v[28:31], v[100:115]
    v_fma_f32 v213, v125, s20, -v220
    v_fma_f32 v214, v126, s20, -v220
    v_fma_f32 v215, v127, s20, -v220
    v_exp_f32 v212, v212
    ds_read_b64_tr_b16 v[204:205], v239
    ds_read_b64_tr_b16 v[206:207], v239 offset:2048
    s_waitcnt lgkmcnt(14)
    v_mfma_f32_32x32x16_bf16 v[100:115], v[176:179], v[32:35], v[100:115]
    v_exp_f32 v213, v213
    v_exp_f32 v214, v214
    v_exp_f32 v215, v215
    ds_read_b64_tr_b16 v[208:209], v239 offset:4096
    ds_read_b64_tr_b16 v[210:211], v239 offset:6144
    s_waitcnt lgkmcnt(14)
    v_mfma_f32_32x32x16_bf16 v[36:51], v[180:183], v[132:135], v[36:51]
    v_add_f32 v223, v223, v216
    v_add_f32 v224, v224, v217
    v_add_f32 v223, v223, v218
    v_add_f32 v224, v224, v219
    ds_read_b128 v[148:151], v228 offset:24576
    s_waitcnt lgkmcnt(11)
    v_mfma_f32_32x32x16_bf16 v[52:67], v[188:191], v[132:135], v[52:67]
    v_cvt_pk_bf16_f32 v142, v216, v217
    v_cvt_pk_bf16_f32 v143, v218, v219
    v_fma_f32 v216, v128, s20, -v220
    ds_read_b128 v[152:155], v229 offset:24576
    s_waitcnt lgkmcnt(8)
    v_mfma_f32_32x32x16_bf16 v[68:83], v[196:199], v[132:135], v[68:83]
    v_fma_f32 v217, v129, s20, -v220
    v_fma_f32 v218, v130, s20, -v220
    v_fma_f32 v219, v131, s20, -v220
    v_exp_f32 v216, v216
    ds_read_b128 v[156:159], v230 offset:24576
    s_waitcnt lgkmcnt(5)
    v_mfma_f32_32x32x16_bf16 v[84:99], v[204:207], v[132:135], v[84:99]
    v_exp_f32 v217, v217
    v_exp_f32 v218, v218
    v_exp_f32 v219, v219
    ds_read_b128 v[160:163], v231 offset:24576
    v_mfma_f32_32x32x16_bf16 v[36:51], v[184:187], v[136:139], v[36:51]
    v_add_f32 v223, v223, v212
    v_add_f32 v224, v224, v213
    v_add_f32 v223, v223, v214
    v_add_f32 v224, v224, v215
    ds_read_b128 v[164:167], v232 offset:24576
    v_mfma_f32_32x32x16_bf16 v[52:67], v[192:195], v[136:139], v[52:67]
    v_cvt_pk_bf16_f32 v144, v212, v213
    v_cvt_pk_bf16_f32 v145, v214, v215
    v_add_f32 v223, v223, v216
    ds_read_b128 v[168:171], v233 offset:24576
    v_mfma_f32_32x32x16_bf16 v[68:83], v[200:203], v[136:139], v[68:83]
    v_add_f32 v224, v224, v217
    v_add_f32 v223, v223, v218
    v_add_f32 v224, v224, v219
    v_cvt_pk_bf16_f32 v146, v216, v217
    ds_read_b128 v[172:175], v234 offset:24576
    s_waitcnt lgkmcnt(7)
    v_mfma_f32_32x32x16_bf16 v[84:99], v[208:211], v[136:139], v[84:99]
    v_cvt_pk_bf16_f32 v147, v218, v219
    v_add_f32 v226, v223, v224
    v_cmp_lt_f32 vcc, 256.0, v226
    ds_read_b128 v[176:179], v235 offset:24576
    s_cbranch_vccnz attn_fix_1
attn_ret_1:
    v_add_f32 v221, v221, v223
    v_add_f32 v222, v222, v224
    s_waitcnt vmcnt(0) lgkmcnt(0)
    s_barrier
    v_mfma_f32_32x32x16_bf16 v[116:131], v[148:151], v[4:7], 0
    v_fma_f32 v212, v100, s20, -v220
    v_fma_f32 v213, v101, s20, -v220
    v_fma_f32 v214, v102, s20, -v220
    v_fma_f32 v215, v103, s20, -v220
    ds_read_b64_tr_b16 v[180:181], v236 offset:8192
    ds_read_b64_tr_b16 v[182:183], v236 offset:10240
    v_mfma_f32_32x32x16_bf16 v[116:131], v[152:155], v[8:11], v[116:131]
    v_exp_f32 v212, v212
    v_exp_f32 v213, v213
    v_exp_f32 v214, v214
    ds_read_b64_tr_b16 v[184:185], v236 offset:12288
    ds_read_b64_tr_b16 v[186:187], v236 offset:14336
    v_mfma_f32_32x32x16_bf16 v[116:131], v[156:159], v[12:15], v[116:131]
    v_exp_f32 v215, v215
    v_fma_f32 v216, v104, s20, -v220
    v_fma_f32 v217, v105, s20, -v220
    v_fma_f32 v218, v106, s20, -v220
    ds_read_b64_tr_b16 v[188:189], v237 offset:8192
    ds_read_b64_tr_b16 v[190:191], v237 offset:10240
    v_mfma_f32_32x32x16_bf16 v[116:131], v[160:163], v[16:19], v[116:131]
    v_fma_f32 v219, v107, s20, -v220
    v_exp_f32 v216, v216
    v_exp_f32 v217, v217
    ds_read_b64_tr_b16 v[192:193], v237 offset:12288
    ds_read_b64_tr_b16 v[194:195], v237 offset:14336
    v_mfma_f32_32x32x16_bf16 v[116:131], v[164:167], v[20:23], v[116:131]
    v_exp_f32 v218, v218
    v_exp_f32 v219, v219
    v_add_f32 v223, v212, v213
    v_add_f32 v224, v214, v215
    ds_read_b64_tr_b16 v[196:197], v238 offset:8192
    ds_read_b64_tr_b16 v[198:199], v238 offset:10240
    v_mfma_f32_32x32x16_bf16 v[116:131], v[168:171], v[24:27], v[116:131]
    v_cvt_pk_bf16_f32 v132, v212, v213
    v_cvt_pk_bf16_f32 v133, v214, v215
    v_fma_f32 v212, v108, s20, -v220
    ds_read_b64_tr_b16 v[200:201], v238 offset:12288
    ds_read_b64_tr_b16 v[202:203], v238 offset:14336
    v_mfma_f32_32x32x16_bf16 v[116:131], v[172:175], v[28:31], v[116:131]
    v_fma_f32 v213, v109, s20, -v220
    v_fma_f32 v214, v110, s20, -v220
    v_fma_f32 v215, v111, s20, -v220
    v_exp_f32 v212, v212
    ds_read_b64_tr_b16 v[204:205], v239 offset:8192
    ds_read_b64_tr_b16 v[206:207], v239 offset:10240
    v_mfma_f32_32x32x16_bf16 v[116:131], v[176:179], v[32:35], v[116:131]
    v_exp_f32 v213, v213
    v_exp_f32 v214, v214
    v_exp_f32 v215, v215
    ds_read_b64_tr_b16 v[208:209], v239 offset:12288
    ds_read_b64_tr_b16 v[210:211], v239 offset:14336
    s_waitcnt lgkmcnt(14)
    v_mfma_f32_32x32x16_bf16 v[36:51], v[180:183], v[140:143], v[36:51]
    v_add_f32 v223, v223, v216
    v_add_f32 v224, v224, v217
    v_add_f32 v223, v223, v218
    v_add_f32 v224, v224, v219
    ds_read_b128 v[148:151], v228
    s_mov_b32 s22, 49152
    s_waitcnt lgkmcnt(11)
    v_mfma_f32_32x32x16_bf16 v[52:67], v[188:191], v[140:143], v[52:67]
    v_cvt_pk_bf16_f32 v134, v216, v217
    v_cvt_pk_bf16_f32 v135, v218, v219
    v_fma_f32 v216, v112, s20, -v220
    ds_read_b128 v[152:155], v229
    s_add_u32 m0, s21, 16384
    s_waitcnt lgkmcnt(8)
    v_mfma_f32_32x32x16_bf16 v[68:83], v[196:199], v[140:143], v[68:83]
    v_fma_f32 v217, v113, s20, -v220
    v_fma_f32 v218, v114, s20, -v220
    v_fma_f32 v219, v115, s20, -v220
    v_exp_f32 v216, v216
    ds_read_b128 v[156:159], v230
    s_waitcnt lgkmcnt(5)
    v_mfma_f32_32x32x16_bf16 v[84:99], v[204:207], v[140:143], v[84:99]
    v_exp_f32 v217, v217
    v_exp_f32 v218, v218
    v_exp_f32 v219, v219
    ds_read_b128 v[160:163], v231
    buffer_load_dwordx4 v240, s[8:11], s22 offen lds
    v_mfma_f32_32x32x16_bf16 v[36:51], v[184:187], v[144:147], v[36:51]
    v_add_f32 v223, v223, v212
    v_add_f32 v224, v224, v213
    v_add_f32 v223, v223, v214
    v_add_f32 v224, v224, v215
    ds_read_b128 v[164:167], v232
    s_add_u32 m0, s21, 17408
    v_mfma_f32_32x32x16_bf16 v[52:67], v[192:195], v[144:147], v[52:67]
    v_cvt_pk_bf16_f32 v136, v212, v213
    v_cvt_pk_bf16_f32 v137, v214, v215
    v_add_f32 v223, v223, v216
    ds_read_b128 v[168:171], v233
    v_mfma_f32_32x32x16_bf16 v[68:83], v[200:203], v[144:147], v[68:83]
    v_add_f32 v224, v224, v217
    v_add_f32 v223, v223, v218
    v_add_f32 v224, v224, v219
    v_cvt_pk_bf16_f32 v138, v216, v217
    ds_read_b128 v[172:175], v234
    buffer_load_dwordx4 v241, s[8:11], s22 offen lds
    s_waitcnt lgkmcnt(7)
    v_mfma_f32_32x32x16_bf16 v[84:99], v[208:211], v[144:147], v[84:99]
    v_cvt_pk_bf16_f32 v139, v218, v219
    v_add_f32 v226, v223, v224
    v_cmp_lt_f32 vcc, 256.0, v226
    ds_read_b128 v[176:179], v235
    s_cbranch_vccnz attn_fix_2
attn_ret_2:
    v_add_f32 v221, v221, v223
    v_add_f32 v222, v222, v224
    s_waitcnt lgkmcnt(7)
    v_mfma_f32_32x32x16_bf16 v[100:115], v[148:151], v[4:7], 0
    v_fma_f32 v212, v116, s20, -v220
    v_fma_f32 v213, v117, s20, -v220
    v_fma_f32 v214, v118, s20, -v220
    v_fma_f32 v215, v119, s20, -v220
    ds_read_b64_tr_b16 v[180:181], v236 offset:16384
    ds_read_b64_tr_b16 v[182:183], v236 offset:18432
    s_waitcnt lgkmcnt(8)
    v_mfma_f32_32x32x16_bf16 v[100:115], v[152:155], v[8:11], v[100:115]
    v_exp_f32 v212, v212
    v_exp_f32 v213, v213
    v_exp_f32 v214, v214
    ds_read_b64_tr_b16 v[184:185], v236 offset:20480
    ds_read_b64_tr_b16 v[186:187], v236 offset:22528
    s_waitcnt lgkmcnt(9)
    v_mfma_f32_32x32x16_bf16 v[100:115], v[156:159], v[12:15], v[100:115]
    v_exp_f32 v215, v215
    v_fma_f32 v216, v120, s20, -v220
    v_fma_f32 v217, v121, s20, -v220
    v_fma_f32 v218, v122, s20, -v220
    ds_read_b64_tr_b16 v[188:189], v237 offset:16384
    ds_read_b64_tr_b16 v[190:191], v237 offset:18432
    s_waitcnt lgkmcnt(10)
    v_mfma_f32_32x32x16_bf16 v[100:115], v[160:163], v[16:19], v[100:115]
    v_fma_f32 v219, v123, s20, -v220
    v_exp_f32 v216, v216
    v_exp_f32 v217, v217
    ds_read_b64_tr_b16 v[192:193], v237 offset:20480
    ds_read_b64_tr_b16 v[194:195], v237 offset:22528
    s_waitcnt lgkmcnt(11)
    v_mfma_f32_32x32x16_bf16 v[100:115], v[164:167], v[20:23], v[100:115]
    v_exp_f32 v218, v218
    v_exp_f32 v219, v219
    v_add_f32 v223, v212, v213
    v_add_f32 v224, v214, v215
    ds_read_b64_tr_b16 v[196:197], v238 offset:16384
    ds_read_b64_tr_b16 v[198:199], v238 offset:18432
    s_waitcnt lgkmcnt(12)
    v_mfma_f32_32x32x16_bf16 v[100:115], v[168:171], v[24:27], v[100:115]
    v_cvt_pk_bf16_f32 v140, v212, v213
    v_cvt_pk_bf16_f32 v141, v214, v215
    v_fma_f32 v212, v124, s20, -v220
    ds_read_b64_tr_b16 v[200:201], v238 offset:20480
    ds_read_b64_tr_b16 v[202:203], v238 offset:22528
    s_waitcnt lgkmcnt(13)
    v_mfma_f32_32x32x16_bf16 v[100:115], v[172:175], v[28:31], v[100:115]
    v_fma_f32 v213, v125, s20, -v220
    v_fma_f32 v214, v126, s20, -v220
    v_fma_f32 v215, v127, s20, -v220
    v_exp_f32 v212, v212
    ds_read_b64_tr_b16 v[204:205], v239 offset:16384
    ds_read_b64_tr_b16 v[206:207], v239 offset:18432
    s_waitcnt lgkmcnt(14)
    v_mfma_f32_32x32x16_bf16 v[100:115], v[176:179], v[32:35], v[100:115]
    v_exp_f32 v213, v213
    v_exp_f32 v214, v214
    v_exp_f32 v215, v215
    ds_read_b64_tr_b16 v[208:209], v239 offset:20480
    ds_read_b64_tr_b16 v[210:211], v239 offset:22528
    s_waitcnt lgkmcnt(14)
    v_mfma_f32_32x32x16_bf16 v[36:51], v[180:183], v[132:135], v[36:51]
    v_add_f32 v223, v223, v216
    v_add_f32 v224, v224, v217
    v_add_f32 v223, v223, v218
    v_add_f32 v224, v224, v219
    ds_read_b128 v[148:151], v228 offset:8192
    s_waitcnt lgkmcnt(11)
    v_mfma_f32_32x32x16_bf16 v[52:67], v[188:191], v[132:135], v[52:67]
    v_cvt_pk_bf16_f32 v142, v216, v217
    v_cvt_pk_bf16_f32 v143, v218, v219
    v_fma_f32 v216, v128, s20, -v220
    ds_read_b128 v[152:155], v229 offset:8192
    s_waitcnt lgkmcnt(8)
    v_mfma_f32_32x32x16_bf16 v[68:83], v[196:199], v[132:135], v[68:83]
    v_fma_f32 v217, v129, s20, -v220
    v_fma_f32 v218, v130, s20, -v220
    v_fma_f32 v219, v131, s20, -v220
    v_exp_f32 v216, v216
    ds_read_b128 v[156:159], v230 offset:8192
    s_waitcnt lgkmcnt(5)
    v_mfma_f32_32x32x16_bf16 v[84:99], v[204:207], v[132:135], v[84:99]
    v_exp_f32 v217, v217
    v_exp_f32 v218, v218
    v_exp_f32 v219, v219
    ds_read_b128 v[160:163], v231 offset:8192
    v_mfma_f32_32x32x16_bf16 v[36:51], v[184:187], v[136:139], v[36:51]
    v_add_f32 v223, v223, v212
    v_add_f32 v224, v224, v213
    v_add_f32 v223, v223, v214
    v_add_f32 v224, v224, v215
    ds_read_b128 v[164:167], v232 offset:8192
    v_mfma_f32_32x32x16_bf16 v[52:67], v[192:195], v[136:139], v[52:67]
    v_cvt_pk_bf16_f32 v144, v212, v213
    v_cvt_pk_bf16_f32 v145, v214, v215
    v_add_f32 v223, v223, v216
    ds_read_b128 v[168:171], v233 offset:8192
    v_mfma_f32_32x32x16_bf16 v[68:83], v[200:203], v[136:139], v[68:83]
    v_add_f32 v224, v224, v217
    v_add_f32 v223, v223, v218
    v_add_f32 v224, v224, v219
    v_cvt_pk_bf16_f32 v146, v216, v217
    ds_read_b128 v[172:175], v234 offset:8192
    s_waitcnt lgkmcnt(7)
    v_mfma_f32_32x32x16_bf16 v[84:99], v[208:211], v[136:139], v[84:99]
    v_cvt_pk_bf16_f32 v147, v218, v219
    v_add_f32 v226, v223, v224
    v_cmp_lt_f32 vcc, 256.0, v226
    ds_read_b128 v[176:179], v235 offset:8192
    s_cbranch_vccnz attn_fix_3
attn_ret_3:
    v_add_f32 v221, v221, v223
    v_add_f32 v222, v222, v224
    s_waitcnt vmcnt(0) lgkmcnt(0)
    s_barrier
    v_mfma_f32_32x32x16_bf16 v[116:131], v[148:151], v[4:7], 0
    v_fma_f32 v212, v100, s20, -v220
    v_fma_f32 v213, v101, s20, -v220
    v_fma_f32 v214, v102, s20, -v220
    v_fma_f32 v215, v103, s20, -v220
    ds_read_b64_tr_b16 v[180:181], v236 offset:24576
    ds_read_b64_tr_b16 v[182:183], v236 offset:26624
    v_mfma_f32_32x32x16_bf16 v[116:131], v[152:155], v[8:11], v[116:131]
    v_exp_f32 v212, v212
    v_exp_f32 v213, v213
    v_exp_f32 v214, v214
    ds_read_b64_tr_b16 v[184:185], v236 offset:28672
    ds_read_b64_tr_b16 v[186:187], v236 offset:30720
    v_mfma_f32_32x32x16_bf16 v[116:131], v[156:159], v[12:15], v[116:131]
    v_exp_f32 v215, v215
    v_fma_f32 v216, v104, s20, -v220
    v_fma_f32 v217, v105, s20, -v220
    v_fma_f32 v218, v106, s20, -v220
    ds_read_b64_tr_b16 v[188:189], v237 offset:24576
    ds_read_b64_tr_b16 v[190:191], v237 offset:26624
    v_mfma_f32_32x32x16_bf16 v[116:131], v[160:163], v[16:19], v[116:131]
    v_fma_f32 v219, v107, s20, -v220
    v_exp_f32 v216, v216
    v_exp_f32 v217, v217
    ds_read_b64_tr_b16 v[192:193], v237 offset:28672
    ds_read_b64_tr_b16 v[194:195], v237 offset:30720
    v_mfma_f32_32x32x16_bf16 v[116:131], v[164:167], v[20:23], v[116:131]
    v_exp_f32 v218, v218
    v_exp_f32 v219, v219
    v_add_f32 v223, v212, v213
    v_add_f32 v224, v214, v215
    ds_read_b64_tr_b16 v[196:197], v238 offset:24576
    ds_read_b64_tr_b16 v[198:199], v238 offset:26624
    v_mfma_f32_32x32x16_bf16 v[116:131], v[168:171], v[24:27], v[116:131]
    v_cvt_pk_bf16_f32 v132, v212, v213
    v_cvt_pk_bf16_f32 v133, v214, v215
    v_fma_f32 v212, v108, s20, -v220
    ds_read_b64_tr_b16 v[200:201], v238 offset:28672
    ds_read_b64_tr_b16 v[202:203], v238 offset:30720
    v_mfma_f32_32x32x16_bf16 v[116:131], v[172:175], v[28:31], v[116:131]
    v_fma_f32 v213, v109, s20, -v220
    v_fma_f32 v214, v110, s20, -v220
    v_fma_f32 v215, v111, s20, -v220
    v_exp_f32 v212, v212
    ds_read_b64_tr_b16 v[204:205], v239 offset:24576
    ds_read_b64_tr_b16 v[206:207], v239 offset:26624
    v_mfma_f32_32x32x16_bf16 v[116:131], v[176:179], v[32:35], v[116:131]
    v_exp_f32 v213, v213
    v_exp_f32 v214, v214
    v_exp_f32 v215, v215
    ds_read_b64_tr_b16 v[208:209], v239 offset:28672
    ds_read_b64_tr_b16 v[210:211], v239 offset:30720
    s_waitcnt lgkmcnt(14)
    v_mfma_f32_32x32x16_bf16 v[36:51], v[180:183], v[140:143], v[36:51]
    v_add_f32 v223, v223, v216
    v_add_f32 v224, v224, v217
    v_add_f32 v223, v223, v218
    v_add_f32 v224, v224, v219
    ds_read_b128 v[148:151], v228 offset:16384
    s_mov_b32 s22, 65536
    s_add_u32 m0, s21, 0
    s_waitcnt lgkmcnt(11)
    v_mfma_f32_32x32x16_bf16 v[52:67], v[188:191], v[140:143], v[52:67]
    v_cvt_pk_bf16_f32 v134, v216, v217
    v_cvt_pk_bf16_f32 v135, v218, v219
    v_fma_f32 v216, v112, s20, -v220
    ds_read_b128 v[152:155], v229 offset:16384
    buffer_load_dwordx4 v240, s[8:11], s22 offen lds
    s_waitcnt lgkmcnt(8)
    v_mfma_f32_32x32x16_bf16 v[68:83], v[196:199], v[140:143], v[68:83]
    v_fma_f32 v217, v113, s20, -v220
    v_fma_f32 v218, v114, s20, -v220
    v_fma_f32 v219, v115, s20, -v220
    v_exp_f32 v216, v216
    ds_read_b128 v[156:159], v230 offset:16384
    s_add_u32 m0, s21, 1024
    s_waitcnt lgkmcnt(5)
    v_mfma_f32_32x32x16_bf16 v[84:99], v[204:207], v[140:143], v[84:99]
    v_exp_f32 v217, v217
    v_exp_f32 v218, v218
    v_exp_f32 v219, v219
    ds_read_b128 v[160:163], v231 offset:16384
    buffer_load_dwordx4 v241, s[8:11], s22 offen lds
    v_mfma_f32_32x32x16_bf16 v[36:51], v[184:187], v[144:147], v[36:51]
    v_add_f32 v223, v223, v212
    v_add_f32 v224, v224, v213
    v_add_f32 v223, v223, v214
    v_add_f32 v224, v224, v215
    ds_read_b128 v[164:167], v232 offset:16384
    s_mov_b32 s22, 49152
    s_add_u32 m0, s21, 32768
    v_mfma_f32_32x32x16_bf16 v[52:67], v[192:195], v[144:147], v[52:67]
    v_cvt_pk_bf16_f32 v136, v212, v213
    v_cvt_pk_bf16_f32 v137, v214, v215
    v_add_f32 v223, v223, v216
    ds_read_b128 v[168:171], v233 offset:16384
    buffer_load_dwordx4 v242, s[12:15], s22 offen lds
    v_mfma_f32_32x32x16_bf16 v[68:83], v[200:203], v[144:147], v[68:83]
    v_add_f32 v224, v224, v217
    v_add_f32 v223, v223, v218
    v_add_f32 v224, v224, v219
    v_cvt_pk_bf16_f32 v138, v216, v217
    ds_read_b128 v[172:175], v234 offset:16384
    s_add_u32 m0, s21, 33792
    s_waitcnt lgkmcnt(7)
    v_mfma_f32_32x32x16_bf16 v[84:99], v[208:211], v[144:147], v[84:99]
    v_cvt_pk_bf16_f32 v139, v218, v219
    v_add_f32 v226, v223, v224
    v_cmp_lt_f32 vcc, 256.0, v226
    ds_read_b128 v[176:179], v235 offset:16384
    buffer_load_dwordx4 v243, s[12:15], s22 offen lds
    s_cbranch_vccnz attn_fix_4
attn_ret_4:
    v_add_f32 v221, v221, v223
    v_add_f32 v222, v222, v224
    s_waitcnt lgkmcnt(7)
    v_mfma_f32_32x32x16_bf16 v[100:115], v[148:151], v[4:7], 0
    v_fma_f32 v212, v116, s20, -v220
    v_fma_f32 v213, v117, s20, -v220
    v_fma_f32 v214, v118, s20, -v220
    v_fma_f32 v215, v119, s20, -v220
    ds_read_b64_tr_b16 v[180:181], v236 offset:32768
    ds_read_b64_tr_b16 v[182:183], v236 offset:34816
    s_waitcnt lgkmcnt(8)
    v_mfma_f32_32x32x16_bf16 v[100:115], v[152:155], v[8:11], v[100:115]
    v_exp_f32 v212, v212
    v_exp_f32 v213, v213
    v_exp_f32 v214, v214
    ds_read_b64_tr_b16 v[184:185], v236 offset:36864
    ds_read_b64_tr_b16 v[186:187], v236 offset:38912
    s_waitcnt lgkmcnt(9)
    v_mfma_f32_32x32x16_bf16 v[100:115], v[156:159], v[12:15], v[100:115]
    v_exp_f32 v215, v215
    v_fma_f32 v216, v120, s20, -v220
    v_fma_f32 v217, v121, s20, -v220
    v_fma_f32 v218, v122, s20, -v220
    ds_read_b64_tr_b16 v[188:189], v237 offset:32768
    ds_read_b64_tr_b16 v[190:191], v237 offset:34816
    s_waitcnt lgkmcnt(10)
    v_mfma_f32_32x32x16_bf16 v[100:115], v[160:163], v[16:19], v[100:115]
    v_fma_f32 v219, v123, s20, -v220
    v_exp_f32 v216, v216
    v_exp_f32 v217, v217
    ds_read_b64_tr_b16 v[192:193], v237 offset:36864
    ds_read_b64_tr_b16 v[194:195], v237 offset:38912
    s_waitcnt lgkmcnt(11)
    v_mfma_f32_32x32x16_bf16 v[100:115], v[164:167], v[20:23], v[100:115]
    v_exp_f32 v218, v218
    v_exp_f32 v219, v219
    v_add_f32 v223, v212, v213
    v_add_f32 v224, v214, v215
    ds_read_b64_tr_b16 v[196:197], v238 offset:32768
    ds_read_b64_tr_b16 v[198:199], v238 offset:34816
    s_waitcnt lgkmcnt(12)
    v_mfma_f32_32x32x16_bf16 v[100:115], v[168:171], v[24:27], v[100:115]
    v_cvt_pk_bf16_f32 v140, v212, v213
    v_cvt_pk_bf16_f32 v141, v214, v215
    v_fma_f32 v212, v124, s20, -v220
    ds_read_b64_tr_b16 v[200:201], v238 offset:36864
    ds_read_b64_tr_b16 v[202:203], v238 offset:38912
    s_waitcnt lgkmcnt(13)
    v_mfma_f32_32x32x16_bf16 v[100:115], v[172:175], v[28:31], v[100:115]
    v_fma_f32 v213, v125, s20, -v220
    v_fma_f32 v214, v126, s20, -v220
    v_fma_f32 v215, v127, s20, -v220
    v_exp_f32 v212, v212
    ds_read_b64_tr_b16 v[204:205], v239 offset:32768
    ds_read_b64_tr_b16 v[206:207], v239 offset:34816
    s_waitcnt lgkmcnt(14)
    v_mfma_f32_32x32x16_bf16 v[100:115], v[176:179], v[32:35], v[100:115]
    v_exp_f32 v213, v213
    v_exp_f32 v214, v214
    v_exp_f32 v215, v215
    ds_read_b64_tr_b16 v[208:209], v239 offset:36864
    ds_read_b64_tr_b16 v[210:211], v239 offset:38912
    s_waitcnt lgkmcnt(14)
    v_mfma_f32_32x32x16_bf16 v[36:51], v[180:183], v[132:135], v[36:51]
    v_add_f32 v223, v223, v216
    v_add_f32 v224, v224, v217
    v_add_f32 v223, v223, v218
    v_add_f32 v224, v224, v219
    ds_read_b128 v[148:151], v228 offset:24576
    s_waitcnt lgkmcnt(11)
    v_mfma_f32_32x32x16_bf16 v[52:67], v[188:191], v[132:135], v[52:67]
    v_cvt_pk_bf16_f32 v142, v216, v217
    v_cvt_pk_bf16_f32 v143, v218, v219
    v_fma_f32 v216, v128, s20, -v220
    ds_read_b128 v[152:155], v229 offset:24576
    s_waitcnt lgkmcnt(8)
    v_mfma_f32_32x32x16_bf16 v[68:83], v[196:199], v[132:135], v[68:83]
    v_fma_f32 v217, v129, s20, -v220
    v_fma_f32 v218, v130, s20, -v220
    v_fma_f32 v219, v131, s20, -v220
    v_exp_f32 v216, v216
    ds_read_b128 v[156:159], v230 offset:24576
    s_waitcnt lgkmcnt(5)
    v_mfma_f32_32x32x16_bf16 v[84:99], v[204:207], v[132:135], v[84:99]
    v_exp_f32 v217, v217
    v_exp_f32 v218, v218
    v_exp_f32 v219, v219
    ds_read_b128 v[160:163], v231 offset:24576
    v_mfma_f32_32x32x16_bf16 v[36:51], v[184:187], v[136:139], v[36:51]
    v_add_f32 v223, v223, v212
    v_add_f32 v224, v224, v213
    v_add_f32 v223, v223, v214
    v_add_f32 v224, v224, v215
    ds_read_b128 v[164:167], v232 offset:24576
    v_mfma_f32_32x32x16_bf16 v[52:67], v[192:195], v[136:139], v[52:67]
    v_cvt_pk_bf16_f32 v144, v212, v213
    v_cvt_pk_bf16_f32 v145, v214, v215
    v_add_f32 v223, v223, v216
    ds_read_b128 v[168:171], v233 offset:24576
    v_mfma_f32_32x32x16_bf16 v[68:83], v[200:203], v[136:139], v[68:83]
    v_add_f32 v224, v224, v217
    v_add_f32 v223, v223, v218
    v_add_f32 v224, v224, v219
    v_cvt_pk_bf16_f32 v146, v216, v217
    ds_read_b128 v[172:175], v234 offset:24576
    s_waitcnt lgkmcnt(7)
    v_mfma_f32_32x32x16_bf16 v[84:99], v[208:211], v[136:139], v[84:99]
    v_cvt_pk_bf16_f32 v147, v218, v219
    v_add_f32 v226, v223, v224
    v_cmp_lt_f32 vcc, 256.0, v226
    ds_read_b128 v[176:179], v235 offset:24576
    s_cbranch_vccnz attn_fix_5
attn_ret_5:
    v_add_f32 v221, v221, v223
    v_add_f32 v222, v222, v224
    s_waitcnt vmcnt(0) lgkmcnt(0)
    s_barrier
    v_mfma_f32_32x32x16_bf16 v[116:131], v[148:151], v[4:7], 0
    v_fma_f32 v212, v100, s20, -v220
    v_fma_f32 v213, v101, s20, -v220
    v_fma_f32 v214, v102, s20, -v220
    v_fma_f32 v215, v103, s20, -v220
    ds_read_b64_tr_b16 v[180:181], v236 offset:40960
    ds_read_b64_tr_b16 v[182:183], v236 offset:43008
    v_mfma_f32_32x32x16_bf16 v[116:131], v[152:155], v[8:11], v[116:131]
    v_exp_f32 v212, v212
    v_exp_f32 v213, v213
    v_exp_f32 v214, v214
    ds_read_b64_tr_b16 v[184:185], v236 offset:45056
    ds_read_b64_tr_b16 v[186:187], v236 offset:47104
    v_mfma_f32_32x32x16_bf16 v[116:131], v[156:159], v[12:15], v[116:131]
    v_exp_f32 v215, v215
    v_fma_f32 v216, v104, s20, -v220
    v_fma_f32 v217, v105, s20, -v220
    v_fma_f32 v218, v106, s20, -v220
    ds_read_b64_tr_b16 v[188:189], v237 offset:40960
    ds_read_b64_tr_b16 v[190:191], v237 offset:43008
    v_mfma_f32_32x32x16_bf16 v[116:131], v[160:163], v[16:19], v[116:131]
    v_fma_f32 v219, v107, s20, -v220
    v_exp_f32 v216, v216
    v_exp_f32 v217, v217
    ds_read_b64_tr_b16 v[192:193], v237 offset:45056
    ds_read_b64_tr_b16 v[194:195], v237 offset:47104
    v_mfma_f32_32x32x16_bf16 v[116:131], v[164:167], v[20:23], v[116:131]
    v_exp_f32 v218, v218
    v_exp_f32 v219, v219
    v_add_f32 v223, v212, v213
    v_add_f32 v224, v214, v215
    ds_read_b64_tr_b16 v[196:197], v238 offset:40960
    ds_read_b64_tr_b16 v[198:199], v238 offset:43008
    v_mfma_f32_32x32x16_bf16 v[116:131], v[168:171], v[24:27], v[116:131]
    v_cvt_pk_bf16_f32 v132, v212, v213
    v_cvt_pk_bf16_f32 v133, v214, v215
    v_fma_f32 v212, v108, s20, -v220
    ds_read_b64_tr_b16 v[200:201], v238 offset:45056
    ds_read_b64_tr_b16 v[202:203], v238 offset:47104
    v_mfma_f32_32x32x16_bf16 v[116:131], v[172:175], v[28:31], v[116:131]
    v_fma_f32 v213, v109, s20, -v220
    v_fma_f32 v214, v110, s20, -v220
    v_fma_f32 v215, v111, s20, -v220
    v_exp_f32 v212, v212
    ds_read_b64_tr_b16 v[204:205], v239 offset:40960
    ds_read_b64_tr_b16 v[206:207], v239 offset:43008
    v_mfma_f32_32x32x16_bf16 v[116:131], v[176:179], v[32:35], v[116:131]
    v_exp_f32 v213, v213
    v_exp_f32 v214, v214
    v_exp_f32 v215, v215
    ds_read_b64_tr_b16 v[208:209], v239 offset:45056
    ds_read_b64_tr_b16 v[210:211], v239 offset:47104
    s_waitcnt lgkmcnt(14)
    v_mfma_f32_32x32x16_bf16 v[36:51], v[180:183], v[140:143], v[36:51]
    v_add_f32 v223, v223, v216
    v_add_f32 v224, v224, v217
    v_add_f32 v223, v223, v218
    v_add_f32 v224, v224, v219
    ds_read_b128 v[148:151], v228
    s_mov_b32 s22, 81920
    s_add_u32 m0, s21, 16384
    s_waitcnt lgkmcnt(11)
    v_mfma_f32_32x32x16_bf16 v[52:67], v[188:191], v[140:143], v[52:67]
    v_cvt_pk_bf16_f32 v134, v216, v217
    v_cvt_pk_bf16_f32 v135, v218, v219
    v_fma_f32 v216, v112, s20, -v220
    ds_read_b128 v[152:155], v229
    buffer_load_dwordx4 v240, s[8:11], s22 offen lds
    s_waitcnt lgkmcnt(8)
    v_mfma_f32_32x32x16_bf16 v[68:83], v[196:199], v[140:143], v[68:83]
    v_fma_f32 v217, v113, s20, -v220
    v_fma_f32 v218, v114, s20, -v220
    v_fma_f32 v219, v115, s20, -v220
    v_exp_f32 v216, v216
    ds_read_b128 v[156:159], v230
    s_add_u32 m0, s21, 17408
    s_waitcnt lgkmcnt(5)
    v_mfma_f32_32x32x16_bf16 v[84:99], v[204:207], v[140:143], v[84:99]
    v_exp_f32 v217, v217
    v_exp_f32 v218, v218
    v_exp_f32 v219, v219
    ds_read_b128 v[160:163], v231
    buffer_load_dwordx4 v241, s[8:11], s22 offen lds
    v_mfma_f32_32x32x16_bf16 v[36:51], v[184:187], v[144:147], v[36:51]
    v_add_f32 v223, v223, v212
    v_add_f32 v224, v224, v213
    v_add_f32 v223, v223, v214
    v_add_f32 v224, v224, v215
    ds_read_b128 v[164:167], v232
    s_mov_b32 s22, 65536
    s_add_u32 m0, s21, 49152
    v_mfma_f32_32x32x16_bf16 v[52:67], v[192:195], v[144:147], v[52:67]
    v_cvt_pk_bf16_f32 v136, v212, v213
    v_cvt_pk_bf16_f32 v137, v214, v215
    v_add_f32 v223, v223, v216
    ds_read_b128 v[168:171], v233
    buffer_load_dwordx4 v242, s[12:15], s22 offen lds
    v_mfma_f32_32x32x16_bf16 v[68:83], v[200:203], v[144:147], v[68:83]
    v_add_f32 v224, v224, v217
    v_add_f32 v223, v223, v218
    v_add_f32 v224, v224, v219
    v_cvt_pk_bf16_f32 v138, v216, v217
    ds_read_b128 v[172:175], v234
    s_add_u32 m0, s21, 50176
    s_waitcnt lgkmcnt(7)
    v_mfma_f32_32x32x16_bf16 v[84:99], v[208:211], v[144:147], v[84:99]
    v_cvt_pk_bf16_f32 v139, v218, v219
    v_add_f32 v226, v223, v224
    v_cmp_lt_f32 vcc, 256.0, v226
    ds_read_b128 v[176:179], v235
    buffer_load_dwordx4 v243, s[12:15], s22 offen lds
    s_cbranch_vccnz attn_fix_6
attn_ret_6:
    v_add_f32 v221, v221, v223
    v_add_f32 v222, v222, v224
    s_waitcnt lgkmcnt(7)
    v_mfma_f32_32x32x16_bf16 v[100:115], v[148:151], v[4:7], 0
    v_fma_f32 v212, v116, s20, -v220
    v_fma_f32 v213, v117, s20, -v220
    v_fma_f32 v214, v118, s20, -v220
    v_fma_f32 v215, v119, s20, -v220
    ds_read_b64_tr_b16 v[180:181], v236
    ds_read_b64_tr_b16 v[182:183], v236 offset:2048
    s_waitcnt lgkmcnt(8)
    v_mfma_f32_32x32x16_bf16 v[100:115], v[152:155], v[8:11], v[100:115]
    v_exp_f32 v212, v212
    v_exp_f32 v213, v213
    v_exp_f32 v214, v214
    ds_read_b64_tr_b16 v[184:185], v236 offset:4096
    ds_read_b64_tr_b16 v[186:187], v236 offset:6144
    s_waitcnt lgkmcnt(9)
    v_mfma_f32_32x32x16_bf16 v[100:115], v[156:159], v[12:15], v[100:115]
    v_exp_f32 v215, v215
    v_fma_f32 v216, v120, s20, -v220
    v_fma_f32 v217, v121, s20, -v220
    v_fma_f32 v218, v122, s20, -v220
    ds_read_b64_tr_b16 v[188:189], v237
    ds_read_b64_tr_b16 v[190:191], v237 offset:2048
    s_waitcnt lgkmcnt(10)
    v_mfma_f32_32x32x16_bf16 v[100:115], v[160:163], v[16:19], v[100:115]
    v_fma_f32 v219, v123, s20, -v220
    v_exp_f32 v216, v216
    v_exp_f32 v217, v217
    ds_read_b64_tr_b16 v[192:193], v237 offset:4096
    ds_read_b64_tr_b16 v[194:195], v237 offset:6144
    s_waitcnt lgkmcnt(11)
    v_mfma_f32_32x32x16_bf16 v[100:115], v[164:167], v[20:23], v[100:115]
    v_exp_f32 v218, v218
    v_exp_f32 v219, v219
    v_add_f32 v223, v212, v213
    v_add_f32 v224, v214, v215
    ds_read_b64_tr_b16 v[196:197], v238
    ds_read_b64_tr_b16 v[198:199], v238 offset:2048
    s_waitcnt lgkmcnt(12)
    v_mfma_f32_32x32x16_bf16 v[100:115], v[168:171], v[24:27], v[100:115]
    v_cvt_pk_bf16_f32 v140, v212, v213
    v_cvt_pk_bf16_f32 v141, v214, v215
    v_fma_f32 v212, v124, s20, -v220
    ds_read_b64_tr_b16 v[200:201], v238 offset:4096
    ds_read_b64_tr_b16 v[202:203], v238 offset:6144
    s_waitcnt lgkmcnt(13)
    v_mfma_f32_32x32x16_bf16 v[100:115], v[172:175], v[28:31], v[100:115]
    v_fma_f32 v213, v125, s20, -v220
    v_fma_f32 v214, v126, s20, -v220
    v_fma_f32 v215, v127, s20, -v220
    v_exp_f32 v212, v212
    ds_read_b64_tr_b16 v[204:205], v239
    ds_read_b64_tr_b16 v[206:207], v239 offset:2048
    s_waitcnt lgkmcnt(14)
    v_mfma_f32_32x32x16_bf16 v[100:115], v[176:179], v[32:35], v[100:115]
    v_exp_f32 v213, v213
    v_exp_f32 v214, v214
    v_exp_f32 v215, v215
    ds_read_b64_tr_b16 v[208:209], v239 offset:4096
    ds_read_b64_tr_b16 v[210:211], v239 offset:6144
    s_waitcnt lgkmcnt(14)
    v_mfma_f32_32x32x16_bf16 v[36:51], v[180:183], v[132:135], v[36:51]
    v_add_f32 v223, v223, v216
    v_add_f32 v224, v224, v217
    v_add_f32 v223, v223, v218
    v_add_f32 v224, v224, v219
    ds_read_b128 v[148:151], v228 offset:8192
    s_waitcnt lgkmcnt(11)
    v_mfma_f32_32x32x16_bf16 v[52:67], v[188:191], v[132:135], v[52:67]
    v_cvt_pk_bf16_f32 v142, v216, v217
    v_cvt_pk_bf16_f32 v143, v218, v219
    v_fma_f32 v216, v128, s20, -v220
    ds_read_b128 v[152:155], v229 offset:8192
    s_waitcnt lgkmcnt(8)
    v_mfma_f32_32x32x16_bf16 v[68:83], v[196:199], v[132:135], v[68:83]
    v_fma_f32 v217, v129, s20, -v220
    v_fma_f32 v218, v130, s20, -v220
    v_fma_f32 v219, v131, s20, -v220
    v_exp_f32 v216, v216
    ds_read_b128 v[156:159], v230 offset:8192
    s_waitcnt lgkmcnt(5)
    v_mfma_f32_32x32x16_bf16 v[84:99], v[204:207], v[132:135], v[84:99]
    v_exp_f32 v217, v217
    v_exp_f32 v218, v218
    v_exp_f32 v219, v219
    ds_read_b128 v[160:163], v231 offset:8192
    v_mfma_f32_32x32x16_bf16 v[36:51], v[184:187], v[136:139], v[36:51]
    v_add_f32 v223, v223, v212
    v_add_f32 v224, v224, v213
    v_add_f32 v223, v223, v214
    v_add_f32 v224, v224, v215
    ds_read_b128 v[164:167], v232 offset:8192
    v_mfma_f32_32x32x16_bf16 v[52:67], v[192:195], v[136:139], v[52:67]
    v_cvt_pk_bf16_f32 v144, v212, v213
    v_cvt_pk_bf16_f32 v145, v214, v215
    v_add_f32 v223, v223, v216
    ds_read_b128 v[168:171], v233 offset:8192
    v_mfma_f32_32x32x16_bf16 v[68:83], v[200:203], v[136:139], v[68:83]
    v_add_f32 v224, v224, v217
    v_add_f32 v223, v223, v218
    v_add_f32 v224, v224, v219
    v_cvt_pk_bf16_f32 v146, v216, v217
    ds_read_b128 v[172:175], v234 offset:8192
    s_waitcnt lgkmcnt(7)
    v_mfma_f32_32x32x16_bf16 v[84:99], v[208:211], v[136:139], v[84:99]
    v_cvt_pk_bf16_f32 v147, v218, v219
    v_add_f32 v226, v223, v224
    v_cmp_lt_f32 vcc, 256.0, v226
    ds_read_b128 v[176:179], v235 offset:8192
    s_cbranch_vccnz attn_fix_7
attn_ret_7:
    v_add_f32 v221, v221, v223
    v_add_f32 v222, v222, v224
    s_waitcnt vmcnt(0) lgkmcnt(0)
    s_barrier
    v_mfma_f32_32x32x16_bf16 v[116:131], v[148:151], v[4:7], 0
    v_fma_f32 v212, v100, s20, -v220
    v_fma_f32 v213, v101, s20, -v220
    v_fma_f32 v214, v102, s20, -v220
    v_fma_f32 v215, v103, s20, -v220
    ds_read_b64_tr_b16 v[180:181], v236 offset:8192
    ds_read_b64_tr_b16 v[182:183], v236 offset:10240
    v_mfma_f32_32x32x16_bf16 v[116:131], v[152:155], v[8:11], v[116:131]
    v_exp_f32 v212, v212
    v_exp_f32 v213, v213
    v_exp_f32 v214, v214
    ds_read_b64_tr_b16 v[184:185], v236 offset:12288
    ds_read_b64_tr_b16 v[186:187], v236 offset:14336
    v_mfma_f32_32x32x16_bf16 v[116:131], v[156:159], v[12:15], v[116:131]
    v_exp_f32 v215, v215
    v_fma_f32 v216, v104, s20, -v220
    v_fma_f32 v217, v105, s20, -v220
    v_fma_f32 v218, v106, s20, -v220
    ds_read_b64_tr_b16 v[188:189], v237 offset:8192
    ds_read_b64_tr_b16 v[190:191], v237 offset:10240
    v_mfma_f32_32x32x16_bf16 v[116:131], v[160:163], v[16:19], v[116:131]
    v_fma_f32 v219, v107, s20, -v220
    v_exp_f32 v216, v216
    v_exp_f32 v217, v217
    ds_read_b64_tr_b16 v[192:193], v237 offset:12288
    ds_read_b64_tr_b16 v[194:195], v237 offset:14336
    v_mfma_f32_32x32x16_bf16 v[116:131], v[164:167], v[20:23], v[116:131]
    v_exp_f32 v218, v218
    v_exp_f32 v219, v219
    v_add_f32 v223, v212, v213
    v_add_f32 v224, v214, v215
    ds_read_b64_tr_b16 v[196:197], v238 offset:8192
    ds_read_b64_tr_b16 v[198:199], v238 offset:10240
    v_mfma_f32_32x32x16_bf16 v[116:131], v[168:171], v[24:27], v[116:131]
    v_cvt_pk_bf16_f32 v132, v212, v213
    v_cvt_pk_bf16_f32 v133, v214, v215
    v_fma_f32 v212, v108, s20, -v220
    ds_read_b64_tr_b16 v[200:201], v238 offset:12288
    ds_read_b64_tr_b16 v[202:203], v238 offset:14336
    v_mfma_f32_32x32x16_bf16 v[116:131], v[172:175], v[28:31], v[116:131]
    v_fma_f32 v213, v109, s20, -v220
    v_fma_f32 v214, v110, s20, -v220
    v_fma_f32 v215, v111, s20, -v220
    v_exp_f32 v212, v212
    ds_read_b64_tr_b16 v[204:205], v239 offset:8192
    ds_read_b64_tr_b16 v[206:207], v239 offset:10240
    v_mfma_f32_32x32x16_bf16 v[116:131], v[176:179], v[32:35], v[116:131]
    v_exp_f32 v213, v213
    v_exp_f32 v214, v214
    v_exp_f32 v215, v215
    ds_read_b64_tr_b16 v[208:209], v239 offset:12288
    ds_read_b64_tr_b16 v[210:211], v239 offset:14336
    s_waitcnt lgkmcnt(14)
    v_mfma_f32_32x32x16_bf16 v[36:51], v[180:183], v[140:143], v[36:51]
    v_add_f32 v223, v223, v216
    v_add_f32 v224, v224, v217
    v_add_f32 v223, v223, v218
    v_add_f32 v224, v224, v219
    ds_read_b128 v[148:151], v228 offset:16384
    s_mov_b32 s22, 98304
    s_add_u32 m0, s21, 0
    s_waitcnt lgkmcnt(11)
    v_mfma_f32_32x32x16_bf16 v[52:67], v[188:191], v[140:143], v[52:67]
    v_cvt_pk_bf16_f32 v134, v216, v217
    v_cvt_pk_bf16_f32 v135, v218, v219
    v_fma_f32 v216, v112, s20, -v220
    ds_read_b128 v[152:155], v229 offset:16384
    buffer_load_dwordx4 v240, s[8:11], s22 offen lds
    s_waitcnt lgkmcnt(8)
    v_mfma_f32_32x32x16_bf16 v[68:83], v[196:199], v[140:143], v[68:83]
    v_fma_f32 v217, v113, s20, -v220
    v_fma_f32 v218, v114, s20, -v220
    v_fma_f32 v219, v115, s20, -v220
    v_exp_f32 v216, v216
    ds_read_b128 v[156:159], v230 offset:16384
    s_add_u32 m0, s21, 1024
    s_waitcnt lgkmcnt(5)
    v_mfma_f32_32x32x16_bf16 v[84:99], v[204:207], v[140:143], v[84:99]
    v_exp_f32 v217, v217
    v_exp_f32 v218, v218
    v_exp_f32 v219, v219
    ds_read_b128 v[160:163], v231 offset:16384
    buffer_load_dwordx4 v241, s[8:11], s22 offen lds
    v_mfma_f32_32x32x16_bf16 v[36:51], v[184:187], v[144:147], v[36:51]
    v_add_f32 v223, v223, v212
    v_add_f32 v224, v224, v213
    v_add_f32 v223, v223, v214
    v_add_f32 v224, v224, v215
    ds_read_b128 v[164:167], v232 offset:16384
    s_mov_b32 s22, 81920
    s_add_u32 m0, s21, 65536
    v_mfma_f32_32x32x16_bf16 v[52:67], v[192:195], v[144:147], v[52:67]
    v_cvt_pk_bf16_f32 v136, v212, v213
    v_cvt_pk_bf16_f32 v137, v214, v215
    v_add_f32 v223, v223, v216
    ds_read_b128 v[168:171], v233 offset:16384
    buffer_load_dwordx4 v242, s[12:15], s22 offen lds
    v_mfma_f32_32x32x16_bf16 v[68:83], v[200:203], v[144:147], v[68:83]
    v_add_f32 v224, v224, v217
    v_add_f32 v223, v223, v218
    v_add_f32 v224, v224, v219
    v_cvt_pk_bf16_f32 v138, v216, v217
    ds_read_b128 v[172:175], v234 offset:16384
    s_add_u32 m0, s21, 66560
    s_waitcnt lgkmcnt(7)
    v_mfma_f32_32x32x16_bf16 v[84:99], v[208:211], v[144:147], v[84:99]
    v_cvt_pk_bf16_f32 v139, v218, v219
    v_add_f32 v226, v223, v224
    v_cmp_lt_f32 vcc, 256.0, v226
    ds_read_b128 v[176:179], v235 offset:16384
    buffer_load_dwordx4 v243, s[12:15], s22 offen lds
    s_cbranch_vccnz attn_fix_8
attn_ret_8:
    v_add_f32 v221, v221, v223
    v_add_f32 v222, v222, v224
    s_waitcnt lgkmcnt(7)
    v_mfma_f32_32x32x16_bf16 v[100:115], v[148:151], v[4:7], 0
    v_fma_f32 v212, v116, s20, -v220
    v_fma_f32 v213, v117, s20, -v220
    v_fma_f32 v214, v118, s20, -v220
    v_fma_f32 v215, v119, s20, -v220
    ds_read_b64_tr_b16 v[180:181], v236 offset:16384
    ds_read_b64_tr_b16 v[182:183], v236 offset:18432
    s_waitcnt lgkmcnt(8)
    v_mfma_f32_32x32x16_bf16 v[100:115], v[152:155], v[8:11], v[100:115]
    v_exp_f32 v212, v212
    v_exp_f32 v213, v213
    v_exp_f32 v214, v214
    ds_read_b64_tr_b16 v[184:185], v236 offset:20480
    ds_read_b64_tr_b16 v[186:187], v236 offset:22528
    s_waitcnt lgkmcnt(9)
    v_mfma_f32_32x32x16_bf16 v[100:115], v[156:159], v[12:15], v[100:115]
    v_exp_f32 v215, v215
    v_fma_f32 v216, v120, s20, -v220
    v_fma_f32 v217, v121, s20, -v220
    v_fma_f32 v218, v122, s20, -v220
    ds_read_b64_tr_b16 v[188:189], v237 offset:16384
    ds_read_b64_tr_b16 v[190:191], v237 offset:18432
    s_waitcnt lgkmcnt(10)
    v_mfma_f32_32x32x16_bf16 v[100:115], v[160:163], v[16:19], v[100:115]
    v_fma_f32 v219, v123, s20, -v220
    v_exp_f32 v216, v216
    v_exp_f32 v217, v217
    ds_read_b64_tr_b16 v[192:193], v237 offset:20480
    ds_read_b64_tr_b16 v[194:195], v237 offset:22528
    s_waitcnt lgkmcnt(11)
    v_mfma_f32_32x32x16_bf16 v[100:115], v[164:167], v[20:23], v[100:115]
    v_exp_f32 v218, v218
    v_exp_f32 v219, v219
    v_add_f32 v223, v212, v213
    v_add_f32 v224, v214, v215
    ds_read_b64_tr_b16 v[196:197], v238 offset:16384
    ds_read_b64_tr_b16 v[198:199], v238 offset:18432
    s_waitcnt lgkmcnt(12)
    v_mfma_f32_32x32x16_bf16 v[100:115], v[168:171], v[24:27], v[100:115]
    v_cvt_pk_bf16_f32 v140, v212, v213
    v_cvt_pk_bf16_f32 v141, v214, v215
    v_fma_f32 v212, v124, s20, -v220
    ds_read_b64_tr_b16 v[200:201], v238 offset:20480
    ds_read_b64_tr_b16 v[202:203], v238 offset:22528
    s_waitcnt lgkmcnt(13)
    v_mfma_f32_32x32x16_bf16 v[100:115], v[172:175], v[28:31], v[100:115]
    v_fma_f32 v213, v125, s20, -v220
    v_fma_f32 v214, v126, s20, -v220
    v_fma_f32 v215, v127, s20, -v220
    v_exp_f32 v212, v212
    ds_read_b64_tr_b16 v[204:205], v239 offset:16384
    ds_read_b64_tr_b16 v[206:207], v239 offset:18432
    s_waitcnt lgkmcnt(14)
    v_mfma_f32_32x32x16_bf16 v[100:115], v[176:179], v[32:35], v[100:115]
    v_exp_f32 v213, v213
    v_exp_f32 v214, v214
    v_exp_f32 v215, v215
    ds_read_b64_tr_b16 v[208:209], v239 offset:20480
    ds_read_b64_tr_b16 v[210:211], v239 offset:22528
    s_waitcnt lgkmcnt(14)
    v_mfma_f32_32x32x16_bf16 v[36:51], v[180:183], v[132:135], v[36:51]
    v_add_f32 v223, v223, v216
    v_add_f32 v224, v224, v217
    v_add_f32 v223, v223, v218
    v_add_f32 v224, v224, v219
    ds_read_b128 v[148:151], v228 offset:24576
    s_waitcnt lgkmcnt(11)
    v_mfma_f32_32x32x16_bf16 v[52:67], v[188:191], v[132:135], v[52:67]
    v_cvt_pk_bf16_f32 v142, v216, v217
    v_cvt_pk_bf16_f32 v143, v218, v219
    v_fma_f32 v216, v128, s20, -v220
    ds_read_b128 v[152:155], v229 offset:24576
    s_waitcnt lgkmcnt(8)
    v_mfma_f32_32x32x16_bf16 v[68:83], v[196:199], v[132:135], v[68:83]
    v_fma_f32 v217, v129, s20, -v220
    v_fma_f32 v218, v130, s20, -v220
    v_fma_f32 v219, v131, s20, -v220
    v_exp_f32 v216, v216
    ds_read_b128 v[156:159], v230 offset:24576
    s_waitcnt lgkmcnt(5)
    v_mfma_f32_32x32x16_bf16 v[84:99], v[204:207], v[132:135], v[84:99]
    v_exp_f32 v217, v217
    v_exp_f32 v218, v218
    v_exp_f32 v219, v219
    ds_read_b128 v[160:163], v231 offset:24576
    v_mfma_f32_32x32x16_bf16 v[36:51], v[184:187], v[136:139], v[36:51]
    v_add_f32 v223, v223, v212
    v_add_f32 v224, v224, v213
    v_add_f32 v223, v223, v214
    v_add_f32 v224, v224, v215
    ds_read_b128 v[164:167], v232 offset:24576
    v_mfma_f32_32x32x16_bf16 v[52:67], v[192:195], v[136:139], v[52:67]
    v_cvt_pk_bf16_f32 v144, v212, v213
    v_cvt_pk_bf16_f32 v145, v214, v215
    v_add_f32 v223, v223, v216
    ds_read_b128 v[168:171], v233 offset:24576
    v_mfma_f32_32x32x16_bf16 v[68:83], v[200:203], v[136:139], v[68:83]
    v_add_f32 v224, v224, v217
    v_add_f32 v223, v223, v218
    v_add_f32 v224, v224, v219
    v_cvt_pk_bf16_f32 v146, v216, v217
    ds_read_b128 v[172:175], v234 offset:24576
    s_waitcnt lgkmcnt(7)
    v_mfma_f32_32x32x16_bf16 v[84:99], v[208:211], v[136:139], v[84:99]
    v_cvt_pk_bf16_f32 v147, v218, v219
    v_add_f32 v226, v223, v224
    v_cmp_lt_f32 vcc, 256.0, v226
    ds_read_b128 v[176:179], v235 offset:24576
    s_cbranch_vccnz attn_fix_9
attn_ret_9:
    v_add_f32 v221, v221, v223
    v_add_f32 v222, v222, v224
    s_waitcnt vmcnt(0) lgkmcnt(0)
    s_barrier
    v_mfma_f32_32x32x16_bf16 v[116:131], v[148:151], v[4:7], 0
    v_fma_f32 v212, v100, s20, -v220
    v_fma_f32 v213, v101, s20, -v220
    v_fma_f32 v214, v102, s20, -v220
    v_fma_f32 v215, v103, s20, -v220
    ds_read_b64_tr_b16 v[180:181], v236 offset:24576
    ds_read_b64_tr_b16 v[182:183], v236 offset:26624
    v_mfma_f32_32x32x16_bf16 v[116:131], v[152:155], v[8:11], v[116:131]
    v_exp_f32 v212, v212
    v_exp_f32 v213, v213
    v_exp_f32 v214, v214
    ds_read_b64_tr_b16 v[184:185], v236 offset:28672
    ds_read_b64_tr_b16 v[186:187], v236 offset:30720
    v_mfma_f32_32x32x16_bf16 v[116:131], v[156:159], v[12:15], v[116:131]
    v_exp_f32 v215, v215
    v_fma_f32 v216, v104, s20, -v220
    v_fma_f32 v217, v105, s20, -v220
    v_fma_f32 v218, v106, s20, -v220
    ds_read_b64_tr_b16 v[188:189], v237 offset:24576
    ds_read_b64_tr_b16 v[190:191], v237 offset:26624
    v_mfma_f32_32x32x16_bf16 v[116:131], v[160:163], v[16:19], v[116:131]
    v_fma_f32 v219, v107, s20, -v220
    v_exp_f32 v216, v216
    v_exp_f32 v217, v217
    ds_read_b64_tr_b16 v[192:193], v237 offset:28672
    ds_read_b64_tr_b16 v[194:195], v237 offset:30720
    v_mfma_f32_32x32x16_bf16 v[116:131], v[164:167], v[20:23], v[116:131]
    v_exp_f32 v218, v218
    v_exp_f32 v219, v219
    v_add_f32 v223, v212, v213
    v_add_f32 v224, v214, v215
    ds_read_b64_tr_b16 v[196:197], v238 offset:24576
    ds_read_b64_tr_b16 v[198:199], v238 offset:26624
    v_mfma_f32_32x32x16_bf16 v[116:131], v[168:171], v[24:27], v[116:131]
    v_cvt_pk_bf16_f32 v132, v212, v213
    v_cvt_pk_bf16_f32 v133, v214, v215
    v_fma_f32 v212, v108, s20, -v220
    ds_read_b64_tr_b16 v[200:201], v238 offset:28672
    ds_read_b64_tr_b16 v[202:203], v238 offset:30720
    v_mfma_f32_32x32x16_bf16 v[116:131], v[172:175], v[28:31], v[116:131]
    v_fma_f32 v213, v109, s20, -v220
    v_fma_f32 v214, v110, s20, -v220
    v_fma_f32 v215, v111, s20, -v220
    v_exp_f32 v212, v212
    ds_read_b64_tr_b16 v[204:205], v239 offset:24576
    ds_read_b64_tr_b16 v[206:207], v239 offset:26624
    v_mfma_f32_32x32x16_bf16 v[116:131], v[176:179], v[32:35], v[116:131]
    v_exp_f32 v213, v213
    v_exp_f32 v214, v214
    v_exp_f32 v215, v215
    ds_read_b64_tr_b16 v[208:209], v239 offset:28672
    ds_read_b64_tr_b16 v[210:211], v239 offset:30720
    s_waitcnt lgkmcnt(14)
    v_mfma_f32_32x32x16_bf16 v[36:51], v[180:183], v[140:143], v[36:51]
    v_add_f32 v223, v223, v216
    v_add_f32 v224, v224, v217
    v_add_f32 v223, v223, v218
    v_add_f32 v224, v224, v219
    ds_read_b128 v[148:151], v228
    s_mov_b32 s22, 114688
    s_add_u32 m0, s21, 16384
    s_waitcnt lgkmcnt(11)
    v_mfma_f32_32x32x16_bf16 v[52:67], v[188:191], v[140:143], v[52:67]
    v_cvt_pk_bf16_f32 v134, v216, v217
    v_cvt_pk_bf16_f32 v135, v218, v219
    v_fma_f32 v216, v112, s20, -v220
    ds_read_b128 v[152:155], v229
    buffer_load_dwordx4 v240, s[8:11], s22 offen lds
    s_waitcnt lgkmcnt(8)
    v_mfma_f32_32x32x16_bf16 v[68:83], v[196:199], v[140:143], v[68:83]
    v_fma_f32 v217, v113, s20, -v220
    v_fma_f32 v218, v114, s20, -v220
    v_fma_f32 v219, v115, s20, -v220
    v_exp_f32 v216, v216
    ds_read_b128 v[156:159], v230
    s_add_u32 m0, s21, 17408
    s_waitcnt lgkmcnt(5)
    v_mfma_f32_32x32x16_bf16 v[84:99], v[204:207], v[140:143], v[84:99]
    v_exp_f32 v217, v217
    v_exp_f32 v218, v218
    v_exp_f32 v219, v219
    ds_read_b128 v[160:163], v231
    buffer_load_dwordx4 v241, s[8:11], s22 offen lds
    v_mfma_f32_32x32x16_bf16 v[36:51], v[184:187], v[144:147], v[36:51]
    v_add_f32 v223, v223, v212
    v_add_f32 v224, v224, v213
    v_add_f32 v223, v223, v214
    v_add_f32 v224, v224, v215
    ds_read_b128 v[164:167], v232
    s_mov_b32 s22, 98304
    s_add_u32 m0, s21, 32768
    v_mfma_f32_32x32x16_bf16 v[52:67], v[192:195], v[144:147], v[52:67]
    v_cvt_pk_bf16_f32 v136, v212, v213
    v_cvt_pk_bf16_f32 v137, v214, v215
    v_add_f32 v223, v223, v216
    ds_read_b128 v[168:171], v233
    buffer_load_dwordx4 v242, s[12:15], s22 offen lds
    v_mfma_f32_32x32x16_bf16 v[68:83], v[200:203], v[144:147], v[68:83]
    v_add_f32 v224, v224, v217
    v_add_f32 v223, v223, v218
    v_add_f32 v224, v224, v219
    v_cvt_pk_bf16_f32 v138, v216, v217
    ds_read_b128 v[172:175], v234
    s_add_u32 m0, s21, 33792
    s_waitcnt lgkmcnt(7)
    v_mfma_f32_32x32x16_bf16 v[84:99], v[208:211], v[144:147], v[84:99]
    v_cvt_pk_bf16_f32 v139, v218, v219
    v_add_f32 v226, v223, v224
    v_cmp_lt_f32 vcc, 256.0, v226
    ds_read_b128 v[176:179], v235
    buffer_load_dwordx4 v243, s[12:15], s22 offen lds
    s_cbranch_vccnz attn_fix_10
attn_ret_10:
    v_add_f32 v221, v221, v223
    v_add_f32 v222, v222, v224
    s_waitcnt lgkmcnt(7)
    v_mfma_f32_32x32x16_bf16 v[100:115], v[148:151], v[4:7], 0
    v_fma_f32 v212, v116, s20, -v220
    v_fma_f32 v213, v117, s20, -v220
    v_fma_f32 v214, v118, s20, -v220
    v_fma_f32 v215, v119, s20, -v220
    ds_read_b64_tr_b16 v[180:181], v236 offset:32768
    ds_read_b64_tr_b16 v[182:183], v236 offset:34816
    s_waitcnt lgkmcnt(8)
    v_mfma_f32_32x32x16_bf16 v[100:115], v[152:155], v[8:11], v[100:115]
    v_exp_f32 v212, v212
    v_exp_f32 v213, v213
    v_exp_f32 v214, v214
    ds_read_b64_tr_b16 v[184:185], v236 offset:36864
    ds_read_b64_tr_b16 v[186:187], v236 offset:38912
    s_waitcnt lgkmcnt(9)
    v_mfma_f32_32x32x16_bf16 v[100:115], v[156:159], v[12:15], v[100:115]
    v_exp_f32 v215, v215
    v_fma_f32 v216, v120, s20, -v220
    v_fma_f32 v217, v121, s20, -v220
    v_fma_f32 v218, v122, s20, -v220
    ds_read_b64_tr_b16 v[188:189], v237 offset:32768
    ds_read_b64_tr_b16 v[190:191], v237 offset:34816
    s_waitcnt lgkmcnt(10)
    v_mfma_f32_32x32x16_bf16 v[100:115], v[160:163], v[16:19], v[100:115]
    v_fma_f32 v219, v123, s20, -v220
    v_exp_f32 v216, v216
    v_exp_f32 v217, v217
    ds_read_b64_tr_b16 v[192:193], v237 offset:36864
    ds_read_b64_tr_b16 v[194:195], v237 offset:38912
    s_waitcnt lgkmcnt(11)
    v_mfma_f32_32x32x16_bf16 v[100:115], v[164:167], v[20:23], v[100:115]
    v_exp_f32 v218, v218
    v_exp_f32 v219, v219
    v_add_f32 v223, v212, v213
    v_add_f32 v224, v214, v215
    ds_read_b64_tr_b16 v[196:197], v238 offset:32768
    ds_read_b64_tr_b16 v[198:199], v238 offset:34816
    s_waitcnt lgkmcnt(12)
    v_mfma_f32_32x32x16_bf16 v[100:115], v[168:171], v[24:27], v[100:115]
    v_cvt_pk_bf16_f32 v140, v212, v213
    v_cvt_pk_bf16_f32 v141, v214, v215
    v_fma_f32 v212, v124, s20, -v220
    ds_read_b64_tr_b16 v[200:201], v238 offset:36864
    ds_read_b64_tr_b16 v[202:203], v238 offset:38912
    s_waitcnt lgkmcnt(13)
    v_mfma_f32_32x32x16_bf16 v[100:115], v[172:175], v[28:31], v[100:115]
    v_fma_f32 v213, v125, s20, -v220
    v_fma_f32 v214, v126, s20, -v220
    v_fma_f32 v215, v127, s20, -v220
    v_exp_f32 v212, v212
    ds_read_b64_tr_b16 v[204:205], v239 offset:32768
    ds_read_b64_tr_b16 v[206:207], v239 offset:34816
    s_waitcnt lgkmcnt(14)
    v_mfma_f32_32x32x16_bf16 v[100:115], v[176:179], v[32:35], v[100:115]
    v_exp_f32 v213, v213
    v_exp_f32 v214, v214
    v_exp_f32 v215, v215
    ds_read_b64_tr_b16 v[208:209], v239 offset:36864
    ds_read_b64_tr_b16 v[210:211], v239 offset:38912
    s_waitcnt lgkmcnt(14)
    v_mfma_f32_32x32x16_bf16 v[36:51], v[180:183], v[132:135], v[36:51]
    v_add_f32 v223, v223, v216
    v_add_f32 v224, v224, v217
    v_add_f32 v223, v223, v218
    v_add_f32 v224, v224, v219
    ds_read_b128 v[148:151], v228 offset:8192
    s_waitcnt lgkmcnt(11)
    v_mfma_f32_32x32x16_bf16 v[52:67], v[188:191], v[132:135], v[52:67]
    v_cvt_pk_bf16_f32 v142, v216, v217
    v_cvt_pk_bf16_f32 v143, v218, v219
    v_fma_f32 v216, v128, s20, -v220
    ds_read_b128 v[152:155], v229 offset:8192
    s_waitcnt lgkmcnt(8)
    v_mfma_f32_32x32x16_bf16 v[68:83], v[196:199], v[132:135], v[68:83]
    v_fma_f32 v217, v129, s20, -v220
    v_fma_f32 v218, v130, s20, -v220
    v_fma_f32 v219, v131, s20, -v220
    v_exp_f32 v216, v216
    ds_read_b128 v[156:159], v230 offset:8192
    s_waitcnt lgkmcnt(5)
    v_mfma_f32_32x32x16_bf16 v[84:99], v[204:207], v[132:135], v[84:99]
    v_exp_f32 v217, v217
    v_exp_f32 v218, v218
    v_exp_f32 v219, v219
    ds_read_b128 v[160:163], v231 offset:8192
    v_mfma_f32_32x32x16_bf16 v[36:51], v[184:187], v[136:139], v[36:51]
    v_add_f32 v223, v223, v212
    v_add_f32 v224, v224, v213
    v_add_f32 v223, v223, v214
    v_add_f32 v224, v224, v215
    ds_read_b128 v[164:167], v232 offset:8192
    v_mfma_f32_32x32x16_bf16 v[52:67], v[192:195], v[136:139], v[52:67]
    v_cvt_pk_bf16_f32 v144, v212, v213
    v_cvt_pk_bf16_f32 v145, v214, v215
    v_add_f32 v223, v223, v216
    ds_read_b128 v[168:171], v233 offset:8192
    v_mfma_f32_32x32x16_bf16 v[68:83], v[200:203], v[136:139], v[68:83]
    v_add_f32 v224, v224, v217
    v_add_f32 v223, v223, v218
    v_add_f32 v224, v224, v219
    v_cvt_pk_bf16_f32 v146, v216, v217
    ds_read_b128 v[172:175], v234 offset:8192
    s_waitcnt lgkmcnt(7)
    v_mfma_f32_32x32x16_bf16 v[84:99], v[208:211], v[136:139], v[84:99]
    v_cvt_pk_bf16_f32 v147, v218, v219
    v_add_f32 v226, v223, v224
    v_cmp_lt_f32 vcc, 256.0, v226
    ds_read_b128 v[176:179], v235 offset:8192
    s_cbranch_vccnz attn_fix_11
attn_ret_11:
    v_add_f32 v221, v221, v223
    v_add_f32 v222, v222, v224
    s_waitcnt vmcnt(0) lgkmcnt(0)
    s_barrier
    v_mfma_f32_32x32x16_bf16 v[116:131], v[148:151], v[4:7], 0
    v_fma_f32 v212, v100, s20, -v220
    v_fma_f32 v213, v101, s20, -v220
    v_fma_f32 v214, v102, s20, -v220
    v_fma_f32 v215, v103, s20, -v220
    ds_read_b64_tr_b16 v[180:181], v236 offset:40960
    ds_read_b64_tr_b16 v[182:183], v236 offset:43008
    v_mfma_f32_32x32x16_bf16 v[116:131], v[152:155], v[8:11], v[116:131]
    v_exp_f32 v212, v212
    v_exp_f32 v213, v213
    v_exp_f32 v214, v214
    ds_read_b64_tr_b16 v[184:185], v236 offset:45056
    ds_read_b64_tr_b16 v[186:187], v236 offset:47104
    v_mfma_f32_32x32x16_bf16 v[116:131], v[156:159], v[12:15], v[116:131]
    v_exp_f32 v215, v215
    v_fma_f32 v216, v104, s20, -v220
    v_fma_f32 v217, v105, s20, -v220
    v_fma_f32 v218, v106, s20, -v220
    ds_read_b64_tr_b16 v[188:189], v237 offset:40960
    ds_read_b64_tr_b16 v[190:191], v237 offset:43008
    v_mfma_f32_32x32x16_bf16 v[116:131], v[160:163], v[16:19], v[116:131]
    v_fma_f32 v219, v107, s20, -v220
    v_exp_f32 v216, v216
    v_exp_f32 v217, v217
    ds_read_b64_tr_b16 v[192:193], v237 offset:45056
    ds_read_b64_tr_b16 v[194:195], v237 offset:47104
    v_mfma_f32_32x32x16_bf16 v[116:131], v[164:167], v[20:23], v[116:131]
    v_exp_f32 v218, v218
    v_exp_f32 v219, v219
    v_add_f32 v223, v212, v213
    v_add_f32 v224, v214, v215
    ds_read_b64_tr_b16 v[196:197], v238 offset:40960
    ds_read_b64_tr_b16 v[198:199], v238 offset:43008
    v_mfma_f32_32x32x16_bf16 v[116:131], v[168:171], v[24:27], v[116:131]
    v_cvt_pk_bf16_f32 v132, v212, v213
    v_cvt_pk_bf16_f32 v133, v214, v215
    v_fma_f32 v212, v108, s20, -v220
    ds_read_b64_tr_b16 v[200:201], v238 offset:45056
    ds_read_b64_tr_b16 v[202:203], v238 offset:47104
    v_mfma_f32_32x32x16_bf16 v[116:131], v[172:175], v[28:31], v[116:131]
    v_fma_f32 v213, v109, s20, -v220
    v_fma_f32 v214, v110, s20, -v220
    v_fma_f32 v215, v111, s20, -v220
    v_exp_f32 v212, v212
    ds_read_b64_tr_b16 v[204:205], v239 offset:40960
    ds_read_b64_tr_b16 v[206:207], v239 offset:43008
    v_mfma_f32_32x32x16_bf16 v[116:131], v[176:179], v[32:35], v[116:131]
    v_exp_f32 v213, v213
    v_exp_f32 v214, v214
    v_exp_f32 v215, v215
    ds_read_b64_tr_b16 v[208:209], v239 offset:45056
    ds_read_b64_tr_b16 v[210:211], v239 offset:47104
    s_waitcnt lgkmcnt(14)
    v_mfma_f32_32x32x16_bf16 v[36:51], v[180:183], v[140:143], v[36:51]
    v_add_f32 v223, v223, v216
    v_add_f32 v224, v224, v217
    v_add_f32 v223, v223, v218
    v_add_f32 v224, v224, v219
    ds_read_b128 v[148:151], v228 offset:16384
    s_mov_b32 s22, 114688
    s_waitcnt lgkmcnt(11)
    v_mfma_f32_32x32x16_bf16 v[52:67], v[188:191], v[140:143], v[52:67]
    v_cvt_pk_bf16_f32 v134, v216, v217
    v_cvt_pk_bf16_f32 v135, v218, v219
    v_fma_f32 v216, v112, s20, -v220
    ds_read_b128 v[152:155], v229 offset:16384
    s_add_u32 m0, s21, 49152
    s_waitcnt lgkmcnt(8)
    v_mfma_f32_32x32x16_bf16 v[68:83], v[196:199], v[140:143], v[68:83]
    v_fma_f32 v217, v113, s20, -v220
    v_fma_f32 v218, v114, s20, -v220
    v_fma_f32 v219, v115, s20, -v220
    v_exp_f32 v216, v216
    ds_read_b128 v[156:159], v230 offset:16384
    s_waitcnt lgkmcnt(5)
    v_mfma_f32_32x32x16_bf16 v[84:99], v[204:207], v[140:143], v[84:99]
    v_exp_f32 v217, v217
    v_exp_f32 v218, v218
    v_exp_f32 v219, v219
    ds_read_b128 v[160:163], v231 offset:16384
    buffer_load_dwordx4 v242, s[12:15], s22 offen lds
    v_mfma_f32_32x32x16_bf16 v[36:51], v[184:187], v[144:147], v[36:51]
    v_add_f32 v223, v223, v212
    v_add_f32 v224, v224, v213
    v_add_f32 v223, v223, v214
    v_add_f32 v224, v224, v215
    ds_read_b128 v[164:167], v232 offset:16384
    s_add_u32 m0, s21, 50176
    v_mfma_f32_32x32x16_bf16 v[52:67], v[192:195], v[144:147], v[52:67]
    v_cvt_pk_bf16_f32 v136, v212, v213
    v_cvt_pk_bf16_f32 v137, v214, v215
    v_add_f32 v223, v223, v216
    ds_read_b128 v[168:171], v233 offset:16384
    v_mfma_f32_32x32x16_bf16 v[68:83], v[200:203], v[144:147], v[68:83]
    v_add_f32 v224, v224, v217
    v_add_f32 v223, v223, v218
    v_add_f32 v224, v224, v219
    v_cvt_pk_bf16_f32 v138, v216, v217
    ds_read_b128 v[172:175], v234 offset:16384
    buffer_load_dwordx4 v243, s[12:15], s22 offen lds
    s_waitcnt lgkmcnt(7)
    v_mfma_f32_32x32x16_bf16 v[84:99], v[208:211], v[144:147], v[84:99]
    v_cvt_pk_bf16_f32 v139, v218, v219
    v_add_f32 v226, v223, v224
    v_cmp_lt_f32 vcc, 256.0, v226
    ds_read_b128 v[176:179], v235 offset:16384
    s_cbranch_vccnz attn_fix_12
attn_ret_12:
    v_add_f32 v221, v221, v223
    v_add_f32 v222, v222, v224
    s_waitcnt lgkmcnt(7)
    v_mfma_f32_32x32x16_bf16 v[100:115], v[148:151], v[4:7], 0
    v_fma_f32 v212, v116, s20, -v220
    v_fma_f32 v213, v117, s20, -v220
    v_fma_f32 v214, v118, s20, -v220
    v_fma_f32 v215, v119, s20, -v220
    ds_read_b64_tr_b16 v[180:181], v236
    ds_read_b64_tr_b16 v[182:183], v236 offset:2048
    s_waitcnt lgkmcnt(8)
    v_mfma_f32_32x32x16_bf16 v[100:115], v[152:155], v[8:11], v[100:115]
    v_exp_f32 v212, v212
    v_exp_f32 v213, v213
    v_exp_f32 v214, v214
    ds_read_b64_tr_b16 v[184:185], v236 offset:4096
    ds_read_b64_tr_b16 v[186:187], v236 offset:6144
    s_waitcnt lgkmcnt(9)
    v_mfma_f32_32x32x16_bf16 v[100:115], v[156:159], v[12:15], v[100:115]
    v_exp_f32 v215, v215
    v_fma_f32 v216, v120, s20, -v220
    v_fma_f32 v217, v121, s20, -v220
    v_fma_f32 v218, v122, s20, -v220
    ds_read_b64_tr_b16 v[188:189], v237
    ds_read_b64_tr_b16 v[190:191], v237 offset:2048
    s_waitcnt lgkmcnt(10)
    v_mfma_f32_32x32x16_bf16 v[100:115], v[160:163], v[16:19], v[100:115]
    v_fma_f32 v219, v123, s20, -v220
    v_exp_f32 v216, v216
    v_exp_f32 v217, v217
    ds_read_b64_tr_b16 v[192:193], v237 offset:4096
    ds_read_b64_tr_b16 v[194:195], v237 offset:6144
    s_waitcnt lgkmcnt(11)
    v_mfma_f32_32x32x16_bf16 v[100:115], v[164:167], v[20:23], v[100:115]
    v_exp_f32 v218, v218
    v_exp_f32 v219, v219
    v_add_f32 v223, v212, v213
    v_add_f32 v224, v214, v215
    ds_read_b64_tr_b16 v[196:197], v238
    ds_read_b64_tr_b16 v[198:199], v238 offset:2048
    s_waitcnt lgkmcnt(12)
    v_mfma_f32_32x32x16_bf16 v[100:115], v[168:171], v[24:27], v[100:115]
    v_cvt_pk_bf16_f32 v140, v212, v213
    v_cvt_pk_bf16_f32 v141, v214, v215
    v_fma_f32 v212, v124, s20, -v220
    ds_read_b64_tr_b16 v[200:201], v238 offset:4096
    ds_read_b64_tr_b16 v[202:203], v238 offset:6144
    s_waitcnt lgkmcnt(13)
    v_mfma_f32_32x32x16_bf16 v[100:115], v[172:175], v[28:31], v[100:115]
    v_fma_f32 v213, v125, s20, -v220
    v_fma_f32 v214, v126, s20, -v220
    v_fma_f32 v215, v127, s20, -v220
    v_exp_f32 v212, v212
    ds_read_b64_tr_b16 v[204:205], v239
    ds_read_b64_tr_b16 v[206:207], v239 offset:2048
    s_waitcnt lgkmcnt(14)
    v_mfma_f32_32x32x16_bf16 v[100:115], v[176:179], v[32:35], v[100:115]
    v_exp_f32 v213, v213
    v_exp_f32 v214, v214
    v_exp_f32 v215, v215
    ds_read_b64_tr_b16 v[208:209], v239 offset:4096
    ds_read_b64_tr_b16 v[210:211], v239 offset:6144
    s_waitcnt lgkmcnt(14)
    v_mfma_f32_32x32x16_bf16 v[36:51], v[180:183], v[132:135], v[36:51]
    v_add_f32 v223, v223, v216
    v_add_f32 v224, v224, v217
    v_add_f32 v223, v223, v218
    v_add_f32 v224, v224, v219
    ds_read_b128 v[148:151], v228 offset:24576
    s_waitcnt lgkmcnt(11)
    v_mfma_f32_32x32x16_bf16 v[52:67], v[188:191], v[132:135], v[52:67]
    v_cvt_pk_bf16_f32 v142, v216, v217
    v_cvt_pk_bf16_f32 v143, v218, v219
    v_fma_f32 v216, v128, s20, -v220
    ds_read_b128 v[152:155], v229 offset:24576
    s_waitcnt lgkmcnt(8)
    v_mfma_f32_32x32x16_bf16 v[68:83], v[196:199], v[132:135], v[68:83]
    v_fma_f32 v217, v129, s20, -v220
    v_fma_f32 v218, v130, s20, -v220
    v_fma_f32 v219, v131, s20, -v220
    v_exp_f32 v216, v216
    ds_read_b128 v[156:159], v230 offset:24576
    s_waitcnt lgkmcnt(5)
    v_mfma_f32_32x32x16_bf16 v[84:99], v[204:207], v[132:135], v[84:99]
    v_exp_f32 v217, v217
    v_exp_f32 v218, v218
    v_exp_f32 v219, v219
    ds_read_b128 v[160:163], v231 offset:24576
    v_mfma_f32_32x32x16_bf16 v[36:51], v[184:187], v[136:139], v[36:51]
    v_add_f32 v223, v223, v212
    v_add_f32 v224, v224, v213
    v_add_f32 v223, v223, v214
    v_add_f32 v224, v224, v215
    ds_read_b128 v[164:167], v232 offset:24576
    v_mfma_f32_32x32x16_bf16 v[52:67], v[192:195], v[136:139], v[52:67]
    v_cvt_pk_bf16_f32 v144, v212, v213
    v_cvt_pk_bf16_f32 v145, v214, v215
    v_add_f32 v223, v223, v216
    ds_read_b128 v[168:171], v233 offset:24576
    v_mfma_f32_32x32x16_bf16 v[68:83], v[200:203], v[136:139], v[68:83]
    v_add_f32 v224, v224, v217
    v_add_f32 v223, v223, v218
    v_add_f32 v224, v224, v219
    v_cvt_pk_bf16_f32 v146, v216, v217
    ds_read_b128 v[172:175], v234 offset:24576
    s_waitcnt lgkmcnt(7)
    v_mfma_f32_32x32x16_bf16 v[84:99], v[208:211], v[136:139], v[84:99]
    v_cvt_pk_bf16_f32 v147, v218, v219
    v_add_f32 v226, v223, v224
    v_cmp_lt_f32 vcc, 256.0, v226
    ds_read_b128 v[176:179], v235 offset:24576
    s_cbranch_vccnz attn_fix_13
attn_ret_13:
    v_add_f32 v221, v221, v223
    v_add_f32 v222, v222, v224
    s_waitcnt vmcnt(0) lgkmcnt(0)
    s_barrier
    v_mfma_f32_32x32x16_bf16 v[116:131], v[148:151], v[4:7], 0
    v_fma_f32 v212, v100, s20, -v220
    v_fma_f32 v213, v101, s20, -v220
    v_fma_f32 v214, v102, s20, -v220
    v_fma_f32 v215, v103, s20, -v220
    ds_read_b64_tr_b16 v[180:181], v236 offset:8192
    ds_read_b64_tr_b16 v[182:183], v236 offset:10240
    v_mfma_f32_32x32x16_bf16 v[116:131], v[152:155], v[8:11], v[116:131]
    v_exp_f32 v212, v212
    v_exp_f32 v213, v213
    v_exp_f32 v214, v214
    ds_read_b64_tr_b16 v[184:185], v236 offset:12288
    ds_read_b64_tr_b16 v[186:187], v236 offset:14336
    v_mfma_f32_32x32x16_bf16 v[116:131], v[156:159], v[12:15], v[116:131]
    v_exp_f32 v215, v215
    v_fma_f32 v216, v104, s20, -v220
    v_fma_f32 v217, v105, s20, -v220
    v_fma_f32 v218, v106, s20, -v220
    ds_read_b64_tr_b16 v[188:189], v237 offset:8192
    ds_read_b64_tr_b16 v[190:191], v237 offset:10240
    v_mfma_f32_32x32x16_bf16 v[116:131], v[160:163], v[16:19], v[116:131]
    v_fma_f32 v219, v107, s20, -v220
    v_exp_f32 v216, v216
    v_exp_f32 v217, v217
    ds_read_b64_tr_b16 v[192:193], v237 offset:12288
    ds_read_b64_tr_b16 v[194:195], v237 offset:14336
    v_mfma_f32_32x32x16_bf16 v[116:131], v[164:167], v[20:23], v[116:131]
    v_exp_f32 v218, v218
    v_exp_f32 v219, v219
    v_add_f32 v223, v212, v213
    v_add_f32 v224, v214, v215
    ds_read_b64_tr_b16 v[196:197], v238 offset:8192
    ds_read_b64_tr_b16 v[198:199], v238 offset:10240
    v_mfma_f32_32x32x16_bf16 v[116:131], v[168:171], v[24:27], v[116:131]
    v_cvt_pk_bf16_f32 v132, v212, v213
    v_cvt_pk_bf16_f32 v133, v214, v215
    v_fma_f32 v212, v108, s20, -v220
    ds_read_b64_tr_b16 v[200:201], v238 offset:12288
    ds_read_b64_tr_b16 v[202:203], v238 offset:14336
    v_mfma_f32_32x32x16_bf16 v[116:131], v[172:175], v[28:31], v[116:131]
    v_fma_f32 v213, v109, s20, -v220
    v_fma_f32 v214, v110, s20, -v220
    v_fma_f32 v215, v111, s20, -v220
    v_exp_f32 v212, v212
    ds_read_b64_tr_b16 v[204:205], v239 offset:8192
    ds_read_b64_tr_b16 v[206:207], v239 offset:10240
    v_mfma_f32_32x32x16_bf16 v[116:131], v[176:179], v[32:35], v[116:131]
    v_exp_f32 v213, v213
    v_exp_f32 v214, v214
    v_exp_f32 v215, v215
    ds_read_b64_tr_b16 v[208:209], v239 offset:12288
    ds_read_b64_tr_b16 v[210:211], v239 offset:14336
    s_waitcnt lgkmcnt(14)
    v_mfma_f32_32x32x16_bf16 v[36:51], v[180:183], v[140:143], v[36:51]
    v_add_f32 v223, v223, v216
    v_add_f32 v224, v224, v217
    v_add_f32 v223, v223, v218
    v_add_f32 v224, v224, v219
    s_waitcnt lgkmcnt(10)
    v_mfma_f32_32x32x16_bf16 v[52:67], v[188:191], v[140:143], v[52:67]
    v_cvt_pk_bf16_f32 v134, v216, v217
    v_cvt_pk_bf16_f32 v135, v218, v219
    v_fma_f32 v216, v112, s20, -v220
    s_waitcnt lgkmcnt(6)
    v_mfma_f32_32x32x16_bf16 v[68:83], v[196:199], v[140:143], v[68:83]
    v_fma_f32 v217, v113, s20, -v220
    v_fma_f32 v218, v114, s20, -v220
    v_fma_f32 v219, v115, s20, -v220
    v_exp_f32 v216, v216
    s_waitcnt lgkmcnt(2)
    v_mfma_f32_32x32x16_bf16 v[84:99], v[204:207], v[140:143], v[84:99]
    v_exp_f32 v217, v217
    v_exp_f32 v218, v218
    v_exp_f32 v219, v219
    v_mfma_f32_32x32x16_bf16 v[36:51], v[184:187], v[144:147], v[36:51]
    v_add_f32 v223, v223, v212
    v_add_f32 v224, v224, v213
    v_add_f32 v223, v223, v214
    v_add_f32 v224, v224, v215
    v_mfma_f32_32x32x16_bf16 v[52:67], v[192:195], v[144:147], v[52:67]
    v_cvt_pk_bf16_f32 v136, v212, v213
    v_cvt_pk_bf16_f32 v137, v214, v215
    v_add_f32 v223, v223, v216
    v_mfma_f32_32x32x16_bf16 v[68:83], v[200:203], v[144:147], v[68:83]
    v_add_f32 v224, v224, v217
    v_add_f32 v223, v223, v218
    v_add_f32 v224, v224, v219
    v_cvt_pk_bf16_f32 v138, v216, v217
    s_waitcnt lgkmcnt(0)
    v_mfma_f32_32x32x16_bf16 v[84:99], v[208:211], v[144:147], v[84:99]
    v_cvt_pk_bf16_f32 v139, v218, v219
    v_add_f32 v226, v223, v224
    v_cmp_lt_f32 vcc, 256.0, v226
    s_cbranch_vccnz attn_fix_14
attn_ret_14:
    v_add_f32 v221, v221, v223
    v_add_f32 v222, v222, v224
    ds_read_b64_tr_b16 v[180:181], v236 offset:16384
    ds_read_b64_tr_b16 v[182:183], v236 offset:18432
    ds_read_b64_tr_b16 v[184:185], v236 offset:20480
    ds_read_b64_tr_b16 v[186:187], v236 offset:22528
    ds_read_b64_tr_b16 v[188:189], v237 offset:16384
    ds_read_b64_tr_b16 v[190:191], v237 offset:18432
    ds_read_b64_tr_b16 v[192:193], v237 offset:20480
    ds_read_b64_tr_b16 v[194:195], v237 offset:22528
    ds_read_b64_tr_b16 v[196:197], v238 offset:16384
    ds_read_b64_tr_b16 v[198:199], v238 offset:18432
    ds_read_b64_tr_b16 v[200:201], v238 offset:20480
    ds_read_b64_tr_b16 v[202:203], v238 offset:22528
    ds_read_b64_tr_b16 v[204:205], v239 offset:16384
    ds_read_b64_tr_b16 v[206:207], v239 offset:18432
    ds_read_b64_tr_b16 v[208:209], v239 offset:20480
    ds_read_b64_tr_b16 v[210:211], v239 offset:22528
    s_waitcnt lgkmcnt(14)
    v_mfma_f32_32x32x16_bf16 v[36:51], v[180:183], v[132:135], v[36:51]
    v_fma_f32 v212, v116, s20, -v220
    v_fma_f32 v213, v117, s20, -v220
    v_fma_f32 v214, v118, s20, -v220
    v_fma_f32 v215, v119, s20, -v220
    v_exp_f32 v212, v212
    v_exp_f32 v213, v213
    v_exp_f32 v214, v214
    s_waitcnt lgkmcnt(10)
    v_mfma_f32_32x32x16_bf16 v[52:67], v[188:191], v[132:135], v[52:67]
    v_exp_f32 v215, v215
    v_fma_f32 v216, v120, s20, -v220
    v_fma_f32 v217, v121, s20, -v220
    v_fma_f32 v218, v122, s20, -v220
    v_fma_f32 v219, v123, s20, -v220
    v_exp_f32 v216, v216
    v_exp_f32 v217, v217
    s_waitcnt lgkmcnt(6)
    v_mfma_f32_32x32x16_bf16 v[68:83], v[196:199], v[132:135], v[68:83]
    v_exp_f32 v218, v218
    v_exp_f32 v219, v219
    v_add_f32 v223, v212, v213
    v_add_f32 v224, v214, v215
    v_cvt_pk_bf16_f32 v140, v212, v213
    v_cvt_pk_bf16_f32 v141, v214, v215
    v_fma_f32 v212, v124, s20, -v220
    s_waitcnt lgkmcnt(2)
    v_mfma_f32_32x32x16_bf16 v[84:99], v[204:207], v[132:135], v[84:99]
    v_fma_f32 v213, v125, s20, -v220
    v_fma_f32 v214, v126, s20, -v220
    v_fma_f32 v215, v127, s20, -v220
    v_exp_f32 v212, v212
    v_exp_f32 v213, v213
    v_exp_f32 v214, v214
    v_exp_f32 v215, v215
    v_mfma_f32_32x32x16_bf16 v[36:51], v[184:187], v[136:139], v[36:51]
    v_add_f32 v223, v223, v216
    v_add_f32 v224, v224, v217
    v_add_f32 v223, v223, v218
    v_add_f32 v224, v224, v219
    v_cvt_pk_bf16_f32 v142, v216, v217
    v_cvt_pk_bf16_f32 v143, v218, v219
    v_fma_f32 v216, v128, s20, -v220
    v_mfma_f32_32x32x16_bf16 v[52:67], v[192:195], v[136:139], v[52:67]
    v_fma_f32 v217, v129, s20, -v220
    v_fma_f32 v218, v130, s20, -v220
    v_fma_f32 v219, v131, s20, -v220
    v_exp_f32 v216, v216
    v_exp_f32 v217, v217
    v_exp_f32 v218, v218
    v_exp_f32 v219, v219
    v_mfma_f32_32x32x16_bf16 v[68:83], v[200:203], v[136:139], v[68:83]
    v_add_f32 v223, v223, v212
    v_add_f32 v224, v224, v213
    v_add_f32 v223, v223, v214
    v_add_f32 v224, v224, v215
    v_cvt_pk_bf16_f32 v144, v212, v213
    v_cvt_pk_bf16_f32 v145, v214, v215
    v_add_f32 v223, v223, v216
    s_waitcnt lgkmcnt(0)
    v_mfma_f32_32x32x16_bf16 v[84:99], v[208:211], v[136:139], v[84:99]
    v_add_f32 v224, v224, v217
    v_add_f32 v223, v223, v218
    v_add_f32 v224, v224, v219
    v_cvt_pk_bf16_f32 v146, v216, v217
    v_cvt_pk_bf16_f32 v147, v218, v219
    v_add_f32 v226, v223, v224
    v_cmp_lt_f32 vcc, 256.0, v226
    s_cbranch_vccnz attn_fix_15
attn_ret_15:
    v_add_f32 v221, v221, v223
    v_add_f32 v222, v222, v224
    ds_read_b64_tr_b16 v[180:181], v236 offset:24576
    ds_read_b64_tr_b16 v[182:183], v236 offset:26624
    ds_read_b64_tr_b16 v[184:185], v236 offset:28672
    ds_read_b64_tr_b16 v[186:187], v236 offset:30720
    ds_read_b64_tr_b16 v[188:189], v237 offset:24576
    ds_read_b64_tr_b16 v[190:191], v237 offset:26624
    ds_read_b64_tr_b16 v[192:193], v237 offset:28672
    ds_read_b64_tr_b16 v[194:195], v237 offset:30720
    ds_read_b64_tr_b16 v[196:197], v238 offset:24576
    ds_read_b64_tr_b16 v[198:199], v238 offset:26624
    ds_read_b64_tr_b16 v[200:201], v238 offset:28672
    ds_read_b64_tr_b16 v[202:203], v238 offset:30720
    ds_read_b64_tr_b16 v[204:205], v239 offset:24576
    ds_read_b64_tr_b16 v[206:207], v239 offset:26624
    ds_read_b64_tr_b16 v[208:209], v239 offset:28672
    ds_read_b64_tr_b16 v[210:211], v239 offset:30720
    s_waitcnt lgkmcnt(14)
    v_mfma_f32_32x32x16_bf16 v[36:51], v[180:183], v[140:143], v[36:51]
    s_waitcnt lgkmcnt(10)
    v_mfma_f32_32x32x16_bf16 v[52:67], v[188:191], v[140:143], v[52:67]
    s_waitcnt lgkmcnt(6)
    v_mfma_f32_32x32x16_bf16 v[68:83], v[196:199], v[140:143], v[68:83]
    s_waitcnt lgkmcnt(2)
    v_mfma_f32_32x32x16_bf16 v[84:99], v[204:207], v[140:143], v[84:99]
    v_mfma_f32_32x32x16_bf16 v[36:51], v[184:187], v[144:147], v[36:51]
    v_mfma_f32_32x32x16_bf16 v[52:67], v[192:195], v[144:147], v[52:67]
    v_mfma_f32_32x32x16_bf16 v[68:83], v[200:203], v[144:147], v[68:83]
    s_waitcnt lgkmcnt(0)
    v_mfma_f32_32x32x16_bf16 v[84:99], v[208:211], v[144:147], v[84:99]
    v_add_f32 v221, v221, v222
    v_mov_b32 v226, v221
    s_nop 1
    v_permlane32_swap_b32 v221, v226
    v_add_f32 v221, v221, v226
    v_rcp_f32 v227, v221
    s_nop 0
    v_mul_f32 v100, v36, v227
    v_mul_f32 v101, v37, v227
    v_mul_f32 v102, v38, v227
    v_mul_f32 v103, v39, v227
    v_mul_f32 v104, v40, v227
    v_mul_f32 v105, v41, v227
    v_mul_f32 v106, v42, v227
    v_mul_f32 v107, v43, v227
    v_cvt_pk_bf16_f32 v108, v100, v101
    v_cvt_pk_bf16_f32 v109, v102, v103
    v_cvt_pk_bf16_f32 v110, v104, v105
    v_cvt_pk_bf16_f32 v111, v106, v107
    s_nop 0
    v_permlane32_swap_b32 v108, v110
    v_permlane32_swap_b32 v109, v111
    buffer_store_dwordx4 v[108:111], v244, s[16:19], 0 offen
    v_mul_f32 v112, v44, v227
    v_mul_f32 v113, v45, v227
    v_mul_f32 v114, v46, v227
    v_mul_f32 v115, v47, v227
    v_mul_f32 v116, v48, v227
    v_mul_f32 v117, v49, v227
    v_mul_f32 v118, v50, v227
    v_mul_f32 v119, v51, v227
    v_cvt_pk_bf16_f32 v120, v112, v113
    v_cvt_pk_bf16_f32 v121, v114, v115
    v_cvt_pk_bf16_f32 v122, v116, v117
    v_cvt_pk_bf16_f32 v123, v118, v119
    s_nop 0
    v_permlane32_swap_b32 v120, v122
    v_permlane32_swap_b32 v121, v123
    buffer_store_dwordx4 v[120:123], v244, s[16:19], 0 offen offset:32
    v_mul_f32 v124, v52, v227
    v_mul_f32 v125, v53, v227
    v_mul_f32 v126, v54, v227
    v_mul_f32 v127, v55, v227
    v_mul_f32 v128, v56, v227
    v_mul_f32 v129, v57, v227
    v_mul_f32 v130, v58, v227
    v_mul_f32 v131, v59, v227
    v_cvt_pk_bf16_f32 v132, v124, v125
    v_cvt_pk_bf16_f32 v133, v126, v127
    v_cvt_pk_bf16_f32 v134, v128, v129
    v_cvt_pk_bf16_f32 v135, v130, v131
    s_nop 0
    v_permlane32_swap_b32 v132, v134
    v_permlane32_swap_b32 v133, v135
    buffer_store_dwordx4 v[132:135], v244, s[16:19], 0 offen offset:64
    v_mul_f32 v136, v60, v227
    v_mul_f32 v137, v61, v227
    v_mul_f32 v138, v62, v227
    v_mul_f32 v139, v63, v227
    v_mul_f32 v140, v64, v227
    v_mul_f32 v141, v65, v227
    v_mul_f32 v142, v66, v227
    v_mul_f32 v143, v67, v227
    v_cvt_pk_bf16_f32 v144, v136, v137
    v_cvt_pk_bf16_f32 v145, v138, v139
    v_cvt_pk_bf16_f32 v146, v140, v141
    v_cvt_pk_bf16_f32 v147, v142, v143
    s_nop 0
    v_permlane32_swap_b32 v144, v146
    v_permlane32_swap_b32 v145, v147
    buffer_store_dwordx4 v[144:147], v244, s[16:19], 0 offen offset:96
    v_mul_f32 v100, v68, v227
    v_mul_f32 v101, v69, v227
    v_mul_f32 v102, v70, v227
    v_mul_f32 v103, v71, v227
    v_mul_f32 v104, v72, v227
    v_mul_f32 v105, v73, v227
    v_mul_f32 v106, v74, v227
    v_mul_f32 v107, v75, v227
    v_cvt_pk_bf16_f32 v108, v100, v101
    v_cvt_pk_bf16_f32 v109, v102, v103
    v_cvt_pk_bf16_f32 v110, v104, v105
    v_cvt_pk_bf16_f32 v111, v106, v107
    s_nop 0
    v_permlane32_swap_b32 v108, v110
    v_permlane32_swap_b32 v109, v111
    buffer_store_dwordx4 v[108:111], v244, s[16:19], 0 offen offset:128
    v_mul_f32 v112, v76, v227
    v_mul_f32 v113, v77, v227
    v_mul_f32 v114, v78, v227
    v_mul_f32 v115, v79, v227
    v_mul_f32 v116, v80, v227
    v_mul_f32 v117, v81, v227
    v_mul_f32 v118, v82, v227
    v_mul_f32 v119, v83, v227
    v_cvt_pk_bf16_f32 v120, v112, v113
    v_cvt_pk_bf16_f32 v121, v114, v115
    v_cvt_pk_bf16_f32 v122, v116, v117
    v_cvt_pk_bf16_f32 v123, v118, v119
    s_nop 0
    v_permlane32_swap_b32 v120, v122
    v_permlane32_swap_b32 v121, v123
    buffer_store_dwordx4 v[120:123], v244, s[16:19], 0 offen offset:160
    v_mul_f32 v124, v84, v227
    v_mul_f32 v125, v85, v227
    v_mul_f32 v126, v86, v227
    v_mul_f32 v127, v87, v227
    v_mul_f32 v128, v88, v227
    v_mul_f32 v129, v89, v227
    v_mul_f32 v130, v90, v227
    v_mul_f32 v131, v91, v227
    v_cvt_pk_bf16_f32 v132, v124, v125
    v_cvt_pk_bf16_f32 v133, v126, v127
    v_cvt_pk_bf16_f32 v134, v128, v129
    v_cvt_pk_bf16_f32 v135, v130, v131
    s_nop 0
    v_permlane32_swap_b32 v132, v134
    v_permlane32_swap_b32 v133, v135
    buffer_store_dwordx4 v[132:135], v244, s[16:19], 0 offen offset:192
    v_mul_f32 v136, v92, v227
    v_mul_f32 v137, v93, v227
    v_mul_f32 v138, v94, v227
    v_mul_f32 v139, v95, v227
    v_mul_f32 v140, v96, v227
    v_mul_f32 v141, v97, v227
    v_mul_f32 v142, v98, v227
    v_mul_f32 v143, v99, v227
    v_cvt_pk_bf16_f32 v144, v136, v137
    v_cvt_pk_bf16_f32 v145, v138, v139
    v_cvt_pk_bf16_f32 v146, v140, v141
    v_cvt_pk_bf16_f32 v147, v142, v143
    s_nop 0
    v_permlane32_swap_b32 v144, v146
    v_permlane32_swap_b32 v145, v147
    buffer_store_dwordx4 v[144:147], v244, s[16:19], 0 offen offset:224
    s_branch attn_kernel_end
attn_fix_1:
    s_waitcnt vmcnt(0) lgkmcnt(0)
    s_nop 15
    s_nop 7
    v_max3_f32 v225, v116, v117, v118
    v_max3_f32 v225, v225, v119, v120
    v_max3_f32 v225, v225, v121, v122
    v_max3_f32 v225, v225, v123, v124
    v_max3_f32 v225, v225, v125, v126
    v_max3_f32 v225, v225, v127, v128
    v_max3_f32 v225, v225, v129, v130
    v_max_f32 v225, v225, v131
    v_mov_b32 v226, v225
    s_nop 1
    v_permlane32_swap_b32 v225, v226
    v_max_f32 v225, v225, v226
    v_mul_f32 v226, s20, v225
    v_max_f32 v226, v220, v226
    v_sub_f32 v227, v220, v226
    v_exp_f32 v227, v227
    v_mov_b32 v220, v226
    v_mul_f32 v36, v36, v227
    v_mul_f32 v37, v37, v227
    v_mul_f32 v38, v38, v227
    v_mul_f32 v39, v39, v227
    v_mul_f32 v40, v40, v227
    v_mul_f32 v41, v41, v227
    v_mul_f32 v42, v42, v227
    v_mul_f32 v43, v43, v227
    v_mul_f32 v44, v44, v227
    v_mul_f32 v45, v45, v227
    v_mul_f32 v46, v46, v227
    v_mul_f32 v47, v47, v227
    v_mul_f32 v48, v48, v227
    v_mul_f32 v49, v49, v227
    v_mul_f32 v50, v50, v227
    v_mul_f32 v51, v51, v227
    v_mul_f32 v52, v52, v227
    v_mul_f32 v53, v53, v227
    v_mul_f32 v54, v54, v227
    v_mul_f32 v55, v55, v227
    v_mul_f32 v56, v56, v227
    v_mul_f32 v57, v57, v227
    v_mul_f32 v58, v58, v227
    v_mul_f32 v59, v59, v227
    v_mul_f32 v60, v60, v227
    v_mul_f32 v61, v61, v227
    v_mul_f32 v62, v62, v227
    v_mul_f32 v63, v63, v227
    v_mul_f32 v64, v64, v227
    v_mul_f32 v65, v65, v227
    v_mul_f32 v66, v66, v227
    v_mul_f32 v67, v67, v227
    v_mul_f32 v68, v68, v227
    v_mul_f32 v69, v69, v227
    v_mul_f32 v70, v70, v227
    v_mul_f32 v71, v71, v227
    v_mul_f32 v72, v72, v227
    v_mul_f32 v73, v73, v227
    v_mul_f32 v74, v74, v227
    v_mul_f32 v75, v75, v227
    v_mul_f32 v76, v76, v227
    v_mul_f32 v77, v77, v227
    v_mul_f32 v78, v78, v227
    v_mul_f32 v79, v79, v227
    v_mul_f32 v80, v80, v227
    v_mul_f32 v81, v81, v227
    v_mul_f32 v82, v82, v227
    v_mul_f32 v83, v83, v227
    v_mul_f32 v84, v84, v227
    v_mul_f32 v85, v85, v227
    v_mul_f32 v86, v86, v227
    v_mul_f32 v87, v87, v227
    v_mul_f32 v88, v88, v227
    v_mul_f32 v89, v89, v227
    v_mul_f32 v90, v90, v227
    v_mul_f32 v91, v91, v227
    v_mul_f32 v92, v92, v227
    v_mul_f32 v93, v93, v227
    v_mul_f32 v94, v94, v227
    v_mul_f32 v95, v95, v227
    v_mul_f32 v96, v96, v227
    v_mul_f32 v97, v97, v227
    v_mul_f32 v98, v98, v227
    v_mul_f32 v99, v99, v227
    v_mul_f32 v221, v221, v227
    v_mul_f32 v222, v222, v227
    v_fma_f32 v212, v116, s20, -v220
    v_fma_f32 v213, v117, s20, -v220
    v_fma_f32 v214, v118, s20, -v220
    v_fma_f32 v215, v119, s20, -v220
    v_exp_f32 v212, v212
    v_exp_f32 v213, v213
    v_exp_f32 v214, v214
    v_exp_f32 v215, v215
    v_add_f32 v223, v212, v213
    v_add_f32 v224, v214, v215
    v_cvt_pk_bf16_f32 v140, v212, v213
    v_cvt_pk_bf16_f32 v141, v214, v215
    v_fma_f32 v212, v120, s20, -v220
    v_fma_f32 v213, v121, s20, -v220
    v_fma_f32 v214, v122, s20, -v220
    v_fma_f32 v215, v123, s20, -v220
    v_exp_f32 v212, v212
    v_exp_f32 v213, v213
    v_exp_f32 v214, v214
    v_exp_f32 v215, v215
    v_add_f32 v223, v223, v212
    v_add_f32 v224, v224, v213
    v_add_f32 v223, v223, v214
    v_add_f32 v224, v224, v215
    v_cvt_pk_bf16_f32 v142, v212, v213
    v_cvt_pk_bf16_f32 v143, v214, v215
    v_fma_f32 v212, v124, s20, -v220
    v_fma_f32 v213, v125, s20, -v220
    v_fma_f32 v214, v126, s20, -v220
    v_fma_f32 v215, v127, s20, -v220
    v_exp_f32 v212, v212
    v_exp_f32 v213, v213
    v_exp_f32 v214, v214
    v_exp_f32 v215, v215
    v_add_f32 v223, v223, v212
    v_add_f32 v224, v224, v213
    v_add_f32 v223, v223, v214
    v_add_f32 v224, v224, v215
    v_cvt_pk_bf16_f32 v144, v212, v213
    v_cvt_pk_bf16_f32 v145, v214, v215
    v_fma_f32 v212, v128, s20, -v220
    v_fma_f32 v213, v129, s20, -v220
    v_fma_f32 v214, v130, s20, -v220
    v_fma_f32 v215, v131, s20, -v220
    v_exp_f32 v212, v212
    v_exp_f32 v213, v213
    v_exp_f32 v214, v214
    v_exp_f32 v215, v215
    v_add_f32 v223, v223, v212
    v_add_f32 v224, v224, v213
    v_add_f32 v223, v223, v214
    v_add_f32 v224, v224, v215
    v_cvt_pk_bf16_f32 v146, v212, v213
    v_cvt_pk_bf16_f32 v147, v214, v215
    s_nop 3
    s_branch attn_ret_1
attn_fix_2:
    s_waitcnt vmcnt(0) lgkmcnt(0)
    s_nop 15
    s_nop 7
    v_max3_f32 v225, v100, v101, v102
    v_max3_f32 v225, v225, v103, v104
    v_max3_f32 v225, v225, v105, v106
    v_max3_f32 v225, v225, v107, v108
    v_max3_f32 v225, v225, v109, v110
    v_max3_f32 v225, v225, v111, v112
    v_max3_f32 v225, v225, v113, v114
    v_max_f32 v225, v225, v115
    v_mov_b32 v226, v225
    s_nop 1
    v_permlane32_swap_b32 v225, v226
    v_max_f32 v225, v225, v226
    v_mul_f32 v226, s20, v225
    v_max_f32 v226, v220, v226
    v_sub_f32 v227, v220, v226
    v_exp_f32 v227, v227
    v_mov_b32 v220, v226
    v_mul_f32 v36, v36, v227
    v_mul_f32 v37, v37, v227
    v_mul_f32 v38, v38, v227
    v_mul_f32 v39, v39, v227
    v_mul_f32 v40, v40, v227
    v_mul_f32 v41, v41, v227
    v_mul_f32 v42, v42, v227
    v_mul_f32 v43, v43, v227
    v_mul_f32 v44, v44, v227
    v_mul_f32 v45, v45, v227
    v_mul_f32 v46, v46, v227
    v_mul_f32 v47, v47, v227
    v_mul_f32 v48, v48, v227
    v_mul_f32 v49, v49, v227
    v_mul_f32 v50, v50, v227
    v_mul_f32 v51, v51, v227
    v_mul_f32 v52, v52, v227
    v_mul_f32 v53, v53, v227
    v_mul_f32 v54, v54, v227
    v_mul_f32 v55, v55, v227
    v_mul_f32 v56, v56, v227
    v_mul_f32 v57, v57, v227
    v_mul_f32 v58, v58, v227
    v_mul_f32 v59, v59, v227
    v_mul_f32 v60, v60, v227
    v_mul_f32 v61, v61, v227
    v_mul_f32 v62, v62, v227
    v_mul_f32 v63, v63, v227
    v_mul_f32 v64, v64, v227
    v_mul_f32 v65, v65, v227
    v_mul_f32 v66, v66, v227
    v_mul_f32 v67, v67, v227
    v_mul_f32 v68, v68, v227
    v_mul_f32 v69, v69, v227
    v_mul_f32 v70, v70, v227
    v_mul_f32 v71, v71, v227
    v_mul_f32 v72, v72, v227
    v_mul_f32 v73, v73, v227
    v_mul_f32 v74, v74, v227
    v_mul_f32 v75, v75, v227
    v_mul_f32 v76, v76, v227
    v_mul_f32 v77, v77, v227
    v_mul_f32 v78, v78, v227
    v_mul_f32 v79, v79, v227
    v_mul_f32 v80, v80, v227
    v_mul_f32 v81, v81, v227
    v_mul_f32 v82, v82, v227
    v_mul_f32 v83, v83, v227
    v_mul_f32 v84, v84, v227
    v_mul_f32 v85, v85, v227
    v_mul_f32 v86, v86, v227
    v_mul_f32 v87, v87, v227
    v_mul_f32 v88, v88, v227
    v_mul_f32 v89, v89, v227
    v_mul_f32 v90, v90, v227
    v_mul_f32 v91, v91, v227
    v_mul_f32 v92, v92, v227
    v_mul_f32 v93, v93, v227
    v_mul_f32 v94, v94, v227
    v_mul_f32 v95, v95, v227
    v_mul_f32 v96, v96, v227
    v_mul_f32 v97, v97, v227
    v_mul_f32 v98, v98, v227
    v_mul_f32 v99, v99, v227
    v_mul_f32 v221, v221, v227
    v_mul_f32 v222, v222, v227
    v_fma_f32 v212, v100, s20, -v220
    v_fma_f32 v213, v101, s20, -v220
    v_fma_f32 v214, v102, s20, -v220
    v_fma_f32 v215, v103, s20, -v220
    v_exp_f32 v212, v212
    v_exp_f32 v213, v213
    v_exp_f32 v214, v214
    v_exp_f32 v215, v215
    v_add_f32 v223, v212, v213
    v_add_f32 v224, v214, v215
    v_cvt_pk_bf16_f32 v132, v212, v213
    v_cvt_pk_bf16_f32 v133, v214, v215
    v_fma_f32 v212, v104, s20, -v220
    v_fma_f32 v213, v105, s20, -v220
    v_fma_f32 v214, v106, s20, -v220
    v_fma_f32 v215, v107, s20, -v220
    v_exp_f32 v212, v212
    v_exp_f32 v213, v213
    v_exp_f32 v214, v214
    v_exp_f32 v215, v215
    v_add_f32 v223, v223, v212
    v_add_f32 v224, v224, v213
    v_add_f32 v223, v223, v214
    v_add_f32 v224, v224, v215
    v_cvt_pk_bf16_f32 v134, v212, v213
    v_cvt_pk_bf16_f32 v135, v214, v215
    v_fma_f32 v212, v108, s20, -v220
    v_fma_f32 v213, v109, s20, -v220
    v_fma_f32 v214, v110, s20, -v220
    v_fma_f32 v215, v111, s20, -v220
    v_exp_f32 v212, v212
    v_exp_f32 v213, v213
    v_exp_f32 v214, v214
    v_exp_f32 v215, v215
    v_add_f32 v223, v223, v212
    v_add_f32 v224, v224, v213
    v_add_f32 v223, v223, v214
    v_add_f32 v224, v224, v215
    v_cvt_pk_bf16_f32 v136, v212, v213
    v_cvt_pk_bf16_f32 v137, v214, v215
    v_fma_f32 v212, v112, s20, -v220
    v_fma_f32 v213, v113, s20, -v220
    v_fma_f32 v214, v114, s20, -v220
    v_fma_f32 v215, v115, s20, -v220
    v_exp_f32 v212, v212
    v_exp_f32 v213, v213
    v_exp_f32 v214, v214
    v_exp_f32 v215, v215
    v_add_f32 v223, v223, v212
    v_add_f32 v224, v224, v213
    v_add_f32 v223, v223, v214
    v_add_f32 v224, v224, v215
    v_cvt_pk_bf16_f32 v138, v212, v213
    v_cvt_pk_bf16_f32 v139, v214, v215
    s_nop 3
    s_branch attn_ret_2
attn_fix_3:
    s_waitcnt vmcnt(0) lgkmcnt(0)
    s_nop 15
    s_nop 7
    v_max3_f32 v225, v116, v117, v118
    v_max3_f32 v225, v225, v119, v120
    v_max3_f32 v225, v225, v121, v122
    v_max3_f32 v225, v225, v123, v124
    v_max3_f32 v225, v225, v125, v126
    v_max3_f32 v225, v225, v127, v128
    v_max3_f32 v225, v225, v129, v130
    v_max_f32 v225, v225, v131
    v_mov_b32 v226, v225
    s_nop 1
    v_permlane32_swap_b32 v225, v226
    v_max_f32 v225, v225, v226
    v_mul_f32 v226, s20, v225
    v_max_f32 v226, v220, v226
    v_sub_f32 v227, v220, v226
    v_exp_f32 v227, v227
    v_mov_b32 v220, v226
    v_mul_f32 v36, v36, v227
    v_mul_f32 v37, v37, v227
    v_mul_f32 v38, v38, v227
    v_mul_f32 v39, v39, v227
    v_mul_f32 v40, v40, v227
    v_mul_f32 v41, v41, v227
    v_mul_f32 v42, v42, v227
    v_mul_f32 v43, v43, v227
    v_mul_f32 v44, v44, v227
    v_mul_f32 v45, v45, v227
    v_mul_f32 v46, v46, v227
    v_mul_f32 v47, v47, v227
    v_mul_f32 v48, v48, v227
    v_mul_f32 v49, v49, v227
    v_mul_f32 v50, v50, v227
    v_mul_f32 v51, v51, v227
    v_mul_f32 v52, v52, v227
    v_mul_f32 v53, v53, v227
    v_mul_f32 v54, v54, v227
    v_mul_f32 v55, v55, v227
    v_mul_f32 v56, v56, v227
    v_mul_f32 v57, v57, v227
    v_mul_f32 v58, v58, v227
    v_mul_f32 v59, v59, v227
    v_mul_f32 v60, v60, v227
    v_mul_f32 v61, v61, v227
    v_mul_f32 v62, v62, v227
    v_mul_f32 v63, v63, v227
    v_mul_f32 v64, v64, v227
    v_mul_f32 v65, v65, v227
    v_mul_f32 v66, v66, v227
    v_mul_f32 v67, v67, v227
    v_mul_f32 v68, v68, v227
    v_mul_f32 v69, v69, v227
    v_mul_f32 v70, v70, v227
    v_mul_f32 v71, v71, v227
    v_mul_f32 v72, v72, v227
    v_mul_f32 v73, v73, v227
    v_mul_f32 v74, v74, v227
    v_mul_f32 v75, v75, v227
    v_mul_f32 v76, v76, v227
    v_mul_f32 v77, v77, v227
    v_mul_f32 v78, v78, v227
    v_mul_f32 v79, v79, v227
    v_mul_f32 v80, v80, v227
    v_mul_f32 v81, v81, v227
    v_mul_f32 v82, v82, v227
    v_mul_f32 v83, v83, v227
    v_mul_f32 v84, v84, v227
    v_mul_f32 v85, v85, v227
    v_mul_f32 v86, v86, v227
    v_mul_f32 v87, v87, v227
    v_mul_f32 v88, v88, v227
    v_mul_f32 v89, v89, v227
    v_mul_f32 v90, v90, v227
    v_mul_f32 v91, v91, v227
    v_mul_f32 v92, v92, v227
    v_mul_f32 v93, v93, v227
    v_mul_f32 v94, v94, v227
    v_mul_f32 v95, v95, v227
    v_mul_f32 v96, v96, v227
    v_mul_f32 v97, v97, v227
    v_mul_f32 v98, v98, v227
    v_mul_f32 v99, v99, v227
    v_mul_f32 v221, v221, v227
    v_mul_f32 v222, v222, v227
    v_fma_f32 v212, v116, s20, -v220
    v_fma_f32 v213, v117, s20, -v220
    v_fma_f32 v214, v118, s20, -v220
    v_fma_f32 v215, v119, s20, -v220
    v_exp_f32 v212, v212
    v_exp_f32 v213, v213
    v_exp_f32 v214, v214
    v_exp_f32 v215, v215
    v_add_f32 v223, v212, v213
    v_add_f32 v224, v214, v215
    v_cvt_pk_bf16_f32 v140, v212, v213
    v_cvt_pk_bf16_f32 v141, v214, v215
    v_fma_f32 v212, v120, s20, -v220
    v_fma_f32 v213, v121, s20, -v220
    v_fma_f32 v214, v122, s20, -v220
    v_fma_f32 v215, v123, s20, -v220
    v_exp_f32 v212, v212
    v_exp_f32 v213, v213
    v_exp_f32 v214, v214
    v_exp_f32 v215, v215
    v_add_f32 v223, v223, v212
    v_add_f32 v224, v224, v213
    v_add_f32 v223, v223, v214
    v_add_f32 v224, v224, v215
    v_cvt_pk_bf16_f32 v142, v212, v213
    v_cvt_pk_bf16_f32 v143, v214, v215
    v_fma_f32 v212, v124, s20, -v220
    v_fma_f32 v213, v125, s20, -v220
    v_fma_f32 v214, v126, s20, -v220
    v_fma_f32 v215, v127, s20, -v220
    v_exp_f32 v212, v212
    v_exp_f32 v213, v213
    v_exp_f32 v214, v214
    v_exp_f32 v215, v215
    v_add_f32 v223, v223, v212
    v_add_f32 v224, v224, v213
    v_add_f32 v223, v223, v214
    v_add_f32 v224, v224, v215
    v_cvt_pk_bf16_f32 v144, v212, v213
    v_cvt_pk_bf16_f32 v145, v214, v215
    v_fma_f32 v212, v128, s20, -v220
    v_fma_f32 v213, v129, s20, -v220
    v_fma_f32 v214, v130, s20, -v220
    v_fma_f32 v215, v131, s20, -v220
    v_exp_f32 v212, v212
    v_exp_f32 v213, v213
    v_exp_f32 v214, v214
    v_exp_f32 v215, v215
    v_add_f32 v223, v223, v212
    v_add_f32 v224, v224, v213
    v_add_f32 v223, v223, v214
    v_add_f32 v224, v224, v215
    v_cvt_pk_bf16_f32 v146, v212, v213
    v_cvt_pk_bf16_f32 v147, v214, v215
    s_nop 3
    s_branch attn_ret_3
attn_fix_4:
    s_waitcnt vmcnt(0) lgkmcnt(0)
    s_nop 15
    s_nop 7
    v_max3_f32 v225, v100, v101, v102
    v_max3_f32 v225, v225, v103, v104
    v_max3_f32 v225, v225, v105, v106
    v_max3_f32 v225, v225, v107, v108
    v_max3_f32 v225, v225, v109, v110
    v_max3_f32 v225, v225, v111, v112
    v_max3_f32 v225, v225, v113, v114
    v_max_f32 v225, v225, v115
    v_mov_b32 v226, v225
    s_nop 1
    v_permlane32_swap_b32 v225, v226
    v_max_f32 v225, v225, v226
    v_mul_f32 v226, s20, v225
    v_max_f32 v226, v220, v226
    v_sub_f32 v227, v220, v226
    v_exp_f32 v227, v227
    v_mov_b32 v220, v226
    v_mul_f32 v36, v36, v227
    v_mul_f32 v37, v37, v227
    v_mul_f32 v38, v38, v227
    v_mul_f32 v39, v39, v227
    v_mul_f32 v40, v40, v227
    v_mul_f32 v41, v41, v227
    v_mul_f32 v42, v42, v227
    v_mul_f32 v43, v43, v227
    v_mul_f32 v44, v44, v227
    v_mul_f32 v45, v45, v227
    v_mul_f32 v46, v46, v227
    v_mul_f32 v47, v47, v227
    v_mul_f32 v48, v48, v227
    v_mul_f32 v49, v49, v227
    v_mul_f32 v50, v50, v227
    v_mul_f32 v51, v51, v227
    v_mul_f32 v52, v52, v227
    v_mul_f32 v53, v53, v227
    v_mul_f32 v54, v54, v227
    v_mul_f32 v55, v55, v227
    v_mul_f32 v56, v56, v227
    v_mul_f32 v57, v57, v227
    v_mul_f32 v58, v58, v227
    v_mul_f32 v59, v59, v227
    v_mul_f32 v60, v60, v227
    v_mul_f32 v61, v61, v227
    v_mul_f32 v62, v62, v227
    v_mul_f32 v63, v63, v227
    v_mul_f32 v64, v64, v227
    v_mul_f32 v65, v65, v227
    v_mul_f32 v66, v66, v227
    v_mul_f32 v67, v67, v227
    v_mul_f32 v68, v68, v227
    v_mul_f32 v69, v69, v227
    v_mul_f32 v70, v70, v227
    v_mul_f32 v71, v71, v227
    v_mul_f32 v72, v72, v227
    v_mul_f32 v73, v73, v227
    v_mul_f32 v74, v74, v227
    v_mul_f32 v75, v75, v227
    v_mul_f32 v76, v76, v227
    v_mul_f32 v77, v77, v227
    v_mul_f32 v78, v78, v227
    v_mul_f32 v79, v79, v227
    v_mul_f32 v80, v80, v227
    v_mul_f32 v81, v81, v227
    v_mul_f32 v82, v82, v227
    v_mul_f32 v83, v83, v227
    v_mul_f32 v84, v84, v227
    v_mul_f32 v85, v85, v227
    v_mul_f32 v86, v86, v227
    v_mul_f32 v87, v87, v227
    v_mul_f32 v88, v88, v227
    v_mul_f32 v89, v89, v227
    v_mul_f32 v90, v90, v227
    v_mul_f32 v91, v91, v227
    v_mul_f32 v92, v92, v227
    v_mul_f32 v93, v93, v227
    v_mul_f32 v94, v94, v227
    v_mul_f32 v95, v95, v227
    v_mul_f32 v96, v96, v227
    v_mul_f32 v97, v97, v227
    v_mul_f32 v98, v98, v227
    v_mul_f32 v99, v99, v227
    v_mul_f32 v221, v221, v227
    v_mul_f32 v222, v222, v227
    v_fma_f32 v212, v100, s20, -v220
    v_fma_f32 v213, v101, s20, -v220
    v_fma_f32 v214, v102, s20, -v220
    v_fma_f32 v215, v103, s20, -v220
    v_exp_f32 v212, v212
    v_exp_f32 v213, v213
    v_exp_f32 v214, v214
    v_exp_f32 v215, v215
    v_add_f32 v223, v212, v213
    v_add_f32 v224, v214, v215
    v_cvt_pk_bf16_f32 v132, v212, v213
    v_cvt_pk_bf16_f32 v133, v214, v215
    v_fma_f32 v212, v104, s20, -v220
    v_fma_f32 v213, v105, s20, -v220
    v_fma_f32 v214, v106, s20, -v220
    v_fma_f32 v215, v107, s20, -v220
    v_exp_f32 v212, v212
    v_exp_f32 v213, v213
    v_exp_f32 v214, v214
    v_exp_f32 v215, v215
    v_add_f32 v223, v223, v212
    v_add_f32 v224, v224, v213
    v_add_f32 v223, v223, v214
    v_add_f32 v224, v224, v215
    v_cvt_pk_bf16_f32 v134, v212, v213
    v_cvt_pk_bf16_f32 v135, v214, v215
    v_fma_f32 v212, v108, s20, -v220
    v_fma_f32 v213, v109, s20, -v220
    v_fma_f32 v214, v110, s20, -v220
    v_fma_f32 v215, v111, s20, -v220
    v_exp_f32 v212, v212
    v_exp_f32 v213, v213
    v_exp_f32 v214, v214
    v_exp_f32 v215, v215
    v_add_f32 v223, v223, v212
    v_add_f32 v224, v224, v213
    v_add_f32 v223, v223, v214
    v_add_f32 v224, v224, v215
    v_cvt_pk_bf16_f32 v136, v212, v213
    v_cvt_pk_bf16_f32 v137, v214, v215
    v_fma_f32 v212, v112, s20, -v220
    v_fma_f32 v213, v113, s20, -v220
    v_fma_f32 v214, v114, s20, -v220
    v_fma_f32 v215, v115, s20, -v220
    v_exp_f32 v212, v212
    v_exp_f32 v213, v213
    v_exp_f32 v214, v214
    v_exp_f32 v215, v215
    v_add_f32 v223, v223, v212
    v_add_f32 v224, v224, v213
    v_add_f32 v223, v223, v214
    v_add_f32 v224, v224, v215
    v_cvt_pk_bf16_f32 v138, v212, v213
    v_cvt_pk_bf16_f32 v139, v214, v215
    s_nop 3
    s_branch attn_ret_4
attn_fix_5:
    s_waitcnt vmcnt(0) lgkmcnt(0)
    s_nop 15
    s_nop 7
    v_max3_f32 v225, v116, v117, v118
    v_max3_f32 v225, v225, v119, v120
    v_max3_f32 v225, v225, v121, v122
    v_max3_f32 v225, v225, v123, v124
    v_max3_f32 v225, v225, v125, v126
    v_max3_f32 v225, v225, v127, v128
    v_max3_f32 v225, v225, v129, v130
    v_max_f32 v225, v225, v131
    v_mov_b32 v226, v225
    s_nop 1
    v_permlane32_swap_b32 v225, v226
    v_max_f32 v225, v225, v226
    v_mul_f32 v226, s20, v225
    v_max_f32 v226, v220, v226
    v_sub_f32 v227, v220, v226
    v_exp_f32 v227, v227
    v_mov_b32 v220, v226
    v_mul_f32 v36, v36, v227
    v_mul_f32 v37, v37, v227
    v_mul_f32 v38, v38, v227
    v_mul_f32 v39, v39, v227
    v_mul_f32 v40, v40, v227
    v_mul_f32 v41, v41, v227
    v_mul_f32 v42, v42, v227
    v_mul_f32 v43, v43, v227
    v_mul_f32 v44, v44, v227
    v_mul_f32 v45, v45, v227
    v_mul_f32 v46, v46, v227
    v_mul_f32 v47, v47, v227
    v_mul_f32 v48, v48, v227
    v_mul_f32 v49, v49, v227
    v_mul_f32 v50, v50, v227
    v_mul_f32 v51, v51, v227
    v_mul_f32 v52, v52, v227
    v_mul_f32 v53, v53, v227
    v_mul_f32 v54, v54, v227
    v_mul_f32 v55, v55, v227
    v_mul_f32 v56, v56, v227
    v_mul_f32 v57, v57, v227
    v_mul_f32 v58, v58, v227
    v_mul_f32 v59, v59, v227
    v_mul_f32 v60, v60, v227
    v_mul_f32 v61, v61, v227
    v_mul_f32 v62, v62, v227
    v_mul_f32 v63, v63, v227
    v_mul_f32 v64, v64, v227
    v_mul_f32 v65, v65, v227
    v_mul_f32 v66, v66, v227
    v_mul_f32 v67, v67, v227
    v_mul_f32 v68, v68, v227
    v_mul_f32 v69, v69, v227
    v_mul_f32 v70, v70, v227
    v_mul_f32 v71, v71, v227
    v_mul_f32 v72, v72, v227
    v_mul_f32 v73, v73, v227
    v_mul_f32 v74, v74, v227
    v_mul_f32 v75, v75, v227
    v_mul_f32 v76, v76, v227
    v_mul_f32 v77, v77, v227
    v_mul_f32 v78, v78, v227
    v_mul_f32 v79, v79, v227
    v_mul_f32 v80, v80, v227
    v_mul_f32 v81, v81, v227
    v_mul_f32 v82, v82, v227
    v_mul_f32 v83, v83, v227
    v_mul_f32 v84, v84, v227
    v_mul_f32 v85, v85, v227
    v_mul_f32 v86, v86, v227
    v_mul_f32 v87, v87, v227
    v_mul_f32 v88, v88, v227
    v_mul_f32 v89, v89, v227
    v_mul_f32 v90, v90, v227
    v_mul_f32 v91, v91, v227
    v_mul_f32 v92, v92, v227
    v_mul_f32 v93, v93, v227
    v_mul_f32 v94, v94, v227
    v_mul_f32 v95, v95, v227
    v_mul_f32 v96, v96, v227
    v_mul_f32 v97, v97, v227
    v_mul_f32 v98, v98, v227
    v_mul_f32 v99, v99, v227
    v_mul_f32 v221, v221, v227
    v_mul_f32 v222, v222, v227
    v_fma_f32 v212, v116, s20, -v220
    v_fma_f32 v213, v117, s20, -v220
    v_fma_f32 v214, v118, s20, -v220
    v_fma_f32 v215, v119, s20, -v220
    v_exp_f32 v212, v212
    v_exp_f32 v213, v213
    v_exp_f32 v214, v214
    v_exp_f32 v215, v215
    v_add_f32 v223, v212, v213
    v_add_f32 v224, v214, v215
    v_cvt_pk_bf16_f32 v140, v212, v213
    v_cvt_pk_bf16_f32 v141, v214, v215
    v_fma_f32 v212, v120, s20, -v220
    v_fma_f32 v213, v121, s20, -v220
    v_fma_f32 v214, v122, s20, -v220
    v_fma_f32 v215, v123, s20, -v220
    v_exp_f32 v212, v212
    v_exp_f32 v213, v213
    v_exp_f32 v214, v214
    v_exp_f32 v215, v215
    v_add_f32 v223, v223, v212
    v_add_f32 v224, v224, v213
    v_add_f32 v223, v223, v214
    v_add_f32 v224, v224, v215
    v_cvt_pk_bf16_f32 v142, v212, v213
    v_cvt_pk_bf16_f32 v143, v214, v215
    v_fma_f32 v212, v124, s20, -v220
    v_fma_f32 v213, v125, s20, -v220
    v_fma_f32 v214, v126, s20, -v220
    v_fma_f32 v215, v127, s20, -v220
    v_exp_f32 v212, v212
    v_exp_f32 v213, v213
    v_exp_f32 v214, v214
    v_exp_f32 v215, v215
    v_add_f32 v223, v223, v212
    v_add_f32 v224, v224, v213
    v_add_f32 v223, v223, v214
    v_add_f32 v224, v224, v215
    v_cvt_pk_bf16_f32 v144, v212, v213
    v_cvt_pk_bf16_f32 v145, v214, v215
    v_fma_f32 v212, v128, s20, -v220
    v_fma_f32 v213, v129, s20, -v220
    v_fma_f32 v214, v130, s20, -v220
    v_fma_f32 v215, v131, s20, -v220
    v_exp_f32 v212, v212
    v_exp_f32 v213, v213
    v_exp_f32 v214, v214
    v_exp_f32 v215, v215
    v_add_f32 v223, v223, v212
    v_add_f32 v224, v224, v213
    v_add_f32 v223, v223, v214
    v_add_f32 v224, v224, v215
    v_cvt_pk_bf16_f32 v146, v212, v213
    v_cvt_pk_bf16_f32 v147, v214, v215
    s_nop 3
    s_branch attn_ret_5
attn_fix_6:
    s_waitcnt vmcnt(0) lgkmcnt(0)
    s_nop 15
    s_nop 7
    v_max3_f32 v225, v100, v101, v102
    v_max3_f32 v225, v225, v103, v104
    v_max3_f32 v225, v225, v105, v106
    v_max3_f32 v225, v225, v107, v108
    v_max3_f32 v225, v225, v109, v110
    v_max3_f32 v225, v225, v111, v112
    v_max3_f32 v225, v225, v113, v114
    v_max_f32 v225, v225, v115
    v_mov_b32 v226, v225
    s_nop 1
    v_permlane32_swap_b32 v225, v226
    v_max_f32 v225, v225, v226
    v_mul_f32 v226, s20, v225
    v_max_f32 v226, v220, v226
    v_sub_f32 v227, v220, v226
    v_exp_f32 v227, v227
    v_mov_b32 v220, v226
    v_mul_f32 v36, v36, v227
    v_mul_f32 v37, v37, v227
    v_mul_f32 v38, v38, v227
    v_mul_f32 v39, v39, v227
    v_mul_f32 v40, v40, v227
    v_mul_f32 v41, v41, v227
    v_mul_f32 v42, v42, v227
    v_mul_f32 v43, v43, v227
    v_mul_f32 v44, v44, v227
    v_mul_f32 v45, v45, v227
    v_mul_f32 v46, v46, v227
    v_mul_f32 v47, v47, v227
    v_mul_f32 v48, v48, v227
    v_mul_f32 v49, v49, v227
    v_mul_f32 v50, v50, v227
    v_mul_f32 v51, v51, v227
    v_mul_f32 v52, v52, v227
    v_mul_f32 v53, v53, v227
    v_mul_f32 v54, v54, v227
    v_mul_f32 v55, v55, v227
    v_mul_f32 v56, v56, v227
    v_mul_f32 v57, v57, v227
    v_mul_f32 v58, v58, v227
    v_mul_f32 v59, v59, v227
    v_mul_f32 v60, v60, v227
    v_mul_f32 v61, v61, v227
    v_mul_f32 v62, v62, v227
    v_mul_f32 v63, v63, v227
    v_mul_f32 v64, v64, v227
    v_mul_f32 v65, v65, v227
    v_mul_f32 v66, v66, v227
    v_mul_f32 v67, v67, v227
    v_mul_f32 v68, v68, v227
    v_mul_f32 v69, v69, v227
    v_mul_f32 v70, v70, v227
    v_mul_f32 v71, v71, v227
    v_mul_f32 v72, v72, v227
    v_mul_f32 v73, v73, v227
    v_mul_f32 v74, v74, v227
    v_mul_f32 v75, v75, v227
    v_mul_f32 v76, v76, v227
    v_mul_f32 v77, v77, v227
    v_mul_f32 v78, v78, v227
    v_mul_f32 v79, v79, v227
    v_mul_f32 v80, v80, v227
    v_mul_f32 v81, v81, v227
    v_mul_f32 v82, v82, v227
    v_mul_f32 v83, v83, v227
    v_mul_f32 v84, v84, v227
    v_mul_f32 v85, v85, v227
    v_mul_f32 v86, v86, v227
    v_mul_f32 v87, v87, v227
    v_mul_f32 v88, v88, v227
    v_mul_f32 v89, v89, v227
    v_mul_f32 v90, v90, v227
    v_mul_f32 v91, v91, v227
    v_mul_f32 v92, v92, v227
    v_mul_f32 v93, v93, v227
    v_mul_f32 v94, v94, v227
    v_mul_f32 v95, v95, v227
    v_mul_f32 v96, v96, v227
    v_mul_f32 v97, v97, v227
    v_mul_f32 v98, v98, v227
    v_mul_f32 v99, v99, v227
    v_mul_f32 v221, v221, v227
    v_mul_f32 v222, v222, v227
    v_fma_f32 v212, v100, s20, -v220
    v_fma_f32 v213, v101, s20, -v220
    v_fma_f32 v214, v102, s20, -v220
    v_fma_f32 v215, v103, s20, -v220
    v_exp_f32 v212, v212
    v_exp_f32 v213, v213
    v_exp_f32 v214, v214
    v_exp_f32 v215, v215
    v_add_f32 v223, v212, v213
    v_add_f32 v224, v214, v215
    v_cvt_pk_bf16_f32 v132, v212, v213
    v_cvt_pk_bf16_f32 v133, v214, v215
    v_fma_f32 v212, v104, s20, -v220
    v_fma_f32 v213, v105, s20, -v220
    v_fma_f32 v214, v106, s20, -v220
    v_fma_f32 v215, v107, s20, -v220
    v_exp_f32 v212, v212
    v_exp_f32 v213, v213
    v_exp_f32 v214, v214
    v_exp_f32 v215, v215
    v_add_f32 v223, v223, v212
    v_add_f32 v224, v224, v213
    v_add_f32 v223, v223, v214
    v_add_f32 v224, v224, v215
    v_cvt_pk_bf16_f32 v134, v212, v213
    v_cvt_pk_bf16_f32 v135, v214, v215
    v_fma_f32 v212, v108, s20, -v220
    v_fma_f32 v213, v109, s20, -v220
    v_fma_f32 v214, v110, s20, -v220
    v_fma_f32 v215, v111, s20, -v220
    v_exp_f32 v212, v212
    v_exp_f32 v213, v213
    v_exp_f32 v214, v214
    v_exp_f32 v215, v215
    v_add_f32 v223, v223, v212
    v_add_f32 v224, v224, v213
    v_add_f32 v223, v223, v214
    v_add_f32 v224, v224, v215
    v_cvt_pk_bf16_f32 v136, v212, v213
    v_cvt_pk_bf16_f32 v137, v214, v215
    v_fma_f32 v212, v112, s20, -v220
    v_fma_f32 v213, v113, s20, -v220
    v_fma_f32 v214, v114, s20, -v220
    v_fma_f32 v215, v115, s20, -v220
    v_exp_f32 v212, v212
    v_exp_f32 v213, v213
    v_exp_f32 v214, v214
    v_exp_f32 v215, v215
    v_add_f32 v223, v223, v212
    v_add_f32 v224, v224, v213
    v_add_f32 v223, v223, v214
    v_add_f32 v224, v224, v215
    v_cvt_pk_bf16_f32 v138, v212, v213
    v_cvt_pk_bf16_f32 v139, v214, v215
    s_nop 3
    s_branch attn_ret_6
attn_fix_7:
    s_waitcnt vmcnt(0) lgkmcnt(0)
    s_nop 15
    s_nop 7
    v_max3_f32 v225, v116, v117, v118
    v_max3_f32 v225, v225, v119, v120
    v_max3_f32 v225, v225, v121, v122
    v_max3_f32 v225, v225, v123, v124
    v_max3_f32 v225, v225, v125, v126
    v_max3_f32 v225, v225, v127, v128
    v_max3_f32 v225, v225, v129, v130
    v_max_f32 v225, v225, v131
    v_mov_b32 v226, v225
    s_nop 1
    v_permlane32_swap_b32 v225, v226
    v_max_f32 v225, v225, v226
    v_mul_f32 v226, s20, v225
    v_max_f32 v226, v220, v226
    v_sub_f32 v227, v220, v226
    v_exp_f32 v227, v227
    v_mov_b32 v220, v226
    v_mul_f32 v36, v36, v227
    v_mul_f32 v37, v37, v227
    v_mul_f32 v38, v38, v227
    v_mul_f32 v39, v39, v227
    v_mul_f32 v40, v40, v227
    v_mul_f32 v41, v41, v227
    v_mul_f32 v42, v42, v227
    v_mul_f32 v43, v43, v227
    v_mul_f32 v44, v44, v227
    v_mul_f32 v45, v45, v227
    v_mul_f32 v46, v46, v227
    v_mul_f32 v47, v47, v227
    v_mul_f32 v48, v48, v227
    v_mul_f32 v49, v49, v227
    v_mul_f32 v50, v50, v227
    v_mul_f32 v51, v51, v227
    v_mul_f32 v52, v52, v227
    v_mul_f32 v53, v53, v227
    v_mul_f32 v54, v54, v227
    v_mul_f32 v55, v55, v227
    v_mul_f32 v56, v56, v227
    v_mul_f32 v57, v57, v227
    v_mul_f32 v58, v58, v227
    v_mul_f32 v59, v59, v227
    v_mul_f32 v60, v60, v227
    v_mul_f32 v61, v61, v227
    v_mul_f32 v62, v62, v227
    v_mul_f32 v63, v63, v227
    v_mul_f32 v64, v64, v227
    v_mul_f32 v65, v65, v227
    v_mul_f32 v66, v66, v227
    v_mul_f32 v67, v67, v227
    v_mul_f32 v68, v68, v227
    v_mul_f32 v69, v69, v227
    v_mul_f32 v70, v70, v227
    v_mul_f32 v71, v71, v227
    v_mul_f32 v72, v72, v227
    v_mul_f32 v73, v73, v227
    v_mul_f32 v74, v74, v227
    v_mul_f32 v75, v75, v227
    v_mul_f32 v76, v76, v227
    v_mul_f32 v77, v77, v227
    v_mul_f32 v78, v78, v227
    v_mul_f32 v79, v79, v227
    v_mul_f32 v80, v80, v227
    v_mul_f32 v81, v81, v227
    v_mul_f32 v82, v82, v227
    v_mul_f32 v83, v83, v227
    v_mul_f32 v84, v84, v227
    v_mul_f32 v85, v85, v227
    v_mul_f32 v86, v86, v227
    v_mul_f32 v87, v87, v227
    v_mul_f32 v88, v88, v227
    v_mul_f32 v89, v89, v227
    v_mul_f32 v90, v90, v227
    v_mul_f32 v91, v91, v227
    v_mul_f32 v92, v92, v227
    v_mul_f32 v93, v93, v227
    v_mul_f32 v94, v94, v227
    v_mul_f32 v95, v95, v227
    v_mul_f32 v96, v96, v227
    v_mul_f32 v97, v97, v227
    v_mul_f32 v98, v98, v227
    v_mul_f32 v99, v99, v227
    v_mul_f32 v221, v221, v227
    v_mul_f32 v222, v222, v227
    v_fma_f32 v212, v116, s20, -v220
    v_fma_f32 v213, v117, s20, -v220
    v_fma_f32 v214, v118, s20, -v220
    v_fma_f32 v215, v119, s20, -v220
    v_exp_f32 v212, v212
    v_exp_f32 v213, v213
    v_exp_f32 v214, v214
    v_exp_f32 v215, v215
    v_add_f32 v223, v212, v213
    v_add_f32 v224, v214, v215
    v_cvt_pk_bf16_f32 v140, v212, v213
    v_cvt_pk_bf16_f32 v141, v214, v215
    v_fma_f32 v212, v120, s20, -v220
    v_fma_f32 v213, v121, s20, -v220
    v_fma_f32 v214, v122, s20, -v220
    v_fma_f32 v215, v123, s20, -v220
    v_exp_f32 v212, v212
    v_exp_f32 v213, v213
    v_exp_f32 v214, v214
    v_exp_f32 v215, v215
    v_add_f32 v223, v223, v212
    v_add_f32 v224, v224, v213
    v_add_f32 v223, v223, v214
    v_add_f32 v224, v224, v215
    v_cvt_pk_bf16_f32 v142, v212, v213
    v_cvt_pk_bf16_f32 v143, v214, v215
    v_fma_f32 v212, v124, s20, -v220
    v_fma_f32 v213, v125, s20, -v220
    v_fma_f32 v214, v126, s20, -v220
    v_fma_f32 v215, v127, s20, -v220
    v_exp_f32 v212, v212
    v_exp_f32 v213, v213
    v_exp_f32 v214, v214
    v_exp_f32 v215, v215
    v_add_f32 v223, v223, v212
    v_add_f32 v224, v224, v213
    v_add_f32 v223, v223, v214
    v_add_f32 v224, v224, v215
    v_cvt_pk_bf16_f32 v144, v212, v213
    v_cvt_pk_bf16_f32 v145, v214, v215
    v_fma_f32 v212, v128, s20, -v220
    v_fma_f32 v213, v129, s20, -v220
    v_fma_f32 v214, v130, s20, -v220
    v_fma_f32 v215, v131, s20, -v220
    v_exp_f32 v212, v212
    v_exp_f32 v213, v213
    v_exp_f32 v214, v214
    v_exp_f32 v215, v215
    v_add_f32 v223, v223, v212
    v_add_f32 v224, v224, v213
    v_add_f32 v223, v223, v214
    v_add_f32 v224, v224, v215
    v_cvt_pk_bf16_f32 v146, v212, v213
    v_cvt_pk_bf16_f32 v147, v214, v215
    s_nop 3
    s_branch attn_ret_7
attn_fix_8:
    s_waitcnt vmcnt(0) lgkmcnt(0)
    s_nop 15
    s_nop 7
    v_max3_f32 v225, v100, v101, v102
    v_max3_f32 v225, v225, v103, v104
    v_max3_f32 v225, v225, v105, v106
    v_max3_f32 v225, v225, v107, v108
    v_max3_f32 v225, v225, v109, v110
    v_max3_f32 v225, v225, v111, v112
    v_max3_f32 v225, v225, v113, v114
    v_max_f32 v225, v225, v115
    v_mov_b32 v226, v225
    s_nop 1
    v_permlane32_swap_b32 v225, v226
    v_max_f32 v225, v225, v226
    v_mul_f32 v226, s20, v225
    v_max_f32 v226, v220, v226
    v_sub_f32 v227, v220, v226
    v_exp_f32 v227, v227
    v_mov_b32 v220, v226
    v_mul_f32 v36, v36, v227
    v_mul_f32 v37, v37, v227
    v_mul_f32 v38, v38, v227
    v_mul_f32 v39, v39, v227
    v_mul_f32 v40, v40, v227
    v_mul_f32 v41, v41, v227
    v_mul_f32 v42, v42, v227
    v_mul_f32 v43, v43, v227
    v_mul_f32 v44, v44, v227
    v_mul_f32 v45, v45, v227
    v_mul_f32 v46, v46, v227
    v_mul_f32 v47, v47, v227
    v_mul_f32 v48, v48, v227
    v_mul_f32 v49, v49, v227
    v_mul_f32 v50, v50, v227
    v_mul_f32 v51, v51, v227
    v_mul_f32 v52, v52, v227
    v_mul_f32 v53, v53, v227
    v_mul_f32 v54, v54, v227
    v_mul_f32 v55, v55, v227
    v_mul_f32 v56, v56, v227
    v_mul_f32 v57, v57, v227
    v_mul_f32 v58, v58, v227
    v_mul_f32 v59, v59, v227
    v_mul_f32 v60, v60, v227
    v_mul_f32 v61, v61, v227
    v_mul_f32 v62, v62, v227
    v_mul_f32 v63, v63, v227
    v_mul_f32 v64, v64, v227
    v_mul_f32 v65, v65, v227
    v_mul_f32 v66, v66, v227
    v_mul_f32 v67, v67, v227
    v_mul_f32 v68, v68, v227
    v_mul_f32 v69, v69, v227
    v_mul_f32 v70, v70, v227
    v_mul_f32 v71, v71, v227
    v_mul_f32 v72, v72, v227
    v_mul_f32 v73, v73, v227
    v_mul_f32 v74, v74, v227
    v_mul_f32 v75, v75, v227
    v_mul_f32 v76, v76, v227
    v_mul_f32 v77, v77, v227
    v_mul_f32 v78, v78, v227
    v_mul_f32 v79, v79, v227
    v_mul_f32 v80, v80, v227
    v_mul_f32 v81, v81, v227
    v_mul_f32 v82, v82, v227
    v_mul_f32 v83, v83, v227
    v_mul_f32 v84, v84, v227
    v_mul_f32 v85, v85, v227
    v_mul_f32 v86, v86, v227
    v_mul_f32 v87, v87, v227
    v_mul_f32 v88, v88, v227
    v_mul_f32 v89, v89, v227
    v_mul_f32 v90, v90, v227
    v_mul_f32 v91, v91, v227
    v_mul_f32 v92, v92, v227
    v_mul_f32 v93, v93, v227
    v_mul_f32 v94, v94, v227
    v_mul_f32 v95, v95, v227
    v_mul_f32 v96, v96, v227
    v_mul_f32 v97, v97, v227
    v_mul_f32 v98, v98, v227
    v_mul_f32 v99, v99, v227
    v_mul_f32 v221, v221, v227
    v_mul_f32 v222, v222, v227
    v_fma_f32 v212, v100, s20, -v220
    v_fma_f32 v213, v101, s20, -v220
    v_fma_f32 v214, v102, s20, -v220
    v_fma_f32 v215, v103, s20, -v220
    v_exp_f32 v212, v212
    v_exp_f32 v213, v213
    v_exp_f32 v214, v214
    v_exp_f32 v215, v215
    v_add_f32 v223, v212, v213
    v_add_f32 v224, v214, v215
    v_cvt_pk_bf16_f32 v132, v212, v213
    v_cvt_pk_bf16_f32 v133, v214, v215
    v_fma_f32 v212, v104, s20, -v220
    v_fma_f32 v213, v105, s20, -v220
    v_fma_f32 v214, v106, s20, -v220
    v_fma_f32 v215, v107, s20, -v220
    v_exp_f32 v212, v212
    v_exp_f32 v213, v213
    v_exp_f32 v214, v214
    v_exp_f32 v215, v215
    v_add_f32 v223, v223, v212
    v_add_f32 v224, v224, v213
    v_add_f32 v223, v223, v214
    v_add_f32 v224, v224, v215
    v_cvt_pk_bf16_f32 v134, v212, v213
    v_cvt_pk_bf16_f32 v135, v214, v215
    v_fma_f32 v212, v108, s20, -v220
    v_fma_f32 v213, v109, s20, -v220
    v_fma_f32 v214, v110, s20, -v220
    v_fma_f32 v215, v111, s20, -v220
    v_exp_f32 v212, v212
    v_exp_f32 v213, v213
    v_exp_f32 v214, v214
    v_exp_f32 v215, v215
    v_add_f32 v223, v223, v212
    v_add_f32 v224, v224, v213
    v_add_f32 v223, v223, v214
    v_add_f32 v224, v224, v215
    v_cvt_pk_bf16_f32 v136, v212, v213
    v_cvt_pk_bf16_f32 v137, v214, v215
    v_fma_f32 v212, v112, s20, -v220
    v_fma_f32 v213, v113, s20, -v220
    v_fma_f32 v214, v114, s20, -v220
    v_fma_f32 v215, v115, s20, -v220
    v_exp_f32 v212, v212
    v_exp_f32 v213, v213
    v_exp_f32 v214, v214
    v_exp_f32 v215, v215
    v_add_f32 v223, v223, v212
    v_add_f32 v224, v224, v213
    v_add_f32 v223, v223, v214
    v_add_f32 v224, v224, v215
    v_cvt_pk_bf16_f32 v138, v212, v213
    v_cvt_pk_bf16_f32 v139, v214, v215
    s_nop 3
    s_branch attn_ret_8
attn_fix_9:
    s_waitcnt vmcnt(0) lgkmcnt(0)
    s_nop 15
    s_nop 7
    v_max3_f32 v225, v116, v117, v118
    v_max3_f32 v225, v225, v119, v120
    v_max3_f32 v225, v225, v121, v122
    v_max3_f32 v225, v225, v123, v124
    v_max3_f32 v225, v225, v125, v126
    v_max3_f32 v225, v225, v127, v128
    v_max3_f32 v225, v225, v129, v130
    v_max_f32 v225, v225, v131
    v_mov_b32 v226, v225
    s_nop 1
    v_permlane32_swap_b32 v225, v226
    v_max_f32 v225, v225, v226
    v_mul_f32 v226, s20, v225
    v_max_f32 v226, v220, v226
    v_sub_f32 v227, v220, v226
    v_exp_f32 v227, v227
    v_mov_b32 v220, v226
    v_mul_f32 v36, v36, v227
    v_mul_f32 v37, v37, v227
    v_mul_f32 v38, v38, v227
    v_mul_f32 v39, v39, v227
    v_mul_f32 v40, v40, v227
    v_mul_f32 v41, v41, v227
    v_mul_f32 v42, v42, v227
    v_mul_f32 v43, v43, v227
    v_mul_f32 v44, v44, v227
    v_mul_f32 v45, v45, v227
    v_mul_f32 v46, v46, v227
    v_mul_f32 v47, v47, v227
    v_mul_f32 v48, v48, v227
    v_mul_f32 v49, v49, v227
    v_mul_f32 v50, v50, v227
    v_mul_f32 v51, v51, v227
    v_mul_f32 v52, v52, v227
    v_mul_f32 v53, v53, v227
    v_mul_f32 v54, v54, v227
    v_mul_f32 v55, v55, v227
    v_mul_f32 v56, v56, v227
    v_mul_f32 v57, v57, v227
    v_mul_f32 v58, v58, v227
    v_mul_f32 v59, v59, v227
    v_mul_f32 v60, v60, v227
    v_mul_f32 v61, v61, v227
    v_mul_f32 v62, v62, v227
    v_mul_f32 v63, v63, v227
    v_mul_f32 v64, v64, v227
    v_mul_f32 v65, v65, v227
    v_mul_f32 v66, v66, v227
    v_mul_f32 v67, v67, v227
    v_mul_f32 v68, v68, v227
    v_mul_f32 v69, v69, v227
    v_mul_f32 v70, v70, v227
    v_mul_f32 v71, v71, v227
    v_mul_f32 v72, v72, v227
    v_mul_f32 v73, v73, v227
    v_mul_f32 v74, v74, v227
    v_mul_f32 v75, v75, v227
    v_mul_f32 v76, v76, v227
    v_mul_f32 v77, v77, v227
    v_mul_f32 v78, v78, v227
    v_mul_f32 v79, v79, v227
    v_mul_f32 v80, v80, v227
    v_mul_f32 v81, v81, v227
    v_mul_f32 v82, v82, v227
    v_mul_f32 v83, v83, v227
    v_mul_f32 v84, v84, v227
    v_mul_f32 v85, v85, v227
    v_mul_f32 v86, v86, v227
    v_mul_f32 v87, v87, v227
    v_mul_f32 v88, v88, v227
    v_mul_f32 v89, v89, v227
    v_mul_f32 v90, v90, v227
    v_mul_f32 v91, v91, v227
    v_mul_f32 v92, v92, v227
    v_mul_f32 v93, v93, v227
    v_mul_f32 v94, v94, v227
    v_mul_f32 v95, v95, v227
    v_mul_f32 v96, v96, v227
    v_mul_f32 v97, v97, v227
    v_mul_f32 v98, v98, v227
    v_mul_f32 v99, v99, v227
    v_mul_f32 v221, v221, v227
    v_mul_f32 v222, v222, v227
    v_fma_f32 v212, v116, s20, -v220
    v_fma_f32 v213, v117, s20, -v220
    v_fma_f32 v214, v118, s20, -v220
    v_fma_f32 v215, v119, s20, -v220
    v_exp_f32 v212, v212
    v_exp_f32 v213, v213
    v_exp_f32 v214, v214
    v_exp_f32 v215, v215
    v_add_f32 v223, v212, v213
    v_add_f32 v224, v214, v215
    v_cvt_pk_bf16_f32 v140, v212, v213
    v_cvt_pk_bf16_f32 v141, v214, v215
    v_fma_f32 v212, v120, s20, -v220
    v_fma_f32 v213, v121, s20, -v220
    v_fma_f32 v214, v122, s20, -v220
    v_fma_f32 v215, v123, s20, -v220
    v_exp_f32 v212, v212
    v_exp_f32 v213, v213
    v_exp_f32 v214, v214
    v_exp_f32 v215, v215
    v_add_f32 v223, v223, v212
    v_add_f32 v224, v224, v213
    v_add_f32 v223, v223, v214
    v_add_f32 v224, v224, v215
    v_cvt_pk_bf16_f32 v142, v212, v213
    v_cvt_pk_bf16_f32 v143, v214, v215
    v_fma_f32 v212, v124, s20, -v220
    v_fma_f32 v213, v125, s20, -v220
    v_fma_f32 v214, v126, s20, -v220
    v_fma_f32 v215, v127, s20, -v220
    v_exp_f32 v212, v212
    v_exp_f32 v213, v213
    v_exp_f32 v214, v214
    v_exp_f32 v215, v215
    v_add_f32 v223, v223, v212
    v_add_f32 v224, v224, v213
    v_add_f32 v223, v223, v214
    v_add_f32 v224, v224, v215
    v_cvt_pk_bf16_f32 v144, v212, v213
    v_cvt_pk_bf16_f32 v145, v214, v215
    v_fma_f32 v212, v128, s20, -v220
    v_fma_f32 v213, v129, s20, -v220
    v_fma_f32 v214, v130, s20, -v220
    v_fma_f32 v215, v131, s20, -v220
    v_exp_f32 v212, v212
    v_exp_f32 v213, v213
    v_exp_f32 v214, v214
    v_exp_f32 v215, v215
    v_add_f32 v223, v223, v212
    v_add_f32 v224, v224, v213
    v_add_f32 v223, v223, v214
    v_add_f32 v224, v224, v215
    v_cvt_pk_bf16_f32 v146, v212, v213
    v_cvt_pk_bf16_f32 v147, v214, v215
    s_nop 3
    s_branch attn_ret_9
attn_fix_10:
    s_waitcnt vmcnt(0) lgkmcnt(0)
    s_nop 15
    s_nop 7
    v_max3_f32 v225, v100, v101, v102
    v_max3_f32 v225, v225, v103, v104
    v_max3_f32 v225, v225, v105, v106
    v_max3_f32 v225, v225, v107, v108
    v_max3_f32 v225, v225, v109, v110
    v_max3_f32 v225, v225, v111, v112
    v_max3_f32 v225, v225, v113, v114
    v_max_f32 v225, v225, v115
    v_mov_b32 v226, v225
    s_nop 1
    v_permlane32_swap_b32 v225, v226
    v_max_f32 v225, v225, v226
    v_mul_f32 v226, s20, v225
    v_max_f32 v226, v220, v226
    v_sub_f32 v227, v220, v226
    v_exp_f32 v227, v227
    v_mov_b32 v220, v226
    v_mul_f32 v36, v36, v227
    v_mul_f32 v37, v37, v227
    v_mul_f32 v38, v38, v227
    v_mul_f32 v39, v39, v227
    v_mul_f32 v40, v40, v227
    v_mul_f32 v41, v41, v227
    v_mul_f32 v42, v42, v227
    v_mul_f32 v43, v43, v227
    v_mul_f32 v44, v44, v227
    v_mul_f32 v45, v45, v227
    v_mul_f32 v46, v46, v227
    v_mul_f32 v47, v47, v227
    v_mul_f32 v48, v48, v227
    v_mul_f32 v49, v49, v227
    v_mul_f32 v50, v50, v227
    v_mul_f32 v51, v51, v227
    v_mul_f32 v52, v52, v227
    v_mul_f32 v53, v53, v227
    v_mul_f32 v54, v54, v227
    v_mul_f32 v55, v55, v227
    v_mul_f32 v56, v56, v227
    v_mul_f32 v57, v57, v227
    v_mul_f32 v58, v58, v227
    v_mul_f32 v59, v59, v227
    v_mul_f32 v60, v60, v227
    v_mul_f32 v61, v61, v227
    v_mul_f32 v62, v62, v227
    v_mul_f32 v63, v63, v227
    v_mul_f32 v64, v64, v227
    v_mul_f32 v65, v65, v227
    v_mul_f32 v66, v66, v227
    v_mul_f32 v67, v67, v227
    v_mul_f32 v68, v68, v227
    v_mul_f32 v69, v69, v227
    v_mul_f32 v70, v70, v227
    v_mul_f32 v71, v71, v227
    v_mul_f32 v72, v72, v227
    v_mul_f32 v73, v73, v227
    v_mul_f32 v74, v74, v227
    v_mul_f32 v75, v75, v227
    v_mul_f32 v76, v76, v227
    v_mul_f32 v77, v77, v227
    v_mul_f32 v78, v78, v227
    v_mul_f32 v79, v79, v227
    v_mul_f32 v80, v80, v227
    v_mul_f32 v81, v81, v227
    v_mul_f32 v82, v82, v227
    v_mul_f32 v83, v83, v227
    v_mul_f32 v84, v84, v227
    v_mul_f32 v85, v85, v227
    v_mul_f32 v86, v86, v227
    v_mul_f32 v87, v87, v227
    v_mul_f32 v88, v88, v227
    v_mul_f32 v89, v89, v227
    v_mul_f32 v90, v90, v227
    v_mul_f32 v91, v91, v227
    v_mul_f32 v92, v92, v227
    v_mul_f32 v93, v93, v227
    v_mul_f32 v94, v94, v227
    v_mul_f32 v95, v95, v227
    v_mul_f32 v96, v96, v227
    v_mul_f32 v97, v97, v227
    v_mul_f32 v98, v98, v227
    v_mul_f32 v99, v99, v227
    v_mul_f32 v221, v221, v227
    v_mul_f32 v222, v222, v227
    v_fma_f32 v212, v100, s20, -v220
    v_fma_f32 v213, v101, s20, -v220
    v_fma_f32 v214, v102, s20, -v220
    v_fma_f32 v215, v103, s20, -v220
    v_exp_f32 v212, v212
    v_exp_f32 v213, v213
    v_exp_f32 v214, v214
    v_exp_f32 v215, v215
    v_add_f32 v223, v212, v213
    v_add_f32 v224, v214, v215
    v_cvt_pk_bf16_f32 v132, v212, v213
    v_cvt_pk_bf16_f32 v133, v214, v215
    v_fma_f32 v212, v104, s20, -v220
    v_fma_f32 v213, v105, s20, -v220
    v_fma_f32 v214, v106, s20, -v220
    v_fma_f32 v215, v107, s20, -v220
    v_exp_f32 v212, v212
    v_exp_f32 v213, v213
    v_exp_f32 v214, v214
    v_exp_f32 v215, v215
    v_add_f32 v223, v223, v212
    v_add_f32 v224, v224, v213
    v_add_f32 v223, v223, v214
    v_add_f32 v224, v224, v215
    v_cvt_pk_bf16_f32 v134, v212, v213
    v_cvt_pk_bf16_f32 v135, v214, v215
    v_fma_f32 v212, v108, s20, -v220
    v_fma_f32 v213, v109, s20, -v220
    v_fma_f32 v214, v110, s20, -v220
    v_fma_f32 v215, v111, s20, -v220
    v_exp_f32 v212, v212
    v_exp_f32 v213, v213
    v_exp_f32 v214, v214
    v_exp_f32 v215, v215
    v_add_f32 v223, v223, v212
    v_add_f32 v224, v224, v213
    v_add_f32 v223, v223, v214
    v_add_f32 v224, v224, v215
    v_cvt_pk_bf16_f32 v136, v212, v213
    v_cvt_pk_bf16_f32 v137, v214, v215
    v_fma_f32 v212, v112, s20, -v220
    v_fma_f32 v213, v113, s20, -v220
    v_fma_f32 v214, v114, s20, -v220
    v_fma_f32 v215, v115, s20, -v220
    v_exp_f32 v212, v212
    v_exp_f32 v213, v213
    v_exp_f32 v214, v214
    v_exp_f32 v215, v215
    v_add_f32 v223, v223, v212
    v_add_f32 v224, v224, v213
    v_add_f32 v223, v223, v214
    v_add_f32 v224, v224, v215
    v_cvt_pk_bf16_f32 v138, v212, v213
    v_cvt_pk_bf16_f32 v139, v214, v215
    s_nop 3
    s_branch attn_ret_10
attn_fix_11:
    s_waitcnt vmcnt(0) lgkmcnt(0)
    s_nop 15
    s_nop 7
    v_max3_f32 v225, v116, v117, v118
    v_max3_f32 v225, v225, v119, v120
    v_max3_f32 v225, v225, v121, v122
    v_max3_f32 v225, v225, v123, v124
    v_max3_f32 v225, v225, v125, v126
    v_max3_f32 v225, v225, v127, v128
    v_max3_f32 v225, v225, v129, v130
    v_max_f32 v225, v225, v131
    v_mov_b32 v226, v225
    s_nop 1
    v_permlane32_swap_b32 v225, v226
    v_max_f32 v225, v225, v226
    v_mul_f32 v226, s20, v225
    v_max_f32 v226, v220, v226
    v_sub_f32 v227, v220, v226
    v_exp_f32 v227, v227
    v_mov_b32 v220, v226
    v_mul_f32 v36, v36, v227
    v_mul_f32 v37, v37, v227
    v_mul_f32 v38, v38, v227
    v_mul_f32 v39, v39, v227
    v_mul_f32 v40, v40, v227
    v_mul_f32 v41, v41, v227
    v_mul_f32 v42, v42, v227
    v_mul_f32 v43, v43, v227
    v_mul_f32 v44, v44, v227
    v_mul_f32 v45, v45, v227
    v_mul_f32 v46, v46, v227
    v_mul_f32 v47, v47, v227
    v_mul_f32 v48, v48, v227
    v_mul_f32 v49, v49, v227
    v_mul_f32 v50, v50, v227
    v_mul_f32 v51, v51, v227
    v_mul_f32 v52, v52, v227
    v_mul_f32 v53, v53, v227
    v_mul_f32 v54, v54, v227
    v_mul_f32 v55, v55, v227
    v_mul_f32 v56, v56, v227
    v_mul_f32 v57, v57, v227
    v_mul_f32 v58, v58, v227
    v_mul_f32 v59, v59, v227
    v_mul_f32 v60, v60, v227
    v_mul_f32 v61, v61, v227
    v_mul_f32 v62, v62, v227
    v_mul_f32 v63, v63, v227
    v_mul_f32 v64, v64, v227
    v_mul_f32 v65, v65, v227
    v_mul_f32 v66, v66, v227
    v_mul_f32 v67, v67, v227
    v_mul_f32 v68, v68, v227
    v_mul_f32 v69, v69, v227
    v_mul_f32 v70, v70, v227
    v_mul_f32 v71, v71, v227
    v_mul_f32 v72, v72, v227
    v_mul_f32 v73, v73, v227
    v_mul_f32 v74, v74, v227
    v_mul_f32 v75, v75, v227
    v_mul_f32 v76, v76, v227
    v_mul_f32 v77, v77, v227
    v_mul_f32 v78, v78, v227
    v_mul_f32 v79, v79, v227
    v_mul_f32 v80, v80, v227
    v_mul_f32 v81, v81, v227
    v_mul_f32 v82, v82, v227
    v_mul_f32 v83, v83, v227
    v_mul_f32 v84, v84, v227
    v_mul_f32 v85, v85, v227
    v_mul_f32 v86, v86, v227
    v_mul_f32 v87, v87, v227
    v_mul_f32 v88, v88, v227
    v_mul_f32 v89, v89, v227
    v_mul_f32 v90, v90, v227
    v_mul_f32 v91, v91, v227
    v_mul_f32 v92, v92, v227
    v_mul_f32 v93, v93, v227
    v_mul_f32 v94, v94, v227
    v_mul_f32 v95, v95, v227
    v_mul_f32 v96, v96, v227
    v_mul_f32 v97, v97, v227
    v_mul_f32 v98, v98, v227
    v_mul_f32 v99, v99, v227
    v_mul_f32 v221, v221, v227
    v_mul_f32 v222, v222, v227
    v_fma_f32 v212, v116, s20, -v220
    v_fma_f32 v213, v117, s20, -v220
    v_fma_f32 v214, v118, s20, -v220
    v_fma_f32 v215, v119, s20, -v220
    v_exp_f32 v212, v212
    v_exp_f32 v213, v213
    v_exp_f32 v214, v214
    v_exp_f32 v215, v215
    v_add_f32 v223, v212, v213
    v_add_f32 v224, v214, v215
    v_cvt_pk_bf16_f32 v140, v212, v213
    v_cvt_pk_bf16_f32 v141, v214, v215
    v_fma_f32 v212, v120, s20, -v220
    v_fma_f32 v213, v121, s20, -v220
    v_fma_f32 v214, v122, s20, -v220
    v_fma_f32 v215, v123, s20, -v220
    v_exp_f32 v212, v212
    v_exp_f32 v213, v213
    v_exp_f32 v214, v214
    v_exp_f32 v215, v215
    v_add_f32 v223, v223, v212
    v_add_f32 v224, v224, v213
    v_add_f32 v223, v223, v214
    v_add_f32 v224, v224, v215
    v_cvt_pk_bf16_f32 v142, v212, v213
    v_cvt_pk_bf16_f32 v143, v214, v215
    v_fma_f32 v212, v124, s20, -v220
    v_fma_f32 v213, v125, s20, -v220
    v_fma_f32 v214, v126, s20, -v220
    v_fma_f32 v215, v127, s20, -v220
    v_exp_f32 v212, v212
    v_exp_f32 v213, v213
    v_exp_f32 v214, v214
    v_exp_f32 v215, v215
    v_add_f32 v223, v223, v212
    v_add_f32 v224, v224, v213
    v_add_f32 v223, v223, v214
    v_add_f32 v224, v224, v215
    v_cvt_pk_bf16_f32 v144, v212, v213
    v_cvt_pk_bf16_f32 v145, v214, v215
    v_fma_f32 v212, v128, s20, -v220
    v_fma_f32 v213, v129, s20, -v220
    v_fma_f32 v214, v130, s20, -v220
    v_fma_f32 v215, v131, s20, -v220
    v_exp_f32 v212, v212
    v_exp_f32 v213, v213
    v_exp_f32 v214, v214
    v_exp_f32 v215, v215
    v_add_f32 v223, v223, v212
    v_add_f32 v224, v224, v213
    v_add_f32 v223, v223, v214
    v_add_f32 v224, v224, v215
    v_cvt_pk_bf16_f32 v146, v212, v213
    v_cvt_pk_bf16_f32 v147, v214, v215
    s_nop 3
    s_branch attn_ret_11
attn_fix_12:
    s_waitcnt vmcnt(0) lgkmcnt(0)
    s_nop 15
    s_nop 7
    v_max3_f32 v225, v100, v101, v102
    v_max3_f32 v225, v225, v103, v104
    v_max3_f32 v225, v225, v105, v106
    v_max3_f32 v225, v225, v107, v108
    v_max3_f32 v225, v225, v109, v110
    v_max3_f32 v225, v225, v111, v112
    v_max3_f32 v225, v225, v113, v114
    v_max_f32 v225, v225, v115
    v_mov_b32 v226, v225
    s_nop 1
    v_permlane32_swap_b32 v225, v226
    v_max_f32 v225, v225, v226
    v_mul_f32 v226, s20, v225
    v_max_f32 v226, v220, v226
    v_sub_f32 v227, v220, v226
    v_exp_f32 v227, v227
    v_mov_b32 v220, v226
    v_mul_f32 v36, v36, v227
    v_mul_f32 v37, v37, v227
    v_mul_f32 v38, v38, v227
    v_mul_f32 v39, v39, v227
    v_mul_f32 v40, v40, v227
    v_mul_f32 v41, v41, v227
    v_mul_f32 v42, v42, v227
    v_mul_f32 v43, v43, v227
    v_mul_f32 v44, v44, v227
    v_mul_f32 v45, v45, v227
    v_mul_f32 v46, v46, v227
    v_mul_f32 v47, v47, v227
    v_mul_f32 v48, v48, v227
    v_mul_f32 v49, v49, v227
    v_mul_f32 v50, v50, v227
    v_mul_f32 v51, v51, v227
    v_mul_f32 v52, v52, v227
    v_mul_f32 v53, v53, v227
    v_mul_f32 v54, v54, v227
    v_mul_f32 v55, v55, v227
    v_mul_f32 v56, v56, v227
    v_mul_f32 v57, v57, v227
    v_mul_f32 v58, v58, v227
    v_mul_f32 v59, v59, v227
    v_mul_f32 v60, v60, v227
    v_mul_f32 v61, v61, v227
    v_mul_f32 v62, v62, v227
    v_mul_f32 v63, v63, v227
    v_mul_f32 v64, v64, v227
    v_mul_f32 v65, v65, v227
    v_mul_f32 v66, v66, v227
    v_mul_f32 v67, v67, v227
    v_mul_f32 v68, v68, v227
    v_mul_f32 v69, v69, v227
    v_mul_f32 v70, v70, v227
    v_mul_f32 v71, v71, v227
    v_mul_f32 v72, v72, v227
    v_mul_f32 v73, v73, v227
    v_mul_f32 v74, v74, v227
    v_mul_f32 v75, v75, v227
    v_mul_f32 v76, v76, v227
    v_mul_f32 v77, v77, v227
    v_mul_f32 v78, v78, v227
    v_mul_f32 v79, v79, v227
    v_mul_f32 v80, v80, v227
    v_mul_f32 v81, v81, v227
    v_mul_f32 v82, v82, v227
    v_mul_f32 v83, v83, v227
    v_mul_f32 v84, v84, v227
    v_mul_f32 v85, v85, v227
    v_mul_f32 v86, v86, v227
    v_mul_f32 v87, v87, v227
    v_mul_f32 v88, v88, v227
    v_mul_f32 v89, v89, v227
    v_mul_f32 v90, v90, v227
    v_mul_f32 v91, v91, v227
    v_mul_f32 v92, v92, v227
    v_mul_f32 v93, v93, v227
    v_mul_f32 v94, v94, v227
    v_mul_f32 v95, v95, v227
    v_mul_f32 v96, v96, v227
    v_mul_f32 v97, v97, v227
    v_mul_f32 v98, v98, v227
    v_mul_f32 v99, v99, v227
    v_mul_f32 v221, v221, v227
    v_mul_f32 v222, v222, v227
    v_fma_f32 v212, v100, s20, -v220
    v_fma_f32 v213, v101, s20, -v220
    v_fma_f32 v214, v102, s20, -v220
    v_fma_f32 v215, v103, s20, -v220
    v_exp_f32 v212, v212
    v_exp_f32 v213, v213
    v_exp_f32 v214, v214
    v_exp_f32 v215, v215
    v_add_f32 v223, v212, v213
    v_add_f32 v224, v214, v215
    v_cvt_pk_bf16_f32 v132, v212, v213
    v_cvt_pk_bf16_f32 v133, v214, v215
    v_fma_f32 v212, v104, s20, -v220
    v_fma_f32 v213, v105, s20, -v220
    v_fma_f32 v214, v106, s20, -v220
    v_fma_f32 v215, v107, s20, -v220
    v_exp_f32 v212, v212
    v_exp_f32 v213, v213
    v_exp_f32 v214, v214
    v_exp_f32 v215, v215
    v_add_f32 v223, v223, v212
    v_add_f32 v224, v224, v213
    v_add_f32 v223, v223, v214
    v_add_f32 v224, v224, v215
    v_cvt_pk_bf16_f32 v134, v212, v213
    v_cvt_pk_bf16_f32 v135, v214, v215
    v_fma_f32 v212, v108, s20, -v220
    v_fma_f32 v213, v109, s20, -v220
    v_fma_f32 v214, v110, s20, -v220
    v_fma_f32 v215, v111, s20, -v220
    v_exp_f32 v212, v212
    v_exp_f32 v213, v213
    v_exp_f32 v214, v214
    v_exp_f32 v215, v215
    v_add_f32 v223, v223, v212
    v_add_f32 v224, v224, v213
    v_add_f32 v223, v223, v214
    v_add_f32 v224, v224, v215
    v_cvt_pk_bf16_f32 v136, v212, v213
    v_cvt_pk_bf16_f32 v137, v214, v215
    v_fma_f32 v212, v112, s20, -v220
    v_fma_f32 v213, v113, s20, -v220
    v_fma_f32 v214, v114, s20, -v220
    v_fma_f32 v215, v115, s20, -v220
    v_exp_f32 v212, v212
    v_exp_f32 v213, v213
    v_exp_f32 v214, v214
    v_exp_f32 v215, v215
    v_add_f32 v223, v223, v212
    v_add_f32 v224, v224, v213
    v_add_f32 v223, v223, v214
    v_add_f32 v224, v224, v215
    v_cvt_pk_bf16_f32 v138, v212, v213
    v_cvt_pk_bf16_f32 v139, v214, v215
    s_nop 3
    s_branch attn_ret_12
attn_fix_13:
    s_waitcnt vmcnt(0) lgkmcnt(0)
    s_nop 15
    s_nop 7
    v_max3_f32 v225, v116, v117, v118
    v_max3_f32 v225, v225, v119, v120
    v_max3_f32 v225, v225, v121, v122
    v_max3_f32 v225, v225, v123, v124
    v_max3_f32 v225, v225, v125, v126
    v_max3_f32 v225, v225, v127, v128
    v_max3_f32 v225, v225, v129, v130
    v_max_f32 v225, v225, v131
    v_mov_b32 v226, v225
    s_nop 1
    v_permlane32_swap_b32 v225, v226
    v_max_f32 v225, v225, v226
    v_mul_f32 v226, s20, v225
    v_max_f32 v226, v220, v226
    v_sub_f32 v227, v220, v226
    v_exp_f32 v227, v227
    v_mov_b32 v220, v226
    v_mul_f32 v36, v36, v227
    v_mul_f32 v37, v37, v227
    v_mul_f32 v38, v38, v227
    v_mul_f32 v39, v39, v227
    v_mul_f32 v40, v40, v227
    v_mul_f32 v41, v41, v227
    v_mul_f32 v42, v42, v227
    v_mul_f32 v43, v43, v227
    v_mul_f32 v44, v44, v227
    v_mul_f32 v45, v45, v227
    v_mul_f32 v46, v46, v227
    v_mul_f32 v47, v47, v227
    v_mul_f32 v48, v48, v227
    v_mul_f32 v49, v49, v227
    v_mul_f32 v50, v50, v227
    v_mul_f32 v51, v51, v227
    v_mul_f32 v52, v52, v227
    v_mul_f32 v53, v53, v227
    v_mul_f32 v54, v54, v227
    v_mul_f32 v55, v55, v227
    v_mul_f32 v56, v56, v227
    v_mul_f32 v57, v57, v227
    v_mul_f32 v58, v58, v227
    v_mul_f32 v59, v59, v227
    v_mul_f32 v60, v60, v227
    v_mul_f32 v61, v61, v227
    v_mul_f32 v62, v62, v227
    v_mul_f32 v63, v63, v227
    v_mul_f32 v64, v64, v227
    v_mul_f32 v65, v65, v227
    v_mul_f32 v66, v66, v227
    v_mul_f32 v67, v67, v227
    v_mul_f32 v68, v68, v227
    v_mul_f32 v69, v69, v227
    v_mul_f32 v70, v70, v227
    v_mul_f32 v71, v71, v227
    v_mul_f32 v72, v72, v227
    v_mul_f32 v73, v73, v227
    v_mul_f32 v74, v74, v227
    v_mul_f32 v75, v75, v227
    v_mul_f32 v76, v76, v227
    v_mul_f32 v77, v77, v227
    v_mul_f32 v78, v78, v227
    v_mul_f32 v79, v79, v227
    v_mul_f32 v80, v80, v227
    v_mul_f32 v81, v81, v227
    v_mul_f32 v82, v82, v227
    v_mul_f32 v83, v83, v227
    v_mul_f32 v84, v84, v227
    v_mul_f32 v85, v85, v227
    v_mul_f32 v86, v86, v227
    v_mul_f32 v87, v87, v227
    v_mul_f32 v88, v88, v227
    v_mul_f32 v89, v89, v227
    v_mul_f32 v90, v90, v227
    v_mul_f32 v91, v91, v227
    v_mul_f32 v92, v92, v227
    v_mul_f32 v93, v93, v227
    v_mul_f32 v94, v94, v227
    v_mul_f32 v95, v95, v227
    v_mul_f32 v96, v96, v227
    v_mul_f32 v97, v97, v227
    v_mul_f32 v98, v98, v227
    v_mul_f32 v99, v99, v227
    v_mul_f32 v221, v221, v227
    v_mul_f32 v222, v222, v227
    v_fma_f32 v212, v116, s20, -v220
    v_fma_f32 v213, v117, s20, -v220
    v_fma_f32 v214, v118, s20, -v220
    v_fma_f32 v215, v119, s20, -v220
    v_exp_f32 v212, v212
    v_exp_f32 v213, v213
    v_exp_f32 v214, v214
    v_exp_f32 v215, v215
    v_add_f32 v223, v212, v213
    v_add_f32 v224, v214, v215
    v_cvt_pk_bf16_f32 v140, v212, v213
    v_cvt_pk_bf16_f32 v141, v214, v215
    v_fma_f32 v212, v120, s20, -v220
    v_fma_f32 v213, v121, s20, -v220
    v_fma_f32 v214, v122, s20, -v220
    v_fma_f32 v215, v123, s20, -v220
    v_exp_f32 v212, v212
    v_exp_f32 v213, v213
    v_exp_f32 v214, v214
    v_exp_f32 v215, v215
    v_add_f32 v223, v223, v212
    v_add_f32 v224, v224, v213
    v_add_f32 v223, v223, v214
    v_add_f32 v224, v224, v215
    v_cvt_pk_bf16_f32 v142, v212, v213
    v_cvt_pk_bf16_f32 v143, v214, v215
    v_fma_f32 v212, v124, s20, -v220
    v_fma_f32 v213, v125, s20, -v220
    v_fma_f32 v214, v126, s20, -v220
    v_fma_f32 v215, v127, s20, -v220
    v_exp_f32 v212, v212
    v_exp_f32 v213, v213
    v_exp_f32 v214, v214
    v_exp_f32 v215, v215
    v_add_f32 v223, v223, v212
    v_add_f32 v224, v224, v213
    v_add_f32 v223, v223, v214
    v_add_f32 v224, v224, v215
    v_cvt_pk_bf16_f32 v144, v212, v213
    v_cvt_pk_bf16_f32 v145, v214, v215
    v_fma_f32 v212, v128, s20, -v220
    v_fma_f32 v213, v129, s20, -v220
    v_fma_f32 v214, v130, s20, -v220
    v_fma_f32 v215, v131, s20, -v220
    v_exp_f32 v212, v212
    v_exp_f32 v213, v213
    v_exp_f32 v214, v214
    v_exp_f32 v215, v215
    v_add_f32 v223, v223, v212
    v_add_f32 v224, v224, v213
    v_add_f32 v223, v223, v214
    v_add_f32 v224, v224, v215
    v_cvt_pk_bf16_f32 v146, v212, v213
    v_cvt_pk_bf16_f32 v147, v214, v215
    s_nop 3
    s_branch attn_ret_13
attn_fix_14:
    s_waitcnt vmcnt(0) lgkmcnt(0)
    s_nop 15
    s_nop 7
    v_max3_f32 v225, v100, v101, v102
    v_max3_f32 v225, v225, v103, v104
    v_max3_f32 v225, v225, v105, v106
    v_max3_f32 v225, v225, v107, v108
    v_max3_f32 v225, v225, v109, v110
    v_max3_f32 v225, v225, v111, v112
    v_max3_f32 v225, v225, v113, v114
    v_max_f32 v225, v225, v115
    v_mov_b32 v226, v225
    s_nop 1
    v_permlane32_swap_b32 v225, v226
    v_max_f32 v225, v225, v226
    v_mul_f32 v226, s20, v225
    v_max_f32 v226, v220, v226
    v_sub_f32 v227, v220, v226
    v_exp_f32 v227, v227
    v_mov_b32 v220, v226
    v_mul_f32 v36, v36, v227
    v_mul_f32 v37, v37, v227
    v_mul_f32 v38, v38, v227
    v_mul_f32 v39, v39, v227
    v_mul_f32 v40, v40, v227
    v_mul_f32 v41, v41, v227
    v_mul_f32 v42, v42, v227
    v_mul_f32 v43, v43, v227
    v_mul_f32 v44, v44, v227
    v_mul_f32 v45, v45, v227
    v_mul_f32 v46, v46, v227
    v_mul_f32 v47, v47, v227
    v_mul_f32 v48, v48, v227
    v_mul_f32 v49, v49, v227
    v_mul_f32 v50, v50, v227
    v_mul_f32 v51, v51, v227
    v_mul_f32 v52, v52, v227
    v_mul_f32 v53, v53, v227
    v_mul_f32 v54, v54, v227
    v_mul_f32 v55, v55, v227
    v_mul_f32 v56, v56, v227
    v_mul_f32 v57, v57, v227
    v_mul_f32 v58, v58, v227
    v_mul_f32 v59, v59, v227
    v_mul_f32 v60, v60, v227
    v_mul_f32 v61, v61, v227
    v_mul_f32 v62, v62, v227
    v_mul_f32 v63, v63, v227
    v_mul_f32 v64, v64, v227
    v_mul_f32 v65, v65, v227
    v_mul_f32 v66, v66, v227
    v_mul_f32 v67, v67, v227
    v_mul_f32 v68, v68, v227
    v_mul_f32 v69, v69, v227
    v_mul_f32 v70, v70, v227
    v_mul_f32 v71, v71, v227
    v_mul_f32 v72, v72, v227
    v_mul_f32 v73, v73, v227
    v_mul_f32 v74, v74, v227
    v_mul_f32 v75, v75, v227
    v_mul_f32 v76, v76, v227
    v_mul_f32 v77, v77, v227
    v_mul_f32 v78, v78, v227
    v_mul_f32 v79, v79, v227
    v_mul_f32 v80, v80, v227
    v_mul_f32 v81, v81, v227
    v_mul_f32 v82, v82, v227
    v_mul_f32 v83, v83, v227
    v_mul_f32 v84, v84, v227
    v_mul_f32 v85, v85, v227
    v_mul_f32 v86, v86, v227
    v_mul_f32 v87, v87, v227
    v_mul_f32 v88, v88, v227
    v_mul_f32 v89, v89, v227
    v_mul_f32 v90, v90, v227
    v_mul_f32 v91, v91, v227
    v_mul_f32 v92, v92, v227
    v_mul_f32 v93, v93, v227
    v_mul_f32 v94, v94, v227
    v_mul_f32 v95, v95, v227
    v_mul_f32 v96, v96, v227
    v_mul_f32 v97, v97, v227
    v_mul_f32 v98, v98, v227
    v_mul_f32 v99, v99, v227
    v_mul_f32 v221, v221, v227
    v_mul_f32 v222, v222, v227
    v_fma_f32 v212, v100, s20, -v220
    v_fma_f32 v213, v101, s20, -v220
    v_fma_f32 v214, v102, s20, -v220
    v_fma_f32 v215, v103, s20, -v220
    v_exp_f32 v212, v212
    v_exp_f32 v213, v213
    v_exp_f32 v214, v214
    v_exp_f32 v215, v215
    v_add_f32 v223, v212, v213
    v_add_f32 v224, v214, v215
    v_cvt_pk_bf16_f32 v132, v212, v213
    v_cvt_pk_bf16_f32 v133, v214, v215
    v_fma_f32 v212, v104, s20, -v220
    v_fma_f32 v213, v105, s20, -v220
    v_fma_f32 v214, v106, s20, -v220
    v_fma_f32 v215, v107, s20, -v220
    v_exp_f32 v212, v212
    v_exp_f32 v213, v213
    v_exp_f32 v214, v214
    v_exp_f32 v215, v215
    v_add_f32 v223, v223, v212
    v_add_f32 v224, v224, v213
    v_add_f32 v223, v223, v214
    v_add_f32 v224, v224, v215
    v_cvt_pk_bf16_f32 v134, v212, v213
    v_cvt_pk_bf16_f32 v135, v214, v215
    v_fma_f32 v212, v108, s20, -v220
    v_fma_f32 v213, v109, s20, -v220
    v_fma_f32 v214, v110, s20, -v220
    v_fma_f32 v215, v111, s20, -v220
    v_exp_f32 v212, v212
    v_exp_f32 v213, v213
    v_exp_f32 v214, v214
    v_exp_f32 v215, v215
    v_add_f32 v223, v223, v212
    v_add_f32 v224, v224, v213
    v_add_f32 v223, v223, v214
    v_add_f32 v224, v224, v215
    v_cvt_pk_bf16_f32 v136, v212, v213
    v_cvt_pk_bf16_f32 v137, v214, v215
    v_fma_f32 v212, v112, s20, -v220
    v_fma_f32 v213, v113, s20, -v220
    v_fma_f32 v214, v114, s20, -v220
    v_fma_f32 v215, v115, s20, -v220
    v_exp_f32 v212, v212
    v_exp_f32 v213, v213
    v_exp_f32 v214, v214
    v_exp_f32 v215, v215
    v_add_f32 v223, v223, v212
    v_add_f32 v224, v224, v213
    v_add_f32 v223, v223, v214
    v_add_f32 v224, v224, v215
    v_cvt_pk_bf16_f32 v138, v212, v213
    v_cvt_pk_bf16_f32 v139, v214, v215
    s_nop 3
    s_branch attn_ret_14
attn_fix_15:
    s_waitcnt vmcnt(0) lgkmcnt(0)
    s_nop 15
    s_nop 7
    v_max3_f32 v225, v116, v117, v118
    v_max3_f32 v225, v225, v119, v120
    v_max3_f32 v225, v225, v121, v122
    v_max3_f32 v225, v225, v123, v124
    v_max3_f32 v225, v225, v125, v126
    v_max3_f32 v225, v225, v127, v128
    v_max3_f32 v225, v225, v129, v130
    v_max_f32 v225, v225, v131
    v_mov_b32 v226, v225
    s_nop 1
    v_permlane32_swap_b32 v225, v226
    v_max_f32 v225, v225, v226
    v_mul_f32 v226, s20, v225
    v_max_f32 v226, v220, v226
    v_sub_f32 v227, v220, v226
    v_exp_f32 v227, v227
    v_mov_b32 v220, v226
    v_mul_f32 v36, v36, v227
    v_mul_f32 v37, v37, v227
    v_mul_f32 v38, v38, v227
    v_mul_f32 v39, v39, v227
    v_mul_f32 v40, v40, v227
    v_mul_f32 v41, v41, v227
    v_mul_f32 v42, v42, v227
    v_mul_f32 v43, v43, v227
    v_mul_f32 v44, v44, v227
    v_mul_f32 v45, v45, v227
    v_mul_f32 v46, v46, v227
    v_mul_f32 v47, v47, v227
    v_mul_f32 v48, v48, v227
    v_mul_f32 v49, v49, v227
    v_mul_f32 v50, v50, v227
    v_mul_f32 v51, v51, v227
    v_mul_f32 v52, v52, v227
    v_mul_f32 v53, v53, v227
    v_mul_f32 v54, v54, v227
    v_mul_f32 v55, v55, v227
    v_mul_f32 v56, v56, v227
    v_mul_f32 v57, v57, v227
    v_mul_f32 v58, v58, v227
    v_mul_f32 v59, v59, v227
    v_mul_f32 v60, v60, v227
    v_mul_f32 v61, v61, v227
    v_mul_f32 v62, v62, v227
    v_mul_f32 v63, v63, v227
    v_mul_f32 v64, v64, v227
    v_mul_f32 v65, v65, v227
    v_mul_f32 v66, v66, v227
    v_mul_f32 v67, v67, v227
    v_mul_f32 v68, v68, v227
    v_mul_f32 v69, v69, v227
    v_mul_f32 v70, v70, v227
    v_mul_f32 v71, v71, v227
    v_mul_f32 v72, v72, v227
    v_mul_f32 v73, v73, v227
    v_mul_f32 v74, v74, v227
    v_mul_f32 v75, v75, v227
    v_mul_f32 v76, v76, v227
    v_mul_f32 v77, v77, v227
    v_mul_f32 v78, v78, v227
    v_mul_f32 v79, v79, v227
    v_mul_f32 v80, v80, v227
    v_mul_f32 v81, v81, v227
    v_mul_f32 v82, v82, v227
    v_mul_f32 v83, v83, v227
    v_mul_f32 v84, v84, v227
    v_mul_f32 v85, v85, v227
    v_mul_f32 v86, v86, v227
    v_mul_f32 v87, v87, v227
    v_mul_f32 v88, v88, v227
    v_mul_f32 v89, v89, v227
    v_mul_f32 v90, v90, v227
    v_mul_f32 v91, v91, v227
    v_mul_f32 v92, v92, v227
    v_mul_f32 v93, v93, v227
    v_mul_f32 v94, v94, v227
    v_mul_f32 v95, v95, v227
    v_mul_f32 v96, v96, v227
    v_mul_f32 v97, v97, v227
    v_mul_f32 v98, v98, v227
    v_mul_f32 v99, v99, v227
    v_mul_f32 v221, v221, v227
    v_mul_f32 v222, v222, v227
    v_fma_f32 v212, v116, s20, -v220
    v_fma_f32 v213, v117, s20, -v220
    v_fma_f32 v214, v118, s20, -v220
    v_fma_f32 v215, v119, s20, -v220
    v_exp_f32 v212, v212
    v_exp_f32 v213, v213
    v_exp_f32 v214, v214
    v_exp_f32 v215, v215
    v_add_f32 v223, v212, v213
    v_add_f32 v224, v214, v215
    v_cvt_pk_bf16_f32 v140, v212, v213
    v_cvt_pk_bf16_f32 v141, v214, v215
    v_fma_f32 v212, v120, s20, -v220
    v_fma_f32 v213, v121, s20, -v220
    v_fma_f32 v214, v122, s20, -v220
    v_fma_f32 v215, v123, s20, -v220
    v_exp_f32 v212, v212
    v_exp_f32 v213, v213
    v_exp_f32 v214, v214
    v_exp_f32 v215, v215
    v_add_f32 v223, v223, v212
    v_add_f32 v224, v224, v213
    v_add_f32 v223, v223, v214
    v_add_f32 v224, v224, v215
    v_cvt_pk_bf16_f32 v142, v212, v213
    v_cvt_pk_bf16_f32 v143, v214, v215
    v_fma_f32 v212, v124, s20, -v220
    v_fma_f32 v213, v125, s20, -v220
    v_fma_f32 v214, v126, s20, -v220
    v_fma_f32 v215, v127, s20, -v220
    v_exp_f32 v212, v212
    v_exp_f32 v213, v213
    v_exp_f32 v214, v214
    v_exp_f32 v215, v215
    v_add_f32 v223, v223, v212
    v_add_f32 v224, v224, v213
    v_add_f32 v223, v223, v214
    v_add_f32 v224, v224, v215
    v_cvt_pk_bf16_f32 v144, v212, v213
    v_cvt_pk_bf16_f32 v145, v214, v215
    v_fma_f32 v212, v128, s20, -v220
    v_fma_f32 v213, v129, s20, -v220
    v_fma_f32 v214, v130, s20, -v220
    v_fma_f32 v215, v131, s20, -v220
    v_exp_f32 v212, v212
    v_exp_f32 v213, v213
    v_exp_f32 v214, v214
    v_exp_f32 v215, v215
    v_add_f32 v223, v223, v212
    v_add_f32 v224, v224, v213
    v_add_f32 v223, v223, v214
    v_add_f32 v224, v224, v215
    v_cvt_pk_bf16_f32 v146, v212, v213
    v_cvt_pk_bf16_f32 v147, v214, v215
    s_nop 3
    s_branch attn_ret_15
attn_kernel_end:
    s_endpgm
.globl gemm2_kernel
.p2align 8
.type gemm2_kernel,@function
gemm2_kernel:
    s_cmp_ge_u32 s2, 256
    s_cbranch_scc1 gemm2_kernel_end
    s_load_dwordx2 s[32:33], s[0:1], 80
    s_load_dwordx2 s[34:35], s[0:1], 32
    s_load_dwordx2 s[36:37], s[0:1], 56
    s_load_dwordx2 s[12:13], s[0:1], 64
    s_load_dwordx2 s[52:53], s[0:1], 0
    s_and_b32 s26, s2, 7
    s_lshr_b32 s27, s2, 3
    s_bfe_u32 s28, s26, 65537
    s_lshl_b32 s28, s28, 3
    s_and_b32 s30, s27, 7
    s_add_u32 s28, s28, s30
    s_and_b32 s29, s26, 1
    s_lshl_b32 s29, s29, 2
    s_lshr_b32 s30, s27, 3
    s_add_u32 s29, s29, s30
    s_lshr_b32 s27, s26, 2
    s_lshl_b32 s27, s27, 4
    s_cmp_lt_u32 s27, 16
    s_waitcnt lgkmcnt(0)
    s_cselect_b32 s38, s34, s36
    s_cmp_lt_u32 s27, 16
    s_cselect_b32 s39, s35, s37
    s_mov_b32 s21, 2048
    s_mov_b32 s22, 2048
    s_mov_b32 s20, 7424
    s_cmp_lt_u32 s27, 16
    s_cselect_b32 s20, 8448, s20
    s_mov_b32 s23, 1
    s_cmp_lt_u32 s27, 16
    s_cselect_b32 s23, 0, s23
    s_mov_b32 s40, 23068672
    s_cmp_lt_u32 s27, 16
    s_cselect_b32 s40, 39845888, s40
    s_mov_b32 s41, 15204352
    s_cmp_lt_u32 s27, 16
    s_cselect_b32 s41, 17301504, s41
    s_mov_b32 s42, 7340032
    s_cmp_lt_u32 s27, 16
    s_cselect_b32 s42, 8388608, s42
    s_mov_b32 s19, 12
    s_cmp_lt_u32 s27, 16
    s_cselect_b32 s19, 14, s19
    s_lshl_b32 s43, s28, 7
    s_mul_i32 s43, s43, s20
    s_add_u32 s44, s43, s40
    s_add_u32 s4, s32, s44
    s_addc_u32 s5, s33, 0
    s_and_b32 s5, s5, 65535
    s_mov_b32 s6, 0
    s_mov_b32 s7, 131072
    s_sub_u32 s6, s41, s43
    s_lshl_b32 s43, s29, 8
    s_add_u32 s8, s38, s43
    s_addc_u32 s9, s39, 0
    s_and_b32 s9, s9, 65535
    s_mov_b32 s10, 0
    s_mov_b32 s11, 131072
    s_sub_u32 s10, s42, s43
    s_lshl_b32 s43, s29, 8
    s_lshl_b32 s44, s28, 18
    s_add_u32 s43, s43, s44
    s_cmp_lt_u32 s27, 16
    s_cselect_b32 s12, s12, s32
    s_cmp_lt_u32 s27, 16
    s_cselect_b32 s13, s13, s33
    s_mov_b32 s45, 62914560
    s_cmp_lt_u32 s27, 16
    s_cselect_b32 s45, 0, s45
    s_add_u32 s44, s43, s45
    s_add_u32 s12, s12, s44
    s_addc_u32 s13, s13, 0
    s_and_b32 s13, s13, 65535
    s_mov_b32 s14, 0
    s_mov_b32 s15, 131072
    s_sub_u32 s14, 4194304, s43
    s_add_u32 s52, s52, s43
    s_addc_u32 s53, s53, 0
    s_and_b32 s53, s53, 65535
    s_mov_b32 s54, 0
    s_mov_b32 s55, 131072
    s_sub_u32 s54, 4194304, s43
    s_add_u32 s44, s43, 62914560
    s_add_u32 s56, s32, s44
    s_addc_u32 s57, s33, 0
    s_and_b32 s57, s57, 65535
    s_mov_b32 s58, 0
    s_mov_b32 s59, 131072
    s_sub_u32 s58, 4194304, s43
    s_add_u32 s60, s32, 67108864
    s_addc_u32 s61, s33, 0
    s_and_b32 s61, s61, 65535
    s_mov_b32 s62, 512
    s_mov_b32 s63, 131072
    s_lshl_b32 s50, s28, 3
    s_add_u32 s50, s50, s29
    s_lshl_b32 s50, s50, 2
    v_and_b32 v100, 63, v0
    v_lshrrev_b32 v101, 6, v0
    s_nop 0
    v_readfirstlane_b32 s26, v101
    s_mul_i32 s24, s26, 4096
    s_mul_i32 s25, s26, 4096
    s_mov_b32 s16, 0
    s_mov_b32 s17, 0
    s_lshl_b32 s18, s21, 6
    s_add_u32 m0, s24, 0
    v_and_b32 v102, 7, v100
    v_lshrrev_b32 v103, 3, v100
    v_mad_u32_u24 v103, v101, 32, v103
    v_add_u32 v104, 0, v103
    v_bfe_u32 v105, v104, 1, 3
    v_xor_b32 v105, v105, v102
    v_lshlrev_b32 v105, 4, v105
    v_mad_u32_u24 v68, v104, s20, v105
    buffer_load_dwordx4 v68, s[4:7], s16 offen lds
    s_add_u32 m0, s24, 1024
    v_add_u32 v104, 8, v103
    v_bfe_u32 v105, v104, 1, 3
    v_xor_b32 v105, v105, v102
    v_lshlrev_b32 v105, 4, v105
    v_mad_u32_u24 v69, v104, s20, v105
    buffer_load_dwordx4 v69, s[4:7], s16 offen lds
    s_add_u32 m0, s24, 2048
    v_add_u32 v104, 16, v103
    v_bfe_u32 v105, v104, 1, 3
    v_xor_b32 v105, v105, v102
    v_lshlrev_b32 v105, 4, v105
    v_mad_u32_u24 v70, v104, s20, v105
    buffer_load_dwordx4 v70, s[4:7], s16 offen lds
    s_add_u32 m0, s24, 3072
    v_add_u32 v104, 24, v103
    v_bfe_u32 v105, v104, 1, 3
    v_xor_b32 v105, v105, v102
    v_lshlrev_b32 v105, 4, v105
    v_mad_u32_u24 v71, v104, s20, v105
    buffer_load_dwordx4 v71, s[4:7], s16 offen lds
    s_add_u32 m0, s25, 16384
    v_and_b32 v102, 15, v100
    v_lshrrev_b32 v103, 4, v100
    v_mad_u32_u24 v103, v101, 16, v103
    v_add_u32 v104, 0, v103
    v_and_b32 v105, 3, v104
    v_bfe_u32 v106, v104, 3, 1
    v_lshl_or_b32 v105, v106, 2, v105
    v_lshrrev_b32 v106, 1, v102
    v_xor_b32 v105, v105, v106
    v_lshlrev_b32 v105, 5, v105
    v_and_b32 v106, 1, v102
    v_lshl_or_b32 v105, v106, 4, v105
    v_mad_u32_u24 v72, v104, s21, v105
    buffer_load_dwordx4 v72, s[8:11], s17 offen lds
    s_add_u32 m0, s25, 17408
    v_add_u32 v104, 4, v103
    v_and_b32 v105, 3, v104
    v_bfe_u32 v106, v104, 3, 1
    v_lshl_or_b32 v105, v106, 2, v105
    v_lshrrev_b32 v106, 1, v102
    v_xor_b32 v105, v105, v106
    v_lshlrev_b32 v105, 5, v105
    v_and_b32 v106, 1, v102
    v_lshl_or_b32 v105, v106, 4, v105
    v_mad_u32_u24 v73, v104, s21, v105
    buffer_load_dwordx4 v73, s[8:11], s17 offen lds
    s_add_u32 m0, s25, 18432
    v_add_u32 v104, 8, v103
    v_and_b32 v105, 3, v104
    v_bfe_u32 v106, v104, 3, 1
    v_lshl_or_b32 v105, v106, 2, v105
    v_lshrrev_b32 v106, 1, v102
    v_xor_b32 v105, v105, v106
    v_lshlrev_b32 v105, 5, v105
    v_and_b32 v106, 1, v102
    v_lshl_or_b32 v105, v106, 4, v105
    v_mad_u32_u24 v74, v104, s21, v105
    buffer_load_dwordx4 v74, s[8:11], s17 offen lds
    s_add_u32 m0, s25, 19456
    v_add_u32 v104, 12, v103
    v_and_b32 v105, 3, v104
    v_bfe_u32 v106, v104, 3, 1
    v_lshl_or_b32 v105, v106, 2, v105
    v_lshrrev_b32 v106, 1, v102
    v_xor_b32 v105, v105, v106
    v_lshlrev_b32 v105, 5, v105
    v_and_b32 v106, 1, v102
    v_lshl_or_b32 v105, v106, 4, v105
    v_mad_u32_u24 v75, v104, s21, v105
    buffer_load_dwordx4 v75, s[8:11], s17 offen lds
    s_add_u32 s16, s16, 128
    s_add_u32 s17, s17, s18
    s_add_u32 m0, s24, 32768
    v_lshrrev_b32 v102, 1, v101
    v_and_b32 v103, 1, v101
    v_and_b32 v104, 15, v100
    v_lshrrev_b32 v105, 4, v100
    v_mul_u32_u24 v106, 64, v102
    v_add_u32 v106, v106, v104
    v_lshlrev_b32 v106, 7, v106
    v_lshrrev_b32 v107, 1, v104
    v_xor_b32 v107, v107, v105
    v_lshl_add_u32 v76, v107, 4, v106
    v_xor_b32 v77, 64, v76
    v_add_u32 v78, 32768, v76
    v_add_u32 v79, 32768, v77
    v_add_u32 v80, 65536, v76
    v_add_u32 v81, 65536, v77
    buffer_load_dwordx4 v68, s[4:7], s16 offen lds
    s_add_u32 m0, s24, 33792
    v_add_u32 v82, 98304, v76
    v_add_u32 v83, 98304, v77
    v_lshrrev_b32 v108, 4, v100
    v_bfe_u32 v109, v100, 2, 2
    v_and_b32 v110, 3, v100
    v_and_b32 v111, 1, v108
    v_lshl_or_b32 v111, v111, 2, v109
    v_lshl_add_u32 v106, v108, 3, v109
    v_mul_u32_u24 v106, 256, v106
    v_lshl_add_u32 v106, v110, 3, v106
    v_add_u32 v106, 16384, v106
    v_mul_u32_u24 v107, 4, v103
    v_add_u32 v107, 0, v107
    v_xor_b32 v107, v107, v111
    v_lshl_add_u32 v84, v107, 5, v106
    buffer_load_dwordx4 v69, s[4:7], s16 offen lds
    s_add_u32 m0, s24, 34816
    v_add_u32 v88, 32768, v84
    v_add_u32 v92, 65536, v84
    v_add_u32 v96, 98304, v84
    v_mul_u32_u24 v107, 4, v103
    v_add_u32 v107, 1, v107
    v_xor_b32 v107, v107, v111
    v_lshl_add_u32 v85, v107, 5, v106
    v_add_u32 v89, 32768, v85
    v_add_u32 v93, 65536, v85
    v_add_u32 v97, 98304, v85
    v_mul_u32_u24 v107, 4, v103
    v_add_u32 v107, 2, v107
    v_xor_b32 v107, v107, v111
    v_lshl_add_u32 v86, v107, 5, v106
    v_add_u32 v90, 32768, v86
    buffer_load_dwordx4 v70, s[4:7], s16 offen lds
    s_add_u32 m0, s24, 35840
    v_add_u32 v94, 65536, v86
    v_add_u32 v98, 98304, v86
    v_mul_u32_u24 v107, 4, v103
    v_add_u32 v107, 3, v107
    v_xor_b32 v107, v107, v111
    v_lshl_add_u32 v87, v107, 5, v106
    v_add_u32 v91, 32768, v87
    v_add_u32 v95, 65536, v87
    v_add_u32 v99, 98304, v87
    v_accvgpr_write_b32 a0, 0
    v_accvgpr_write_b32 a1, 0
    v_accvgpr_write_b32 a2, 0
    v_accvgpr_write_b32 a3, 0
    v_accvgpr_write_b32 a4, 0
    v_accvgpr_write_b32 a5, 0
    buffer_load_dwordx4 v71, s[4:7], s16 offen lds
    s_add_u32 m0, s25, 49152
    v_accvgpr_write_b32 a6, 0
    v_accvgpr_write_b32 a7, 0
    v_accvgpr_write_b32 a8, 0
    v_accvgpr_write_b32 a9, 0
    v_accvgpr_write_b32 a10, 0
    v_accvgpr_write_b32 a11, 0
    v_accvgpr_write_b32 a12, 0
    v_accvgpr_write_b32 a13, 0
    v_accvgpr_write_b32 a14, 0
    v_accvgpr_write_b32 a15, 0
    v_accvgpr_write_b32 a16, 0
    v_accvgpr_write_b32 a17, 0
    v_accvgpr_write_b32 a18, 0
    v_accvgpr_write_b32 a19, 0
    v_accvgpr_write_b32 a20, 0
    buffer_load_dwordx4 v72, s[8:11], s17 offen lds
    s_add_u32 m0, s25, 50176
    v_accvgpr_write_b32 a21, 0
    v_accvgpr_write_b32 a22, 0
    v_accvgpr_write_b32 a23, 0
    v_accvgpr_write_b32 a24, 0
    v_accvgpr_write_b32 a25, 0
    v_accvgpr_write_b32 a26, 0
    v_accvgpr_write_b32 a27, 0
    v_accvgpr_write_b32 a28, 0
    v_accvgpr_write_b32 a29, 0
    v_accvgpr_write_b32 a30, 0
    v_accvgpr_write_b32 a31, 0
    v_accvgpr_write_b32 a32, 0
    v_accvgpr_write_b32 a33, 0
    v_accvgpr_write_b32 a34, 0
    v_accvgpr_write_b32 a35, 0
    buffer_load_dwordx4 v73, s[8:11], s17 offen lds
    s_add_u32 m0, s25, 51200
    v_accvgpr_write_b32 a36, 0
    v_accvgpr_write_b32 a37, 0
    v_accvgpr_write_b32 a38, 0
    v_accvgpr_write_b32 a39, 0
    v_accvgpr_write_b32 a40, 0
    v_accvgpr_write_b32 a41, 0
    v_accvgpr_write_b32 a42, 0
    v_accvgpr_write_b32 a43, 0
    v_accvgpr_write_b32 a44, 0
    v_accvgpr_write_b32 a45, 0
    v_accvgpr_write_b32 a46, 0
    v_accvgpr_write_b32 a47, 0
    v_accvgpr_write_b32 a48, 0
    v_accvgpr_write_b32 a49, 0
    v_accvgpr_write_b32 a50, 0
    buffer_load_dwordx4 v74, s[8:11], s17 offen lds
    s_add_u32 m0, s25, 52224
    v_accvgpr_write_b32 a51, 0
    v_accvgpr_write_b32 a52, 0
    v_accvgpr_write_b32 a53, 0
    v_accvgpr_write_b32 a54, 0
    v_accvgpr_write_b32 a55, 0
    v_accvgpr_write_b32 a56, 0
    v_accvgpr_write_b32 a57, 0
    v_accvgpr_write_b32 a58, 0
    v_accvgpr_write_b32 a59, 0
    v_accvgpr_write_b32 a60, 0
    v_accvgpr_write_b32 a61, 0
    v_accvgpr_write_b32 a62, 0
    v_accvgpr_write_b32 a63, 0
    buffer_load_dwordx4 v75, s[8:11], s17 offen lds
    s_add_u32 s16, s16, 128
    s_add_u32 s17, s17, s18
    s_waitcnt vmcnt(8)
    s_barrier
    ds_read_b64_tr_b16 v[4:5], v84
    ds_read_b64_tr_b16 v[6:7], v84 offset:1024
    ds_read_b128 v[20:23], v76
    ds_read_b64_tr_b16 v[8:9], v85
    ds_read_b64_tr_b16 v[10:11], v85 offset:1024
    ds_read_b128 v[24:27], v76 offset:2048
    ds_read_b64_tr_b16 v[12:13], v86
    ds_read_b64_tr_b16 v[14:15], v86 offset:1024
    ds_read_b128 v[28:31], v76 offset:4096
    ds_read_b64_tr_b16 v[16:17], v87
    ds_read_b64_tr_b16 v[18:19], v87 offset:1024
    ds_read_b128 v[32:35], v76 offset:6144
    s_waitcnt lgkmcnt(9)
    v_mfma_f32_16x16x32_bf16 a[0:3], v[4:7], v[20:23], a[0:3]
    ds_read_b64_tr_b16 v[36:37], v84 offset:8192
    s_waitcnt lgkmcnt(7)
    v_mfma_f32_16x16x32_bf16 a[4:7], v[4:7], v[24:27], a[4:7]
    ds_read_b64_tr_b16 v[38:39], v84 offset:9216
    s_add_u32 m0, s24, 65536
    s_nop 0
    buffer_load_dwordx4 v68, s[4:7], s16 offen lds
    s_add_u32 m0, s24, 66560
    s_waitcnt lgkmcnt(5)
    v_mfma_f32_16x16x32_bf16 a[8:11], v[4:7], v[28:31], a[8:11]
    ds_read_b128 v[52:55], v77
    buffer_load_dwordx4 v69, s[4:7], s16 offen lds
    s_add_u32 m0, s24, 67584
    s_waitcnt lgkmcnt(3)
    v_mfma_f32_16x16x32_bf16 a[12:15], v[4:7], v[32:35], a[12:15]
    ds_read_b64_tr_b16 v[40:41], v85 offset:8192
    buffer_load_dwordx4 v70, s[4:7], s16 offen lds
    s_add_u32 m0, s24, 68608
    s_nop 0
    buffer_load_dwordx4 v71, s[4:7], s16 offen lds
    v_mfma_f32_16x16x32_bf16 a[16:19], v[8:11], v[20:23], a[16:19]
    ds_read_b64_tr_b16 v[42:43], v85 offset:9216
    s_add_u32 m0, s25, 81920
    s_nop 0
    buffer_load_dwordx4 v72, s[8:11], s17 offen lds
    v_mfma_f32_16x16x32_bf16 a[20:23], v[8:11], v[24:27], a[20:23]
    ds_read_b128 v[56:59], v77 offset:2048
    s_add_u32 m0, s25, 82944
    s_nop 0
    buffer_load_dwordx4 v73, s[8:11], s17 offen lds
    v_mfma_f32_16x16x32_bf16 a[24:27], v[8:11], v[28:31], a[24:27]
    ds_read_b64_tr_b16 v[44:45], v86 offset:8192
    s_add_u32 m0, s25, 83968
    s_nop 0
    buffer_load_dwordx4 v74, s[8:11], s17 offen lds
    s_add_u32 m0, s25, 84992
    v_mfma_f32_16x16x32_bf16 a[28:31], v[8:11], v[32:35], a[28:31]
    ds_read_b64_tr_b16 v[46:47], v86 offset:9216
    buffer_load_dwordx4 v75, s[8:11], s17 offen lds
    s_add_u32 s16, s16, 128
    v_mfma_f32_16x16x32_bf16 a[32:35], v[12:15], v[20:23], a[32:35]
    ds_read_b128 v[60:63], v77 offset:4096
    s_add_u32 s17, s17, s18
    s_add_u32 m0, s24, 98304
    s_nop 0
    buffer_load_dwordx4 v68, s[4:7], s16 offen lds
    v_mfma_f32_16x16x32_bf16 a[36:39], v[12:15], v[24:27], a[36:39]
    ds_read_b64_tr_b16 v[48:49], v87 offset:8192
    s_add_u32 m0, s24, 99328
    s_nop 0
    buffer_load_dwordx4 v69, s[4:7], s16 offen lds
    v_mfma_f32_16x16x32_bf16 a[40:43], v[12:15], v[28:31], a[40:43]
    ds_read_b64_tr_b16 v[50:51], v87 offset:9216
    s_add_u32 m0, s24, 100352
    s_nop 0
    buffer_load_dwordx4 v70, s[4:7], s16 offen lds
    v_mfma_f32_16x16x32_bf16 a[44:47], v[12:15], v[32:35], a[44:47]
    ds_read_b128 v[64:67], v77 offset:6144
    s_add_u32 m0, s24, 101376
    s_nop 0
    buffer_load_dwordx4 v71, s[4:7], s16 offen lds
    s_add_u32 m0, s25, 114688
    v_mfma_f32_16x16x32_bf16 a[48:51], v[16:19], v[20:23], a[48:51]
    buffer_load_dwordx4 v72, s[8:11], s17 offen lds
    s_add_u32 m0, s25, 115712
    v_mfma_f32_16x16x32_bf16 a[52:55], v[16:19], v[24:27], a[52:55]
    buffer_load_dwordx4 v73, s[8:11], s17 offen lds
    s_add_u32 m0, s25, 116736
    s_nop 0
    buffer_load_dwordx4 v74, s[8:11], s17 offen lds
    v_mfma_f32_16x16x32_bf16 a[56:59], v[16:19], v[28:31], a[56:59]
    s_add_u32 m0, s25, 117760
    s_nop 0
    buffer_load_dwordx4 v75, s[8:11], s17 offen lds
    v_mfma_f32_16x16x32_bf16 a[60:63], v[16:19], v[32:35], a[60:63]
    s_add_u32 s16, s16, 128
    s_add_u32 s17, s17, s18
    s_waitcnt vmcnt(16) lgkmcnt(0)
    s_barrier
    v_mfma_f32_16x16x32_bf16 a[0:3], v[36:39], v[52:55], a[0:3]
    ds_read_b64_tr_b16 v[4:5], v88
    v_mfma_f32_16x16x32_bf16 a[4:7], v[36:39], v[56:59], a[4:7]
    ds_read_b64_tr_b16 v[6:7], v88 offset:1024
    s_add_u32 m0, s24, 0
    s_nop 0
    buffer_load_dwordx4 v68, s[4:7], s16 offen lds
    v_mfma_f32_16x16x32_bf16 a[8:11], v[36:39], v[60:63], a[8:11]
    ds_read_b128 v[20:23], v78
    s_add_u32 m0, s24, 1024
    v_mfma_f32_16x16x32_bf16 a[12:15], v[36:39], v[64:67], a[12:15]
    ds_read_b64_tr_b16 v[8:9], v89
    buffer_load_dwordx4 v69, s[4:7], s16 offen lds
    v_mfma_f32_16x16x32_bf16 a[16:19], v[40:43], v[52:55], a[16:19]
    ds_read_b64_tr_b16 v[10:11], v89 offset:1024
    s_add_u32 m0, s24, 2048
    v_mfma_f32_16x16x32_bf16 a[20:23], v[40:43], v[56:59], a[20:23]
    ds_read_b128 v[24:27], v78 offset:2048
    buffer_load_dwordx4 v70, s[4:7], s16 offen lds
    v_mfma_f32_16x16x32_bf16 a[24:27], v[40:43], v[60:63], a[24:27]
    ds_read_b64_tr_b16 v[12:13], v90
    s_add_u32 m0, s24, 3072
    v_mfma_f32_16x16x32_bf16 a[28:31], v[40:43], v[64:67], a[28:31]
    ds_read_b64_tr_b16 v[14:15], v90 offset:1024
    buffer_load_dwordx4 v71, s[4:7], s16 offen lds
    v_mfma_f32_16x16x32_bf16 a[32:35], v[44:47], v[52:55], a[32:35]
    ds_read_b128 v[28:31], v78 offset:4096
    s_add_u32 m0, s25, 16384
    v_mfma_f32_16x16x32_bf16 a[36:39], v[44:47], v[56:59], a[36:39]
    ds_read_b64_tr_b16 v[16:17], v91
    buffer_load_dwordx4 v72, s[8:11], s17 offen lds
    v_mfma_f32_16x16x32_bf16 a[40:43], v[44:47], v[60:63], a[40:43]
    ds_read_b64_tr_b16 v[18:19], v91 offset:1024
    s_add_u32 m0, s25, 17408
    v_mfma_f32_16x16x32_bf16 a[44:47], v[44:47], v[64:67], a[44:47]
    ds_read_b128 v[32:35], v78 offset:6144
    buffer_load_dwordx4 v73, s[8:11], s17 offen lds
    v_mfma_f32_16x16x32_bf16 a[48:51], v[48:51], v[52:55], a[48:51]
    s_add_u32 m0, s25, 18432
    v_mfma_f32_16x16x32_bf16 a[52:55], v[48:51], v[56:59], a[52:55]
    buffer_load_dwordx4 v74, s[8:11], s17 offen lds
    v_mfma_f32_16x16x32_bf16 a[56:59], v[48:51], v[60:63], a[56:59]
    s_add_u32 m0, s25, 19456
    v_mfma_f32_16x16x32_bf16 a[60:63], v[48:51], v[64:67], a[60:63]
    buffer_load_dwordx4 v75, s[8:11], s17 offen lds
    s_add_u32 s16, s16, 128
    s_add_u32 s17, s17, s18
    s_waitcnt lgkmcnt(9)
    v_mfma_f32_16x16x32_bf16 a[0:3], v[4:7], v[20:23], a[0:3]
    ds_read_b64_tr_b16 v[36:37], v88 offset:8192
    s_waitcnt lgkmcnt(7)
    v_mfma_f32_16x16x32_bf16 a[4:7], v[4:7], v[24:27], a[4:7]
    ds_read_b64_tr_b16 v[38:39], v88 offset:9216
    s_waitcnt lgkmcnt(5)
    v_mfma_f32_16x16x32_bf16 a[8:11], v[4:7], v[28:31], a[8:11]
    ds_read_b128 v[52:55], v79
    s_waitcnt lgkmcnt(3)
    v_mfma_f32_16x16x32_bf16 a[12:15], v[4:7], v[32:35], a[12:15]
    ds_read_b64_tr_b16 v[40:41], v89 offset:8192
    v_mfma_f32_16x16x32_bf16 a[16:19], v[8:11], v[20:23], a[16:19]
    ds_read_b64_tr_b16 v[42:43], v89 offset:9216
    v_mfma_f32_16x16x32_bf16 a[20:23], v[8:11], v[24:27], a[20:23]
    ds_read_b128 v[56:59], v79 offset:2048
    v_mfma_f32_16x16x32_bf16 a[24:27], v[8:11], v[28:31], a[24:27]
    ds_read_b64_tr_b16 v[44:45], v90 offset:8192
    v_mfma_f32_16x16x32_bf16 a[28:31], v[8:11], v[32:35], a[28:31]
    ds_read_b64_tr_b16 v[46:47], v90 offset:9216
    v_mfma_f32_16x16x32_bf16 a[32:35], v[12:15], v[20:23], a[32:35]
    ds_read_b128 v[60:63], v79 offset:4096
    v_mfma_f32_16x16x32_bf16 a[36:39], v[12:15], v[24:27], a[36:39]
    ds_read_b64_tr_b16 v[48:49], v91 offset:8192
    v_mfma_f32_16x16x32_bf16 a[40:43], v[12:15], v[28:31], a[40:43]
    ds_read_b64_tr_b16 v[50:51], v91 offset:9216
    v_mfma_f32_16x16x32_bf16 a[44:47], v[12:15], v[32:35], a[44:47]
    ds_read_b128 v[64:67], v79 offset:6144
    v_mfma_f32_16x16x32_bf16 a[48:51], v[16:19], v[20:23], a[48:51]
    v_mfma_f32_16x16x32_bf16 a[52:55], v[16:19], v[24:27], a[52:55]
    v_mfma_f32_16x16x32_bf16 a[56:59], v[16:19], v[28:31], a[56:59]
    v_mfma_f32_16x16x32_bf16 a[60:63], v[16:19], v[32:35], a[60:63]
    s_waitcnt vmcnt(16) lgkmcnt(0)
    s_barrier
    v_mfma_f32_16x16x32_bf16 a[0:3], v[36:39], v[52:55], a[0:3]
    ds_read_b64_tr_b16 v[4:5], v92
    v_mfma_f32_16x16x32_bf16 a[4:7], v[36:39], v[56:59], a[4:7]
    ds_read_b64_tr_b16 v[6:7], v92 offset:1024
    s_add_u32 m0, s24, 32768
    s_nop 0
    buffer_load_dwordx4 v68, s[4:7], s16 offen lds
    v_mfma_f32_16x16x32_bf16 a[8:11], v[36:39], v[60:63], a[8:11]
    ds_read_b128 v[20:23], v80
    s_add_u32 m0, s24, 33792
    v_mfma_f32_16x16x32_bf16 a[12:15], v[36:39], v[64:67], a[12:15]
    ds_read_b64_tr_b16 v[8:9], v93
    buffer_load_dwordx4 v69, s[4:7], s16 offen lds
    v_mfma_f32_16x16x32_bf16 a[16:19], v[40:43], v[52:55], a[16:19]
    ds_read_b64_tr_b16 v[10:11], v93 offset:1024
    s_add_u32 m0, s24, 34816
    v_mfma_f32_16x16x32_bf16 a[20:23], v[40:43], v[56:59], a[20:23]
    ds_read_b128 v[24:27], v80 offset:2048
    buffer_load_dwordx4 v70, s[4:7], s16 offen lds
    v_mfma_f32_16x16x32_bf16 a[24:27], v[40:43], v[60:63], a[24:27]
    ds_read_b64_tr_b16 v[12:13], v94
    s_add_u32 m0, s24, 35840
    v_mfma_f32_16x16x32_bf16 a[28:31], v[40:43], v[64:67], a[28:31]
    ds_read_b64_tr_b16 v[14:15], v94 offset:1024
    buffer_load_dwordx4 v71, s[4:7], s16 offen lds
    v_mfma_f32_16x16x32_bf16 a[32:35], v[44:47], v[52:55], a[32:35]
    ds_read_b128 v[28:31], v80 offset:4096
    s_add_u32 m0, s25, 49152
    v_mfma_f32_16x16x32_bf16 a[36:39], v[44:47], v[56:59], a[36:39]
    ds_read_b64_tr_b16 v[16:17], v95
    buffer_load_dwordx4 v72, s[8:11], s17 offen lds
    v_mfma_f32_16x16x32_bf16 a[40:43], v[44:47], v[60:63], a[40:43]
    ds_read_b64_tr_b16 v[18:19], v95 offset:1024
    s_add_u32 m0, s25, 50176
    v_mfma_f32_16x16x32_bf16 a[44:47], v[44:47], v[64:67], a[44:47]
    ds_read_b128 v[32:35], v80 offset:6144
    buffer_load_dwordx4 v73, s[8:11], s17 offen lds
    v_mfma_f32_16x16x32_bf16 a[48:51], v[48:51], v[52:55], a[48:51]
    s_add_u32 m0, s25, 51200
    v_mfma_f32_16x16x32_bf16 a[52:55], v[48:51], v[56:59], a[52:55]
    buffer_load_dwordx4 v74, s[8:11], s17 offen lds
    v_mfma_f32_16x16x32_bf16 a[56:59], v[48:51], v[60:63], a[56:59]
    s_add_u32 m0, s25, 52224
    v_mfma_f32_16x16x32_bf16 a[60:63], v[48:51], v[64:67], a[60:63]
    buffer_load_dwordx4 v75, s[8:11], s17 offen lds
    s_add_u32 s16, s16, 128
    s_add_u32 s17, s17, s18
    s_waitcnt lgkmcnt(9)
    v_mfma_f32_16x16x32_bf16 a[0:3], v[4:7], v[20:23], a[0:3]
    ds_read_b64_tr_b16 v[36:37], v92 offset:8192
    s_waitcnt lgkmcnt(7)
    v_mfma_f32_16x16x32_bf16 a[4:7], v[4:7], v[24:27], a[4:7]
    ds_read_b64_tr_b16 v[38:39], v92 offset:9216
    s_waitcnt lgkmcnt(5)
    v_mfma_f32_16x16x32_bf16 a[8:11], v[4:7], v[28:31], a[8:11]
    ds_read_b128 v[52:55], v81
    s_waitcnt lgkmcnt(3)
    v_mfma_f32_16x16x32_bf16 a[12:15], v[4:7], v[32:35], a[12:15]
    ds_read_b64_tr_b16 v[40:41], v93 offset:8192
    v_mfma_f32_16x16x32_bf16 a[16:19], v[8:11], v[20:23], a[16:19]
    ds_read_b64_tr_b16 v[42:43], v93 offset:9216
    v_mfma_f32_16x16x32_bf16 a[20:23], v[8:11], v[24:27], a[20:23]
    ds_read_b128 v[56:59], v81 offset:2048
    v_mfma_f32_16x16x32_bf16 a[24:27], v[8:11], v[28:31], a[24:27]
    ds_read_b64_tr_b16 v[44:45], v94 offset:8192
    v_mfma_f32_16x16x32_bf16 a[28:31], v[8:11], v[32:35], a[28:31]
    ds_read_b64_tr_b16 v[46:47], v94 offset:9216
    v_mfma_f32_16x16x32_bf16 a[32:35], v[12:15], v[20:23], a[32:35]
    ds_read_b128 v[60:63], v81 offset:4096
    v_mfma_f32_16x16x32_bf16 a[36:39], v[12:15], v[24:27], a[36:39]
    ds_read_b64_tr_b16 v[48:49], v95 offset:8192
    v_mfma_f32_16x16x32_bf16 a[40:43], v[12:15], v[28:31], a[40:43]
    ds_read_b64_tr_b16 v[50:51], v95 offset:9216
    v_mfma_f32_16x16x32_bf16 a[44:47], v[12:15], v[32:35], a[44:47]
    ds_read_b128 v[64:67], v81 offset:6144
    v_mfma_f32_16x16x32_bf16 a[48:51], v[16:19], v[20:23], a[48:51]
    v_mfma_f32_16x16x32_bf16 a[52:55], v[16:19], v[24:27], a[52:55]
    v_mfma_f32_16x16x32_bf16 a[56:59], v[16:19], v[28:31], a[56:59]
    v_mfma_f32_16x16x32_bf16 a[60:63], v[16:19], v[32:35], a[60:63]
    s_waitcnt vmcnt(16) lgkmcnt(0)
    s_barrier
    v_mfma_f32_16x16x32_bf16 a[0:3], v[36:39], v[52:55], a[0:3]
    ds_read_b64_tr_b16 v[4:5], v96
    v_mfma_f32_16x16x32_bf16 a[4:7], v[36:39], v[56:59], a[4:7]
    ds_read_b64_tr_b16 v[6:7], v96 offset:1024
    s_add_u32 m0, s24, 65536
    s_nop 0
    buffer_load_dwordx4 v68, s[4:7], s16 offen lds
    v_mfma_f32_16x16x32_bf16 a[8:11], v[36:39], v[60:63], a[8:11]
    ds_read_b128 v[20:23], v82
    s_add_u32 m0, s24, 66560
    v_mfma_f32_16x16x32_bf16 a[12:15], v[36:39], v[64:67], a[12:15]
    ds_read_b64_tr_b16 v[8:9], v97
    buffer_load_dwordx4 v69, s[4:7], s16 offen lds
    v_mfma_f32_16x16x32_bf16 a[16:19], v[40:43], v[52:55], a[16:19]
    ds_read_b64_tr_b16 v[10:11], v97 offset:1024
    s_add_u32 m0, s24, 67584
    v_mfma_f32_16x16x32_bf16 a[20:23], v[40:43], v[56:59], a[20:23]
    ds_read_b128 v[24:27], v82 offset:2048
    buffer_load_dwordx4 v70, s[4:7], s16 offen lds
    v_mfma_f32_16x16x32_bf16 a[24:27], v[40:43], v[60:63], a[24:27]
    ds_read_b64_tr_b16 v[12:13], v98
    s_add_u32 m0, s24, 68608
    v_mfma_f32_16x16x32_bf16 a[28:31], v[40:43], v[64:67], a[28:31]
    ds_read_b64_tr_b16 v[14:15], v98 offset:1024
    buffer_load_dwordx4 v71, s[4:7], s16 offen lds
    v_mfma_f32_16x16x32_bf16 a[32:35], v[44:47], v[52:55], a[32:35]
    ds_read_b128 v[28:31], v82 offset:4096
    s_add_u32 m0, s25, 81920
    v_mfma_f32_16x16x32_bf16 a[36:39], v[44:47], v[56:59], a[36:39]
    ds_read_b64_tr_b16 v[16:17], v99
    buffer_load_dwordx4 v72, s[8:11], s17 offen lds
    v_mfma_f32_16x16x32_bf16 a[40:43], v[44:47], v[60:63], a[40:43]
    ds_read_b64_tr_b16 v[18:19], v99 offset:1024
    s_add_u32 m0, s25, 82944
    v_mfma_f32_16x16x32_bf16 a[44:47], v[44:47], v[64:67], a[44:47]
    ds_read_b128 v[32:35], v82 offset:6144
    buffer_load_dwordx4 v73, s[8:11], s17 offen lds
    v_mfma_f32_16x16x32_bf16 a[48:51], v[48:51], v[52:55], a[48:51]
    s_add_u32 m0, s25, 83968
    v_mfma_f32_16x16x32_bf16 a[52:55], v[48:51], v[56:59], a[52:55]
    buffer_load_dwordx4 v74, s[8:11], s17 offen lds
    v_mfma_f32_16x16x32_bf16 a[56:59], v[48:51], v[60:63], a[56:59]
    s_add_u32 m0, s25, 84992
    v_mfma_f32_16x16x32_bf16 a[60:63], v[48:51], v[64:67], a[60:63]
    buffer_load_dwordx4 v75, s[8:11], s17 offen lds
    s_add_u32 s16, s16, 128
    s_add_u32 s17, s17, s18
    s_waitcnt lgkmcnt(9)
    v_mfma_f32_16x16x32_bf16 a[0:3], v[4:7], v[20:23], a[0:3]
    ds_read_b64_tr_b16 v[36:37], v96 offset:8192
    s_waitcnt lgkmcnt(7)
    v_mfma_f32_16x16x32_bf16 a[4:7], v[4:7], v[24:27], a[4:7]
    ds_read_b64_tr_b16 v[38:39], v96 offset:9216
    s_waitcnt lgkmcnt(5)
    v_mfma_f32_16x16x32_bf16 a[8:11], v[4:7], v[28:31], a[8:11]
    ds_read_b128 v[52:55], v83
    s_waitcnt lgkmcnt(3)
    v_mfma_f32_16x16x32_bf16 a[12:15], v[4:7], v[32:35], a[12:15]
    ds_read_b64_tr_b16 v[40:41], v97 offset:8192
    v_mfma_f32_16x16x32_bf16 a[16:19], v[8:11], v[20:23], a[16:19]
    ds_read_b64_tr_b16 v[42:43], v97 offset:9216
    v_mfma_f32_16x16x32_bf16 a[20:23], v[8:11], v[24:27], a[20:23]
    ds_read_b128 v[56:59], v83 offset:2048
    v_mfma_f32_16x16x32_bf16 a[24:27], v[8:11], v[28:31], a[24:27]
    ds_read_b64_tr_b16 v[44:45], v98 offset:8192
    v_mfma_f32_16x16x32_bf16 a[28:31], v[8:11], v[32:35], a[28:31]
    ds_read_b64_tr_b16 v[46:47], v98 offset:9216
    v_mfma_f32_16x16x32_bf16 a[32:35], v[12:15], v[20:23], a[32:35]
    ds_read_b128 v[60:63], v83 offset:4096
    v_mfma_f32_16x16x32_bf16 a[36:39], v[12:15], v[24:27], a[36:39]
    ds_read_b64_tr_b16 v[48:49], v99 offset:8192
    v_mfma_f32_16x16x32_bf16 a[40:43], v[12:15], v[28:31], a[40:43]
    ds_read_b64_tr_b16 v[50:51], v99 offset:9216
    v_mfma_f32_16x16x32_bf16 a[44:47], v[12:15], v[32:35], a[44:47]
    ds_read_b128 v[64:67], v83 offset:6144
    v_mfma_f32_16x16x32_bf16 a[48:51], v[16:19], v[20:23], a[48:51]
    v_mfma_f32_16x16x32_bf16 a[52:55], v[16:19], v[24:27], a[52:55]
    v_mfma_f32_16x16x32_bf16 a[56:59], v[16:19], v[28:31], a[56:59]
    v_mfma_f32_16x16x32_bf16 a[60:63], v[16:19], v[32:35], a[60:63]
    s_waitcnt vmcnt(16) lgkmcnt(0)
    s_barrier
    v_mfma_f32_16x16x32_bf16 a[0:3], v[36:39], v[52:55], a[0:3]
    ds_read_b64_tr_b16 v[4:5], v84
    v_mfma_f32_16x16x32_bf16 a[4:7], v[36:39], v[56:59], a[4:7]
    ds_read_b64_tr_b16 v[6:7], v84 offset:1024
    s_add_u32 m0, s24, 98304
    s_nop 0
    buffer_load_dwordx4 v68, s[4:7], s16 offen lds
    v_mfma_f32_16x16x32_bf16 a[8:11], v[36:39], v[60:63], a[8:11]
    ds_read_b128 v[20:23], v76
    s_add_u32 m0, s24, 99328
    v_mfma_f32_16x16x32_bf16 a[12:15], v[36:39], v[64:67], a[12:15]
    ds_read_b64_tr_b16 v[8:9], v85
    buffer_load_dwordx4 v69, s[4:7], s16 offen lds
    v_mfma_f32_16x16x32_bf16 a[16:19], v[40:43], v[52:55], a[16:19]
    ds_read_b64_tr_b16 v[10:11], v85 offset:1024
    s_add_u32 m0, s24, 100352
    v_mfma_f32_16x16x32_bf16 a[20:23], v[40:43], v[56:59], a[20:23]
    ds_read_b128 v[24:27], v76 offset:2048
    buffer_load_dwordx4 v70, s[4:7], s16 offen lds
    v_mfma_f32_16x16x32_bf16 a[24:27], v[40:43], v[60:63], a[24:27]
    ds_read_b64_tr_b16 v[12:13], v86
    s_add_u32 m0, s24, 101376
    v_mfma_f32_16x16x32_bf16 a[28:31], v[40:43], v[64:67], a[28:31]
    ds_read_b64_tr_b16 v[14:15], v86 offset:1024
    buffer_load_dwordx4 v71, s[4:7], s16 offen lds
    v_mfma_f32_16x16x32_bf16 a[32:35], v[44:47], v[52:55], a[32:35]
    ds_read_b128 v[28:31], v76 offset:4096
    s_add_u32 m0, s25, 114688
    v_mfma_f32_16x16x32_bf16 a[36:39], v[44:47], v[56:59], a[36:39]
    ds_read_b64_tr_b16 v[16:17], v87
    buffer_load_dwordx4 v72, s[8:11], s17 offen lds
    v_mfma_f32_16x16x32_bf16 a[40:43], v[44:47], v[60:63], a[40:43]
    ds_read_b64_tr_b16 v[18:19], v87 offset:1024
    s_add_u32 m0, s25, 115712
    v_mfma_f32_16x16x32_bf16 a[44:47], v[44:47], v[64:67], a[44:47]
    ds_read_b128 v[32:35], v76 offset:6144
    buffer_load_dwordx4 v73, s[8:11], s17 offen lds
    v_mfma_f32_16x16x32_bf16 a[48:51], v[48:51], v[52:55], a[48:51]
    s_add_u32 m0, s25, 116736
    v_mfma_f32_16x16x32_bf16 a[52:55], v[48:51], v[56:59], a[52:55]
    buffer_load_dwordx4 v74, s[8:11], s17 offen lds
    v_mfma_f32_16x16x32_bf16 a[56:59], v[48:51], v[60:63], a[56:59]
    s_add_u32 m0, s25, 117760
    v_mfma_f32_16x16x32_bf16 a[60:63], v[48:51], v[64:67], a[60:63]
    buffer_load_dwordx4 v75, s[8:11], s17 offen lds
    s_add_u32 s16, s16, 128
    s_add_u32 s17, s17, s18
gemm2_kernel_loop:
    s_waitcnt lgkmcnt(9)
    v_mfma_f32_16x16x32_bf16 a[0:3], v[4:7], v[20:23], a[0:3]
    ds_read_b64_tr_b16 v[36:37], v84 offset:8192
    s_waitcnt lgkmcnt(7)
    v_mfma_f32_16x16x32_bf16 a[4:7], v[4:7], v[24:27], a[4:7]
    ds_read_b64_tr_b16 v[38:39], v84 offset:9216
    s_waitcnt lgkmcnt(5)
    v_mfma_f32_16x16x32_bf16 a[8:11], v[4:7], v[28:31], a[8:11]
    ds_read_b128 v[52:55], v77
    s_waitcnt lgkmcnt(3)
    v_mfma_f32_16x16x32_bf16 a[12:15], v[4:7], v[32:35], a[12:15]
    ds_read_b64_tr_b16 v[40:41], v85 offset:8192
    v_mfma_f32_16x16x32_bf16 a[16:19], v[8:11], v[20:23], a[16:19]
    ds_read_b64_tr_b16 v[42:43], v85 offset:9216
    v_mfma_f32_16x16x32_bf16 a[20:23], v[8:11], v[24:27], a[20:23]
    ds_read_b128 v[56:59], v77 offset:2048
    v_mfma_f32_16x16x32_bf16 a[24:27], v[8:11], v[28:31], a[24:27]
    ds_read_b64_tr_b16 v[44:45], v86 offset:8192
    v_mfma_f32_16x16x32_bf16 a[28:31], v[8:11], v[32:35], a[28:31]
    ds_read_b64_tr_b16 v[46:47], v86 offset:9216
    v_mfma_f32_16x16x32_bf16 a[32:35], v[12:15], v[20:23], a[32:35]
    ds_read_b128 v[60:63], v77 offset:4096
    v_mfma_f32_16x16x32_bf16 a[36:39], v[12:15], v[24:27], a[36:39]
    ds_read_b64_tr_b16 v[48:49], v87 offset:8192
    v_mfma_f32_16x16x32_bf16 a[40:43], v[12:15], v[28:31], a[40:43]
    ds_read_b64_tr_b16 v[50:51], v87 offset:9216
    v_mfma_f32_16x16x32_bf16 a[44:47], v[12:15], v[32:35], a[44:47]
    ds_read_b128 v[64:67], v77 offset:6144
    v_mfma_f32_16x16x32_bf16 a[48:51], v[16:19], v[20:23], a[48:51]
    v_mfma_f32_16x16x32_bf16 a[52:55], v[16:19], v[24:27], a[52:55]
    v_mfma_f32_16x16x32_bf16 a[56:59], v[16:19], v[28:31], a[56:59]
    v_mfma_f32_16x16x32_bf16 a[60:63], v[16:19], v[32:35], a[60:63]
    s_waitcnt vmcnt(16) lgkmcnt(0)
    s_barrier
    v_mfma_f32_16x16x32_bf16 a[0:3], v[36:39], v[52:55], a[0:3]
    ds_read_b64_tr_b16 v[4:5], v88
    v_mfma_f32_16x16x32_bf16 a[4:7], v[36:39], v[56:59], a[4:7]
    ds_read_b64_tr_b16 v[6:7], v88 offset:1024
    s_add_u32 m0, s24, 0
    s_nop 0
    buffer_load_dwordx4 v68, s[4:7], s16 offen lds
    v_mfma_f32_16x16x32_bf16 a[8:11], v[36:39], v[60:63], a[8:11]
    ds_read_b128 v[20:23], v78
    s_add_u32 m0, s24, 1024
    v_mfma_f32_16x16x32_bf16 a[12:15], v[36:39], v[64:67], a[12:15]
    ds_read_b64_tr_b16 v[8:9], v89
    buffer_load_dwordx4 v69, s[4:7], s16 offen lds
    v_mfma_f32_16x16x32_bf16 a[16:19], v[40:43], v[52:55], a[16:19]
    ds_read_b64_tr_b16 v[10:11], v89 offset:1024
    s_add_u32 m0, s24, 2048
    v_mfma_f32_16x16x32_bf16 a[20:23], v[40:43], v[56:59], a[20:23]
    ds_read_b128 v[24:27], v78 offset:2048
    buffer_load_dwordx4 v70, s[4:7], s16 offen lds
    v_mfma_f32_16x16x32_bf16 a[24:27], v[40:43], v[60:63], a[24:27]
    ds_read_b64_tr_b16 v[12:13], v90
    s_add_u32 m0, s24, 3072
    v_mfma_f32_16x16x32_bf16 a[28:31], v[40:43], v[64:67], a[28:31]
    ds_read_b64_tr_b16 v[14:15], v90 offset:1024
    buffer_load_dwordx4 v71, s[4:7], s16 offen lds
    v_mfma_f32_16x16x32_bf16 a[32:35], v[44:47], v[52:55], a[32:35]
    ds_read_b128 v[28:31], v78 offset:4096
    s_add_u32 m0, s25, 16384
    v_mfma_f32_16x16x32_bf16 a[36:39], v[44:47], v[56:59], a[36:39]
    ds_read_b64_tr_b16 v[16:17], v91
    buffer_load_dwordx4 v72, s[8:11], s17 offen lds
    v_mfma_f32_16x16x32_bf16 a[40:43], v[44:47], v[60:63], a[40:43]
    ds_read_b64_tr_b16 v[18:19], v91 offset:1024
    s_add_u32 m0, s25, 17408
    v_mfma_f32_16x16x32_bf16 a[44:47], v[44:47], v[64:67], a[44:47]
    ds_read_b128 v[32:35], v78 offset:6144
    buffer_load_dwordx4 v73, s[8:11], s17 offen lds
    v_mfma_f32_16x16x32_bf16 a[48:51], v[48:51], v[52:55], a[48:51]
    s_add_u32 m0, s25, 18432
    v_mfma_f32_16x16x32_bf16 a[52:55], v[48:51], v[56:59], a[52:55]
    buffer_load_dwordx4 v74, s[8:11], s17 offen lds
    v_mfma_f32_16x16x32_bf16 a[56:59], v[48:51], v[60:63], a[56:59]
    s_add_u32 m0, s25, 19456
    v_mfma_f32_16x16x32_bf16 a[60:63], v[48:51], v[64:67], a[60:63]
    buffer_load_dwordx4 v75, s[8:11], s17 offen lds
    s_add_u32 s16, s16, 128
    s_add_u32 s17, s17, s18
    s_waitcnt lgkmcnt(9)
    v_mfma_f32_16x16x32_bf16 a[0:3], v[4:7], v[20:23], a[0:3]
    ds_read_b64_tr_b16 v[36:37], v88 offset:8192
    s_waitcnt lgkmcnt(7)
    v_mfma_f32_16x16x32_bf16 a[4:7], v[4:7], v[24:27], a[4:7]
    ds_read_b64_tr_b16 v[38:39], v88 offset:9216
    s_waitcnt lgkmcnt(5)
    v_mfma_f32_16x16x32_bf16 a[8:11], v[4:7], v[28:31], a[8:11]
    ds_read_b128 v[52:55], v79
    s_waitcnt lgkmcnt(3)
    v_mfma_f32_16x16x32_bf16 a[12:15], v[4:7], v[32:35], a[12:15]
    ds_read_b64_tr_b16 v[40:41], v89 offset:8192
    v_mfma_f32_16x16x32_bf16 a[16:19], v[8:11], v[20:23], a[16:19]
    ds_read_b64_tr_b16 v[42:43], v89 offset:9216
    v_mfma_f32_16x16x32_bf16 a[20:23], v[8:11], v[24:27], a[20:23]
    ds_read_b128 v[56:59], v79 offset:2048
    v_mfma_f32_16x16x32_bf16 a[24:27], v[8:11], v[28:31], a[24:27]
    ds_read_b64_tr_b16 v[44:45], v90 offset:8192
    v_mfma_f32_16x16x32_bf16 a[28:31], v[8:11], v[32:35], a[28:31]
    ds_read_b64_tr_b16 v[46:47], v90 offset:9216
    v_mfma_f32_16x16x32_bf16 a[32:35], v[12:15], v[20:23], a[32:35]
    ds_read_b128 v[60:63], v79 offset:4096
    v_mfma_f32_16x16x32_bf16 a[36:39], v[12:15], v[24:27], a[36:39]
    ds_read_b64_tr_b16 v[48:49], v91 offset:8192
    v_mfma_f32_16x16x32_bf16 a[40:43], v[12:15], v[28:31], a[40:43]
    ds_read_b64_tr_b16 v[50:51], v91 offset:9216
    v_mfma_f32_16x16x32_bf16 a[44:47], v[12:15], v[32:35], a[44:47]
    ds_read_b128 v[64:67], v79 offset:6144
    v_mfma_f32_16x16x32_bf16 a[48:51], v[16:19], v[20:23], a[48:51]
    v_mfma_f32_16x16x32_bf16 a[52:55], v[16:19], v[24:27], a[52:55]
    v_mfma_f32_16x16x32_bf16 a[56:59], v[16:19], v[28:31], a[56:59]
    v_mfma_f32_16x16x32_bf16 a[60:63], v[16:19], v[32:35], a[60:63]
    s_waitcnt vmcnt(16) lgkmcnt(0)
    s_barrier
    v_mfma_f32_16x16x32_bf16 a[0:3], v[36:39], v[52:55], a[0:3]
    ds_read_b64_tr_b16 v[4:5], v92
    v_mfma_f32_16x16x32_bf16 a[4:7], v[36:39], v[56:59], a[4:7]
    ds_read_b64_tr_b16 v[6:7], v92 offset:1024
    s_add_u32 m0, s24, 32768
    s_nop 0
    buffer_load_dwordx4 v68, s[4:7], s16 offen lds
    v_mfma_f32_16x16x32_bf16 a[8:11], v[36:39], v[60:63], a[8:11]
    ds_read_b128 v[20:23], v80
    s_add_u32 m0, s24, 33792
    v_mfma_f32_16x16x32_bf16 a[12:15], v[36:39], v[64:67], a[12:15]
    ds_read_b64_tr_b16 v[8:9], v93
    buffer_load_dwordx4 v69, s[4:7], s16 offen lds
    v_mfma_f32_16x16x32_bf16 a[16:19], v[40:43], v[52:55], a[16:19]
    ds_read_b64_tr_b16 v[10:11], v93 offset:1024
    s_add_u32 m0, s24, 34816
    v_mfma_f32_16x16x32_bf16 a[20:23], v[40:43], v[56:59], a[20:23]
    ds_read_b128 v[24:27], v80 offset:2048
    buffer_load_dwordx4 v70, s[4:7], s16 offen lds
    v_mfma_f32_16x16x32_bf16 a[24:27], v[40:43], v[60:63], a[24:27]
    ds_read_b64_tr_b16 v[12:13], v94
    s_add_u32 m0, s24, 35840
    v_mfma_f32_16x16x32_bf16 a[28:31], v[40:43], v[64:67], a[28:31]
    ds_read_b64_tr_b16 v[14:15], v94 offset:1024
    buffer_load_dwordx4 v71, s[4:7], s16 offen lds
    v_mfma_f32_16x16x32_bf16 a[32:35], v[44:47], v[52:55], a[32:35]
    ds_read_b128 v[28:31], v80 offset:4096
    s_add_u32 m0, s25, 49152
    v_mfma_f32_16x16x32_bf16 a[36:39], v[44:47], v[56:59], a[36:39]
    ds_read_b64_tr_b16 v[16:17], v95
    buffer_load_dwordx4 v72, s[8:11], s17 offen lds
    v_mfma_f32_16x16x32_bf16 a[40:43], v[44:47], v[60:63], a[40:43]
    ds_read_b64_tr_b16 v[18:19], v95 offset:1024
    s_add_u32 m0, s25, 50176
    v_mfma_f32_16x16x32_bf16 a[44:47], v[44:47], v[64:67], a[44:47]
    ds_read_b128 v[32:35], v80 offset:6144
    buffer_load_dwordx4 v73, s[8:11], s17 offen lds
    v_mfma_f32_16x16x32_bf16 a[48:51], v[48:51], v[52:55], a[48:51]
    s_add_u32 m0, s25, 51200
    v_mfma_f32_16x16x32_bf16 a[52:55], v[48:51], v[56:59], a[52:55]
    buffer_load_dwordx4 v74, s[8:11], s17 offen lds
    v_mfma_f32_16x16x32_bf16 a[56:59], v[48:51], v[60:63], a[56:59]
    s_add_u32 m0, s25, 52224
    v_mfma_f32_16x16x32_bf16 a[60:63], v[48:51], v[64:67], a[60:63]
    buffer_load_dwordx4 v75, s[8:11], s17 offen lds
    s_add_u32 s16, s16, 128
    s_add_u32 s17, s17, s18
    s_waitcnt lgkmcnt(9)
    v_mfma_f32_16x16x32_bf16 a[0:3], v[4:7], v[20:23], a[0:3]
    ds_read_b64_tr_b16 v[36:37], v92 offset:8192
    s_waitcnt lgkmcnt(7)
    v_mfma_f32_16x16x32_bf16 a[4:7], v[4:7], v[24:27], a[4:7]
    ds_read_b64_tr_b16 v[38:39], v92 offset:9216
    s_waitcnt lgkmcnt(5)
    v_mfma_f32_16x16x32_bf16 a[8:11], v[4:7], v[28:31], a[8:11]
    ds_read_b128 v[52:55], v81
    s_waitcnt lgkmcnt(3)
    v_mfma_f32_16x16x32_bf16 a[12:15], v[4:7], v[32:35], a[12:15]
    ds_read_b64_tr_b16 v[40:41], v93 offset:8192
    v_mfma_f32_16x16x32_bf16 a[16:19], v[8:11], v[20:23], a[16:19]
    ds_read_b64_tr_b16 v[42:43], v93 offset:9216
    v_mfma_f32_16x16x32_bf16 a[20:23], v[8:11], v[24:27], a[20:23]
    ds_read_b128 v[56:59], v81 offset:2048
    v_mfma_f32_16x16x32_bf16 a[24:27], v[8:11], v[28:31], a[24:27]
    ds_read_b64_tr_b16 v[44:45], v94 offset:8192
    v_mfma_f32_16x16x32_bf16 a[28:31], v[8:11], v[32:35], a[28:31]
    ds_read_b64_tr_b16 v[46:47], v94 offset:9216
    v_mfma_f32_16x16x32_bf16 a[32:35], v[12:15], v[20:23], a[32:35]
    ds_read_b128 v[60:63], v81 offset:4096
    v_mfma_f32_16x16x32_bf16 a[36:39], v[12:15], v[24:27], a[36:39]
    ds_read_b64_tr_b16 v[48:49], v95 offset:8192
    v_mfma_f32_16x16x32_bf16 a[40:43], v[12:15], v[28:31], a[40:43]
    ds_read_b64_tr_b16 v[50:51], v95 offset:9216
    v_mfma_f32_16x16x32_bf16 a[44:47], v[12:15], v[32:35], a[44:47]
    ds_read_b128 v[64:67], v81 offset:6144
    v_mfma_f32_16x16x32_bf16 a[48:51], v[16:19], v[20:23], a[48:51]
    v_mfma_f32_16x16x32_bf16 a[52:55], v[16:19], v[24:27], a[52:55]
    v_mfma_f32_16x16x32_bf16 a[56:59], v[16:19], v[28:31], a[56:59]
    v_mfma_f32_16x16x32_bf16 a[60:63], v[16:19], v[32:35], a[60:63]
    s_waitcnt vmcnt(16) lgkmcnt(0)
    s_barrier
    v_mfma_f32_16x16x32_bf16 a[0:3], v[36:39], v[52:55], a[0:3]
    ds_read_b64_tr_b16 v[4:5], v96
    v_mfma_f32_16x16x32_bf16 a[4:7], v[36:39], v[56:59], a[4:7]
    ds_read_b64_tr_b16 v[6:7], v96 offset:1024
    s_add_u32 m0, s24, 65536
    s_nop 0
    buffer_load_dwordx4 v68, s[4:7], s16 offen lds
    v_mfma_f32_16x16x32_bf16 a[8:11], v[36:39], v[60:63], a[8:11]
    ds_read_b128 v[20:23], v82
    s_add_u32 m0, s24, 66560
    v_mfma_f32_16x16x32_bf16 a[12:15], v[36:39], v[64:67], a[12:15]
    ds_read_b64_tr_b16 v[8:9], v97
    buffer_load_dwordx4 v69, s[4:7], s16 offen lds
    v_mfma_f32_16x16x32_bf16 a[16:19], v[40:43], v[52:55], a[16:19]
    ds_read_b64_tr_b16 v[10:11], v97 offset:1024
    s_add_u32 m0, s24, 67584
    v_mfma_f32_16x16x32_bf16 a[20:23], v[40:43], v[56:59], a[20:23]
    ds_read_b128 v[24:27], v82 offset:2048
    buffer_load_dwordx4 v70, s[4:7], s16 offen lds
    v_mfma_f32_16x16x32_bf16 a[24:27], v[40:43], v[60:63], a[24:27]
    ds_read_b64_tr_b16 v[12:13], v98
    s_add_u32 m0, s24, 68608
    v_mfma_f32_16x16x32_bf16 a[28:31], v[40:43], v[64:67], a[28:31]
    ds_read_b64_tr_b16 v[14:15], v98 offset:1024
    buffer_load_dwordx4 v71, s[4:7], s16 offen lds
    v_mfma_f32_16x16x32_bf16 a[32:35], v[44:47], v[52:55], a[32:35]
    ds_read_b128 v[28:31], v82 offset:4096
    s_add_u32 m0, s25, 81920
    v_mfma_f32_16x16x32_bf16 a[36:39], v[44:47], v[56:59], a[36:39]
    ds_read_b64_tr_b16 v[16:17], v99
    buffer_load_dwordx4 v72, s[8:11], s17 offen lds
    v_mfma_f32_16x16x32_bf16 a[40:43], v[44:47], v[60:63], a[40:43]
    ds_read_b64_tr_b16 v[18:19], v99 offset:1024
    s_add_u32 m0, s25, 82944
    v_mfma_f32_16x16x32_bf16 a[44:47], v[44:47], v[64:67], a[44:47]
    ds_read_b128 v[32:35], v82 offset:6144
    buffer_load_dwordx4 v73, s[8:11], s17 offen lds
    v_mfma_f32_16x16x32_bf16 a[48:51], v[48:51], v[52:55], a[48:51]
    s_add_u32 m0, s25, 83968
    v_mfma_f32_16x16x32_bf16 a[52:55], v[48:51], v[56:59], a[52:55]
    buffer_load_dwordx4 v74, s[8:11], s17 offen lds
    v_mfma_f32_16x16x32_bf16 a[56:59], v[48:51], v[60:63], a[56:59]
    s_add_u32 m0, s25, 84992
    v_mfma_f32_16x16x32_bf16 a[60:63], v[48:51], v[64:67], a[60:63]
    buffer_load_dwordx4 v75, s[8:11], s17 offen lds
    s_add_u32 s16, s16, 128
    s_add_u32 s17, s17, s18
    s_waitcnt lgkmcnt(9)
    v_mfma_f32_16x16x32_bf16 a[0:3], v[4:7], v[20:23], a[0:3]
    ds_read_b64_tr_b16 v[36:37], v96 offset:8192
    s_waitcnt lgkmcnt(7)
    v_mfma_f32_16x16x32_bf16 a[4:7], v[4:7], v[24:27], a[4:7]
    ds_read_b64_tr_b16 v[38:39], v96 offset:9216
    s_waitcnt lgkmcnt(5)
    v_mfma_f32_16x16x32_bf16 a[8:11], v[4:7], v[28:31], a[8:11]
    ds_read_b128 v[52:55], v83
    s_waitcnt lgkmcnt(3)
    v_mfma_f32_16x16x32_bf16 a[12:15], v[4:7], v[32:35], a[12:15]
    ds_read_b64_tr_b16 v[40:41], v97 offset:8192
    v_mfma_f32_16x16x32_bf16 a[16:19], v[8:11], v[20:23], a[16:19]
    ds_read_b64_tr_b16 v[42:43], v97 offset:9216
    v_mfma_f32_16x16x32_bf16 a[20:23], v[8:11], v[24:27], a[20:23]
    ds_read_b128 v[56:59], v83 offset:2048
    v_mfma_f32_16x16x32_bf16 a[24:27], v[8:11], v[28:31], a[24:27]
    ds_read_b64_tr_b16 v[44:45], v98 offset:8192
    v_mfma_f32_16x16x32_bf16 a[28:31], v[8:11], v[32:35], a[28:31]
    ds_read_b64_tr_b16 v[46:47], v98 offset:9216
    v_mfma_f32_16x16x32_bf16 a[32:35], v[12:15], v[20:23], a[32:35]
    ds_read_b128 v[60:63], v83 offset:4096
    v_mfma_f32_16x16x32_bf16 a[36:39], v[12:15], v[24:27], a[36:39]
    ds_read_b64_tr_b16 v[48:49], v99 offset:8192
    v_mfma_f32_16x16x32_bf16 a[40:43], v[12:15], v[28:31], a[40:43]
    ds_read_b64_tr_b16 v[50:51], v99 offset:9216
    v_mfma_f32_16x16x32_bf16 a[44:47], v[12:15], v[32:35], a[44:47]
    ds_read_b128 v[64:67], v83 offset:6144
    v_mfma_f32_16x16x32_bf16 a[48:51], v[16:19], v[20:23], a[48:51]
    v_mfma_f32_16x16x32_bf16 a[52:55], v[16:19], v[24:27], a[52:55]
    v_mfma_f32_16x16x32_bf16 a[56:59], v[16:19], v[28:31], a[56:59]
    v_mfma_f32_16x16x32_bf16 a[60:63], v[16:19], v[32:35], a[60:63]
    s_waitcnt vmcnt(16) lgkmcnt(0)
    s_barrier
    v_mfma_f32_16x16x32_bf16 a[0:3], v[36:39], v[52:55], a[0:3]
    ds_read_b64_tr_b16 v[4:5], v84
    v_mfma_f32_16x16x32_bf16 a[4:7], v[36:39], v[56:59], a[4:7]
    ds_read_b64_tr_b16 v[6:7], v84 offset:1024
    s_add_u32 m0, s24, 98304
    s_nop 0
    buffer_load_dwordx4 v68, s[4:7], s16 offen lds
    v_mfma_f32_16x16x32_bf16 a[8:11], v[36:39], v[60:63], a[8:11]
    ds_read_b128 v[20:23], v76
    s_add_u32 m0, s24, 99328
    v_mfma_f32_16x16x32_bf16 a[12:15], v[36:39], v[64:67], a[12:15]
    ds_read_b64_tr_b16 v[8:9], v85
    buffer_load_dwordx4 v69, s[4:7], s16 offen lds
    v_mfma_f32_16x16x32_bf16 a[16:19], v[40:43], v[52:55], a[16:19]
    ds_read_b64_tr_b16 v[10:11], v85 offset:1024
    s_add_u32 m0, s24, 100352
    v_mfma_f32_16x16x32_bf16 a[20:23], v[40:43], v[56:59], a[20:23]
    ds_read_b128 v[24:27], v76 offset:2048
    buffer_load_dwordx4 v70, s[4:7], s16 offen lds
    v_mfma_f32_16x16x32_bf16 a[24:27], v[40:43], v[60:63], a[24:27]
    ds_read_b64_tr_b16 v[12:13], v86
    s_add_u32 m0, s24, 101376
    v_mfma_f32_16x16x32_bf16 a[28:31], v[40:43], v[64:67], a[28:31]
    ds_read_b64_tr_b16 v[14:15], v86 offset:1024
    buffer_load_dwordx4 v71, s[4:7], s16 offen lds
    v_mfma_f32_16x16x32_bf16 a[32:35], v[44:47], v[52:55], a[32:35]
    ds_read_b128 v[28:31], v76 offset:4096
    s_add_u32 m0, s25, 114688
    v_mfma_f32_16x16x32_bf16 a[36:39], v[44:47], v[56:59], a[36:39]
    ds_read_b64_tr_b16 v[16:17], v87
    buffer_load_dwordx4 v72, s[8:11], s17 offen lds
    v_mfma_f32_16x16x32_bf16 a[40:43], v[44:47], v[60:63], a[40:43]
    ds_read_b64_tr_b16 v[18:19], v87 offset:1024
    s_add_u32 m0, s25, 115712
    v_mfma_f32_16x16x32_bf16 a[44:47], v[44:47], v[64:67], a[44:47]
    ds_read_b128 v[32:35], v76 offset:6144
    buffer_load_dwordx4 v73, s[8:11], s17 offen lds
    v_mfma_f32_16x16x32_bf16 a[48:51], v[48:51], v[52:55], a[48:51]
    s_add_u32 m0, s25, 116736
    v_mfma_f32_16x16x32_bf16 a[52:55], v[48:51], v[56:59], a[52:55]
    buffer_load_dwordx4 v74, s[8:11], s17 offen lds
    v_mfma_f32_16x16x32_bf16 a[56:59], v[48:51], v[60:63], a[56:59]
    s_add_u32 m0, s25, 117760
    v_mfma_f32_16x16x32_bf16 a[60:63], v[48:51], v[64:67], a[60:63]
    buffer_load_dwordx4 v75, s[8:11], s17 offen lds
    s_add_u32 s16, s16, 128
    s_add_u32 s17, s17, s18
    s_sub_u32 s19, s19, 1
    s_cmp_lg_u32 s19, 0
    s_cbranch_scc1 gemm2_kernel_loop
    s_cmp_lg_u32 s23, 0
    s_cbranch_scc1 gemm2_kernel_nopre
    v_and_b32 v152, 15, v0
    v_lshrrev_b32 v153, 6, v0
    v_lshrrev_b32 v154, 1, v153
    v_and_b32 v155, 1, v153
    v_mul_u32_u24 v156, 64, v154
    v_add_u32 v156, v156, v152
    v_mul_u32_u24 v157, 128, v155
    v_mad_u32_u24 v159, v156, s22, v157
    v_bfe_u32 v152, v0, 4, 2
    v_and_b32 v156, 1, v152
    v_lshlrev_b32 v156, 5, v156
    v_lshrrev_b32 v157, 1, v152
    v_lshl_or_b32 v156, v157, 4, v156
    v_add_u32 v159, v159, v156
    v_readfirstlane_b32 s29, v153
    s_cmp_lg_u32 s29, 0
    s_cbranch_scc1 gemm2_kernel_flag_ok
    v_mov_b32 v152, s50
    s_mov_b32 s30, 262144
gemm2_kernel_poll:
    buffer_load_dword v153, v152, s[60:63], 0 offen sc1
    s_waitcnt vmcnt(0)
    v_readfirstlane_b32 s31, v153
    s_cmp_lg_u32 s31, 0
    s_cbranch_scc1 gemm2_kernel_flag_ok
    s_sleep 4
    s_sub_u32 s30, s30, 1
    s_cmp_lg_u32 s30, 0
    s_cbranch_scc1 gemm2_kernel_poll
gemm2_kernel_flag_ok:
    s_waitcnt vmcnt(0) lgkmcnt(0)
    s_nop 15
    s_nop 7
    s_barrier
    s_mov_b32 s27, 0
    buffer_load_dwordx4 v[112:115], v159, s[56:59], s27 offen sc1
    buffer_load_dwordx4 v[160:163], v159, s[52:55], s27 offen
    s_mov_b32 s27, 0
    buffer_load_dwordx4 v[116:119], v159, s[56:59], s27 offen offset:64 sc1
    buffer_load_dwordx4 v[164:167], v159, s[52:55], s27 offen offset:64
    s_mov_b32 s27, 32768
    buffer_load_dwordx4 v[120:123], v159, s[56:59], s27 offen sc1
    buffer_load_dwordx4 v[168:171], v159, s[52:55], s27 offen
    s_mov_b32 s27, 32768
    buffer_load_dwordx4 v[124:127], v159, s[56:59], s27 offen offset:64 sc1
    buffer_load_dwordx4 v[172:175], v159, s[52:55], s27 offen offset:64
    s_mov_b32 s27, 65536
    buffer_load_dwordx4 v[128:131], v159, s[56:59], s27 offen sc1
    buffer_load_dwordx4 v[176:179], v159, s[52:55], s27 offen
    s_mov_b32 s27, 65536
    buffer_load_dwordx4 v[132:135], v159, s[56:59], s27 offen offset:64 sc1
    buffer_load_dwordx4 v[180:183], v159, s[52:55], s27 offen offset:64
    s_mov_b32 s27, 98304
    buffer_load_dwordx4 v[136:139], v159, s[56:59], s27 offen sc1
    buffer_load_dwordx4 v[184:187], v159, s[52:55], s27 offen
    s_mov_b32 s27, 98304
    buffer_load_dwordx4 v[140:143], v159, s[56:59], s27 offen offset:64 sc1
    buffer_load_dwordx4 v[188:191], v159, s[52:55], s27 offen offset:64
gemm2_kernel_nopre:
    v_mfma_f32_16x16x32_bf16 a[0:3], v[4:7], v[20:23], a[0:3]
    ds_read_b64_tr_b16 v[36:37], v84 offset:8192
    v_mfma_f32_16x16x32_bf16 a[4:7], v[4:7], v[24:27], a[4:7]
    ds_read_b64_tr_b16 v[38:39], v84 offset:9216
    v_mfma_f32_16x16x32_bf16 a[8:11], v[4:7], v[28:31], a[8:11]
    ds_read_b128 v[52:55], v77
    v_mfma_f32_16x16x32_bf16 a[12:15], v[4:7], v[32:35], a[12:15]
    ds_read_b64_tr_b16 v[40:41], v85 offset:8192
    v_mfma_f32_16x16x32_bf16 a[16:19], v[8:11], v[20:23], a[16:19]
    ds_read_b64_tr_b16 v[42:43], v85 offset:9216
    v_mfma_f32_16x16x32_bf16 a[20:23], v[8:11], v[24:27], a[20:23]
    ds_read_b128 v[56:59], v77 offset:2048
    v_mfma_f32_16x16x32_bf16 a[24:27], v[8:11], v[28:31], a[24:27]
    ds_read_b64_tr_b16 v[44:45], v86 offset:8192
    v_mfma_f32_16x16x32_bf16 a[28:31], v[8:11], v[32:35], a[28:31]
    ds_read_b64_tr_b16 v[46:47], v86 offset:9216
    v_mfma_f32_16x16x32_bf16 a[32:35], v[12:15], v[20:23], a[32:35]
    ds_read_b128 v[60:63], v77 offset:4096
    v_mfma_f32_16x16x32_bf16 a[36:39], v[12:15], v[24:27], a[36:39]
    ds_read_b64_tr_b16 v[48:49], v87 offset:8192
    v_mfma_f32_16x16x32_bf16 a[40:43], v[12:15], v[28:31], a[40:43]
    ds_read_b64_tr_b16 v[50:51], v87 offset:9216
    v_mfma_f32_16x16x32_bf16 a[44:47], v[12:15], v[32:35], a[44:47]
    ds_read_b128 v[64:67], v77 offset:6144
    v_mfma_f32_16x16x32_bf16 a[48:51], v[16:19], v[20:23], a[48:51]
    v_mfma_f32_16x16x32_bf16 a[52:55], v[16:19], v[24:27], a[52:55]
    v_mfma_f32_16x16x32_bf16 a[56:59], v[16:19], v[28:31], a[56:59]
    v_mfma_f32_16x16x32_bf16 a[60:63], v[16:19], v[32:35], a[60:63]
    s_waitcnt vmcnt(16) lgkmcnt(0)
    s_barrier
    v_mfma_f32_16x16x32_bf16 a[0:3], v[36:39], v[52:55], a[0:3]
    ds_read_b64_tr_b16 v[4:5], v88
    v_mfma_f32_16x16x32_bf16 a[4:7], v[36:39], v[56:59], a[4:7]
    ds_read_b64_tr_b16 v[6:7], v88 offset:1024
    v_mfma_f32_16x16x32_bf16 a[8:11], v[36:39], v[60:63], a[8:11]
    ds_read_b128 v[20:23], v78
    v_mfma_f32_16x16x32_bf16 a[12:15], v[36:39], v[64:67], a[12:15]
    ds_read_b64_tr_b16 v[8:9], v89
    v_mfma_f32_16x16x32_bf16 a[16:19], v[40:43], v[52:55], a[16:19]
    ds_read_b64_tr_b16 v[10:11], v89 offset:1024
    v_mfma_f32_16x16x32_bf16 a[20:23], v[40:43], v[56:59], a[20:23]
    ds_read_b128 v[24:27], v78 offset:2048
    v_mfma_f32_16x16x32_bf16 a[24:27], v[40:43], v[60:63], a[24:27]
    ds_read_b64_tr_b16 v[12:13], v90
    v_mfma_f32_16x16x32_bf16 a[28:31], v[40:43], v[64:67], a[28:31]
    ds_read_b64_tr_b16 v[14:15], v90 offset:1024
    v_mfma_f32_16x16x32_bf16 a[32:35], v[44:47], v[52:55], a[32:35]
    ds_read_b128 v[28:31], v78 offset:4096
    v_mfma_f32_16x16x32_bf16 a[36:39], v[44:47], v[56:59], a[36:39]
    ds_read_b64_tr_b16 v[16:17], v91
    v_mfma_f32_16x16x32_bf16 a[40:43], v[44:47], v[60:63], a[40:43]
    ds_read_b64_tr_b16 v[18:19], v91 offset:1024
    v_mfma_f32_16x16x32_bf16 a[44:47], v[44:47], v[64:67], a[44:47]
    ds_read_b128 v[32:35], v78 offset:6144
    v_mfma_f32_16x16x32_bf16 a[48:51], v[48:51], v[52:55], a[48:51]
    v_mfma_f32_16x16x32_bf16 a[52:55], v[48:51], v[56:59], a[52:55]
    v_mfma_f32_16x16x32_bf16 a[56:59], v[48:51], v[60:63], a[56:59]
    v_mfma_f32_16x16x32_bf16 a[60:63], v[48:51], v[64:67], a[60:63]
    s_waitcnt lgkmcnt(9)
    v_mfma_f32_16x16x32_bf16 a[0:3], v[4:7], v[20:23], a[0:3]
    ds_read_b64_tr_b16 v[36:37], v88 offset:8192
    s_waitcnt lgkmcnt(7)
    v_mfma_f32_16x16x32_bf16 a[4:7], v[4:7], v[24:27], a[4:7]
    ds_read_b64_tr_b16 v[38:39], v88 offset:9216
    s_waitcnt lgkmcnt(5)
    v_mfma_f32_16x16x32_bf16 a[8:11], v[4:7], v[28:31], a[8:11]
    ds_read_b128 v[52:55], v79
    s_waitcnt lgkmcnt(3)
    v_mfma_f32_16x16x32_bf16 a[12:15], v[4:7], v[32:35], a[12:15]
    ds_read_b64_tr_b16 v[40:41], v89 offset:8192
    v_mfma_f32_16x16x32_bf16 a[16:19], v[8:11], v[20:23], a[16:19]
    ds_read_b64_tr_b16 v[42:43], v89 offset:9216
    v_mfma_f32_16x16x32_bf16 a[20:23], v[8:11], v[24:27], a[20:23]
    ds_read_b128 v[56:59], v79 offset:2048
    v_mfma_f32_16x16x32_bf16 a[24:27], v[8:11], v[28:31], a[24:27]
    ds_read_b64_tr_b16 v[44:45], v90 offset:8192
    v_mfma_f32_16x16x32_bf16 a[28:31], v[8:11], v[32:35], a[28:31]
    ds_read_b64_tr_b16 v[46:47], v90 offset:9216
    v_mfma_f32_16x16x32_bf16 a[32:35], v[12:15], v[20:23], a[32:35]
    ds_read_b128 v[60:63], v79 offset:4096
    v_mfma_f32_16x16x32_bf16 a[36:39], v[12:15], v[24:27], a[36:39]
    ds_read_b64_tr_b16 v[48:49], v91 offset:8192
    v_mfma_f32_16x16x32_bf16 a[40:43], v[12:15], v[28:31], a[40:43]
    ds_read_b64_tr_b16 v[50:51], v91 offset:9216
    v_mfma_f32_16x16x32_bf16 a[44:47], v[12:15], v[32:35], a[44:47]
    ds_read_b128 v[64:67], v79 offset:6144
    v_mfma_f32_16x16x32_bf16 a[48:51], v[16:19], v[20:23], a[48:51]
    v_mfma_f32_16x16x32_bf16 a[52:55], v[16:19], v[24:27], a[52:55]
    v_mfma_f32_16x16x32_bf16 a[56:59], v[16:19], v[28:31], a[56:59]
    v_mfma_f32_16x16x32_bf16 a[60:63], v[16:19], v[32:35], a[60:63]
    s_waitcnt vmcnt(8) lgkmcnt(0)
    s_barrier
    v_mfma_f32_16x16x32_bf16 a[0:3], v[36:39], v[52:55], a[0:3]
    ds_read_b64_tr_b16 v[4:5], v92
    v_mfma_f32_16x16x32_bf16 a[4:7], v[36:39], v[56:59], a[4:7]
    ds_read_b64_tr_b16 v[6:7], v92 offset:1024
    v_mfma_f32_16x16x32_bf16 a[8:11], v[36:39], v[60:63], a[8:11]
    ds_read_b128 v[20:23], v80
    v_mfma_f32_16x16x32_bf16 a[12:15], v[36:39], v[64:67], a[12:15]
    ds_read_b64_tr_b16 v[8:9], v93
    v_mfma_f32_16x16x32_bf16 a[16:19], v[40:43], v[52:55], a[16:19]
    ds_read_b64_tr_b16 v[10:11], v93 offset:1024
    v_mfma_f32_16x16x32_bf16 a[20:23], v[40:43], v[56:59], a[20:23]
    ds_read_b128 v[24:27], v80 offset:2048
    v_mfma_f32_16x16x32_bf16 a[24:27], v[40:43], v[60:63], a[24:27]
    ds_read_b64_tr_b16 v[12:13], v94
    v_mfma_f32_16x16x32_bf16 a[28:31], v[40:43], v[64:67], a[28:31]
    ds_read_b64_tr_b16 v[14:15], v94 offset:1024
    v_mfma_f32_16x16x32_bf16 a[32:35], v[44:47], v[52:55], a[32:35]
    ds_read_b128 v[28:31], v80 offset:4096
    v_mfma_f32_16x16x32_bf16 a[36:39], v[44:47], v[56:59], a[36:39]
    ds_read_b64_tr_b16 v[16:17], v95
    v_mfma_f32_16x16x32_bf16 a[40:43], v[44:47], v[60:63], a[40:43]
    ds_read_b64_tr_b16 v[18:19], v95 offset:1024
    v_mfma_f32_16x16x32_bf16 a[44:47], v[44:47], v[64:67], a[44:47]
    ds_read_b128 v[32:35], v80 offset:6144
    v_mfma_f32_16x16x32_bf16 a[48:51], v[48:51], v[52:55], a[48:51]
    v_mfma_f32_16x16x32_bf16 a[52:55], v[48:51], v[56:59], a[52:55]
    v_mfma_f32_16x16x32_bf16 a[56:59], v[48:51], v[60:63], a[56:59]
    v_mfma_f32_16x16x32_bf16 a[60:63], v[48:51], v[64:67], a[60:63]
    s_waitcnt lgkmcnt(9)
    v_mfma_f32_16x16x32_bf16 a[0:3], v[4:7], v[20:23], a[0:3]
    ds_read_b64_tr_b16 v[36:37], v92 offset:8192
    s_waitcnt lgkmcnt(7)
    v_mfma_f32_16x16x32_bf16 a[4:7], v[4:7], v[24:27], a[4:7]
    ds_read_b64_tr_b16 v[38:39], v92 offset:9216
    s_waitcnt lgkmcnt(5)
    v_mfma_f32_16x16x32_bf16 a[8:11], v[4:7], v[28:31], a[8:11]
    ds_read_b128 v[52:55], v81
    s_waitcnt lgkmcnt(3)
    v_mfma_f32_16x16x32_bf16 a[12:15], v[4:7], v[32:35], a[12:15]
    ds_read_b64_tr_b16 v[40:41], v93 offset:8192
    v_mfma_f32_16x16x32_bf16 a[16:19], v[8:11], v[20:23], a[16:19]
    ds_read_b64_tr_b16 v[42:43], v93 offset:9216
    v_mfma_f32_16x16x32_bf16 a[20:23], v[8:11], v[24:27], a[20:23]
    ds_read_b128 v[56:59], v81 offset:2048
    v_mfma_f32_16x16x32_bf16 a[24:27], v[8:11], v[28:31], a[24:27]
    ds_read_b64_tr_b16 v[44:45], v94 offset:8192
    v_mfma_f32_16x16x32_bf16 a[28:31], v[8:11], v[32:35], a[28:31]
    ds_read_b64_tr_b16 v[46:47], v94 offset:9216
    v_mfma_f32_16x16x32_bf16 a[32:35], v[12:15], v[20:23], a[32:35]
    ds_read_b128 v[60:63], v81 offset:4096
    v_mfma_f32_16x16x32_bf16 a[36:39], v[12:15], v[24:27], a[36:39]
    ds_read_b64_tr_b16 v[48:49], v95 offset:8192
    v_mfma_f32_16x16x32_bf16 a[40:43], v[12:15], v[28:31], a[40:43]
    ds_read_b64_tr_b16 v[50:51], v95 offset:9216
    v_mfma_f32_16x16x32_bf16 a[44:47], v[12:15], v[32:35], a[44:47]
    ds_read_b128 v[64:67], v81 offset:6144
    v_mfma_f32_16x16x32_bf16 a[48:51], v[16:19], v[20:23], a[48:51]
    v_mfma_f32_16x16x32_bf16 a[52:55], v[16:19], v[24:27], a[52:55]
    v_mfma_f32_16x16x32_bf16 a[56:59], v[16:19], v[28:31], a[56:59]
    v_mfma_f32_16x16x32_bf16 a[60:63], v[16:19], v[32:35], a[60:63]
    s_waitcnt vmcnt(0) lgkmcnt(0)
    s_barrier
    v_mfma_f32_16x16x32_bf16 a[0:3], v[36:39], v[52:55], a[0:3]
    ds_read_b64_tr_b16 v[4:5], v96
    v_mfma_f32_16x16x32_bf16 a[4:7], v[36:39], v[56:59], a[4:7]
    ds_read_b64_tr_b16 v[6:7], v96 offset:1024
    v_mfma_f32_16x16x32_bf16 a[8:11], v[36:39], v[60:63], a[8:11]
    ds_read_b128 v[20:23], v82
    v_mfma_f32_16x16x32_bf16 a[12:15], v[36:39], v[64:67], a[12:15]
    ds_read_b64_tr_b16 v[8:9], v97
    v_mfma_f32_16x16x32_bf16 a[16:19], v[40:43], v[52:55], a[16:19]
    ds_read_b64_tr_b16 v[10:11], v97 offset:1024
    v_mfma_f32_16x16x32_bf16 a[20:23], v[40:43], v[56:59], a[20:23]
    ds_read_b128 v[24:27], v82 offset:2048
    v_mfma_f32_16x16x32_bf16 a[24:27], v[40:43], v[60:63], a[24:27]
    ds_read_b64_tr_b16 v[12:13], v98
    v_mfma_f32_16x16x32_bf16 a[28:31], v[40:43], v[64:67], a[28:31]
    ds_read_b64_tr_b16 v[14:15], v98 offset:1024
    v_mfma_f32_16x16x32_bf16 a[32:35], v[44:47], v[52:55], a[32:35]
    ds_read_b128 v[28:31], v82 offset:4096
    v_mfma_f32_16x16x32_bf16 a[36:39], v[44:47], v[56:59], a[36:39]
    ds_read_b64_tr_b16 v[16:17], v99
    v_mfma_f32_16x16x32_bf16 a[40:43], v[44:47], v[60:63], a[40:43]
    ds_read_b64_tr_b16 v[18:19], v99 offset:1024
    v_mfma_f32_16x16x32_bf16 a[44:47], v[44:47], v[64:67], a[44:47]
    ds_read_b128 v[32:35], v82 offset:6144
    v_mfma_f32_16x16x32_bf16 a[48:51], v[48:51], v[52:55], a[48:51]
    v_mfma_f32_16x16x32_bf16 a[52:55], v[48:51], v[56:59], a[52:55]
    v_mfma_f32_16x16x32_bf16 a[56:59], v[48:51], v[60:63], a[56:59]
    v_mfma_f32_16x16x32_bf16 a[60:63], v[48:51], v[64:67], a[60:63]
    s_waitcnt lgkmcnt(9)
    v_mfma_f32_16x16x32_bf16 a[0:3], v[4:7], v[20:23], a[0:3]
    ds_read_b64_tr_b16 v[36:37], v96 offset:8192
    s_waitcnt lgkmcnt(7)
    v_mfma_f32_16x16x32_bf16 a[4:7], v[4:7], v[24:27], a[4:7]
    ds_read_b64_tr_b16 v[38:39], v96 offset:9216
    s_waitcnt lgkmcnt(5)
    v_mfma_f32_16x16x32_bf16 a[8:11], v[4:7], v[28:31], a[8:11]
    ds_read_b128 v[52:55], v83
    s_waitcnt lgkmcnt(3)
    v_mfma_f32_16x16x32_bf16 a[12:15], v[4:7], v[32:35], a[12:15]
    ds_read_b64_tr_b16 v[40:41], v97 offset:8192
    v_mfma_f32_16x16x32_bf16 a[16:19], v[8:11], v[20:23], a[16:19]
    ds_read_b64_tr_b16 v[42:43], v97 offset:9216
    v_mfma_f32_16x16x32_bf16 a[20:23], v[8:11], v[24:27], a[20:23]
    ds_read_b128 v[56:59], v83 offset:2048
    v_mfma_f32_16x16x32_bf16 a[24:27], v[8:11], v[28:31], a[24:27]
    ds_read_b64_tr_b16 v[44:45], v98 offset:8192
    v_mfma_f32_16x16x32_bf16 a[28:31], v[8:11], v[32:35], a[28:31]
    ds_read_b64_tr_b16 v[46:47], v98 offset:9216
    v_mfma_f32_16x16x32_bf16 a[32:35], v[12:15], v[20:23], a[32:35]
    ds_read_b128 v[60:63], v83 offset:4096
    v_mfma_f32_16x16x32_bf16 a[36:39], v[12:15], v[24:27], a[36:39]
    ds_read_b64_tr_b16 v[48:49], v99 offset:8192
    v_mfma_f32_16x16x32_bf16 a[40:43], v[12:15], v[28:31], a[40:43]
    ds_read_b64_tr_b16 v[50:51], v99 offset:9216
    v_mfma_f32_16x16x32_bf16 a[44:47], v[12:15], v[32:35], a[44:47]
    ds_read_b128 v[64:67], v83 offset:6144
    v_mfma_f32_16x16x32_bf16 a[48:51], v[16:19], v[20:23], a[48:51]
    v_mfma_f32_16x16x32_bf16 a[52:55], v[16:19], v[24:27], a[52:55]
    v_mfma_f32_16x16x32_bf16 a[56:59], v[16:19], v[28:31], a[56:59]
    v_mfma_f32_16x16x32_bf16 a[60:63], v[16:19], v[32:35], a[60:63]
    s_waitcnt lgkmcnt(9)
    v_mfma_f32_16x16x32_bf16 a[0:3], v[36:39], v[52:55], a[0:3]
    s_waitcnt lgkmcnt(6)
    v_mfma_f32_16x16x32_bf16 a[4:7], v[36:39], v[56:59], a[4:7]
    s_waitcnt lgkmcnt(3)
    v_mfma_f32_16x16x32_bf16 a[8:11], v[36:39], v[60:63], a[8:11]
    s_waitcnt lgkmcnt(0)
    v_mfma_f32_16x16x32_bf16 a[12:15], v[36:39], v[64:67], a[12:15]
    v_mfma_f32_16x16x32_bf16 a[16:19], v[40:43], v[52:55], a[16:19]
    v_mfma_f32_16x16x32_bf16 a[20:23], v[40:43], v[56:59], a[20:23]
    v_mfma_f32_16x16x32_bf16 a[24:27], v[40:43], v[60:63], a[24:27]
    v_mfma_f32_16x16x32_bf16 a[28:31], v[40:43], v[64:67], a[28:31]
    v_mfma_f32_16x16x32_bf16 a[32:35], v[44:47], v[52:55], a[32:35]
    v_mfma_f32_16x16x32_bf16 a[36:39], v[44:47], v[56:59], a[36:39]
    v_mfma_f32_16x16x32_bf16 a[40:43], v[44:47], v[60:63], a[40:43]
    v_mfma_f32_16x16x32_bf16 a[44:47], v[44:47], v[64:67], a[44:47]
    v_mfma_f32_16x16x32_bf16 a[48:51], v[48:51], v[52:55], a[48:51]
    v_mfma_f32_16x16x32_bf16 a[52:55], v[48:51], v[56:59], a[52:55]
    v_mfma_f32_16x16x32_bf16 a[56:59], v[48:51], v[60:63], a[56:59]
    v_mfma_f32_16x16x32_bf16 a[60:63], v[48:51], v[64:67], a[60:63]
    v_and_b32 v104, 15, v0
    v_lshrrev_b32 v101, 6, v0
    v_lshrrev_b32 v102, 1, v101
    v_and_b32 v103, 1, v101
    v_mul_u32_u24 v106, 64, v102
    v_add_u32 v106, v106, v104
    v_mul_u32_u24 v107, 128, v103
    v_mad_u32_u24 v100, v106, s22, v107
    v_bfe_u32 v105, v0, 4, 2
    v_and_b32 v106, 1, v105
    v_lshlrev_b32 v106, 5, v106
    v_lshrrev_b32 v107, 1, v105
    v_lshl_or_b32 v106, v107, 4, v106
    v_add_u32 v100, v100, v106
    s_cmp_eq_u32 s23, 0
    s_cbranch_scc1 gemm2_kernel_epi_plain
    v_accvgpr_read_b32 v4, a0
    v_accvgpr_read_b32 v5, a1
    v_accvgpr_read_b32 v6, a2
    v_accvgpr_read_b32 v7, a3
    v_accvgpr_read_b32 v8, a16
    v_accvgpr_read_b32 v9, a17
    v_accvgpr_read_b32 v10, a18
    v_accvgpr_read_b32 v11, a19
    v_cvt_pk_bf16_f32 v12, v4, v5
    v_cvt_pk_bf16_f32 v13, v6, v7
    v_cvt_pk_bf16_f32 v14, v8, v9
    v_cvt_pk_bf16_f32 v15, v10, v11
    v_lshlrev_b32 v4, 16, v12
    v_and_b32 v5, 4294901760, v12
    v_mul_f32 v6, -1.4426950408889634, v4
    v_mul_f32 v7, -1.4426950408889634, v5
    v_exp_f32 v6, v6
    v_exp_f32 v7, v7
    v_add_f32 v6, 1.0, v6
    v_add_f32 v7, 1.0, v7
    v_rcp_f32 v6, v6
    v_rcp_f32 v7, v7
    v_mul_f32 v4, v4, v6
    v_mul_f32 v5, v5, v7
    v_cvt_pk_bf16_f32 v12, v4, v5
    v_lshlrev_b32 v8, 16, v13
    v_and_b32 v9, 4294901760, v13
    v_mul_f32 v10, -1.4426950408889634, v8
    v_mul_f32 v11, -1.4426950408889634, v9
    v_exp_f32 v10, v10
    v_exp_f32 v11, v11
    v_add_f32 v10, 1.0, v10
    v_add_f32 v11, 1.0, v11
    v_rcp_f32 v10, v10
    v_rcp_f32 v11, v11
    v_mul_f32 v8, v8, v10
    v_mul_f32 v9, v9, v11
    v_cvt_pk_bf16_f32 v13, v8, v9
    v_lshlrev_b32 v4, 16, v14
    v_and_b32 v5, 4294901760, v14
    v_mul_f32 v6, -1.4426950408889634, v4
    v_mul_f32 v7, -1.4426950408889634, v5
    v_exp_f32 v6, v6
    v_exp_f32 v7, v7
    v_add_f32 v6, 1.0, v6
    v_add_f32 v7, 1.0, v7
    v_rcp_f32 v6, v6
    v_rcp_f32 v7, v7
    v_mul_f32 v4, v4, v6
    v_mul_f32 v5, v5, v7
    v_cvt_pk_bf16_f32 v14, v4, v5
    v_lshlrev_b32 v8, 16, v15
    v_and_b32 v9, 4294901760, v15
    v_mul_f32 v10, -1.4426950408889634, v8
    v_mul_f32 v11, -1.4426950408889634, v9
    v_exp_f32 v10, v10
    v_exp_f32 v11, v11
    v_add_f32 v10, 1.0, v10
    v_add_f32 v11, 1.0, v11
    v_rcp_f32 v10, v10
    v_rcp_f32 v11, v11
    v_mul_f32 v8, v8, v10
    v_mul_f32 v9, v9, v11
    v_cvt_pk_bf16_f32 v15, v8, v9
    v_permlane16_swap_b32 v12, v14
    s_nop 0
    v_permlane16_swap_b32 v13, v15
    buffer_store_dwordx4 v[12:15], v100, s[12:15], 0 offen sc1
    v_accvgpr_read_b32 v16, a32
    v_accvgpr_read_b32 v17, a33
    v_accvgpr_read_b32 v18, a34
    v_accvgpr_read_b32 v19, a35
    v_accvgpr_read_b32 v20, a48
    v_accvgpr_read_b32 v21, a49
    v_accvgpr_read_b32 v22, a50
    v_accvgpr_read_b32 v23, a51
    v_cvt_pk_bf16_f32 v24, v16, v17
    v_cvt_pk_bf16_f32 v25, v18, v19
    v_cvt_pk_bf16_f32 v26, v20, v21
    v_cvt_pk_bf16_f32 v27, v22, v23
    v_lshlrev_b32 v16, 16, v24
    v_and_b32 v17, 4294901760, v24
    v_mul_f32 v18, -1.4426950408889634, v16
    v_mul_f32 v19, -1.4426950408889634, v17
    v_exp_f32 v18, v18
    v_exp_f32 v19, v19
    v_add_f32 v18, 1.0, v18
    v_add_f32 v19, 1.0, v19
    v_rcp_f32 v18, v18
    v_rcp_f32 v19, v19
    v_mul_f32 v16, v16, v18
    v_mul_f32 v17, v17, v19
    v_cvt_pk_bf16_f32 v24, v16, v17
    v_lshlrev_b32 v20, 16, v25
    v_and_b32 v21, 4294901760, v25
    v_mul_f32 v22, -1.4426950408889634, v20
    v_mul_f32 v23, -1.4426950408889634, v21
    v_exp_f32 v22, v22
    v_exp_f32 v23, v23
    v_add_f32 v22, 1.0, v22
    v_add_f32 v23, 1.0, v23
    v_rcp_f32 v22, v22
    v_rcp_f32 v23, v23
    v_mul_f32 v20, v20, v22
    v_mul_f32 v21, v21, v23
    v_cvt_pk_bf16_f32 v25, v20, v21
    v_lshlrev_b32 v16, 16, v26
    v_and_b32 v17, 4294901760, v26
    v_mul_f32 v18, -1.4426950408889634, v16
    v_mul_f32 v19, -1.4426950408889634, v17
    v_exp_f32 v18, v18
    v_exp_f32 v19, v19
    v_add_f32 v18, 1.0, v18
    v_add_f32 v19, 1.0, v19
    v_rcp_f32 v18, v18
    v_rcp_f32 v19, v19
    v_mul_f32 v16, v16, v18
    v_mul_f32 v17, v17, v19
    v_cvt_pk_bf16_f32 v26, v16, v17
    v_lshlrev_b32 v20, 16, v27
    v_and_b32 v21, 4294901760, v27
    v_mul_f32 v22, -1.4426950408889634, v20
    v_mul_f32 v23, -1.4426950408889634, v21
    v_exp_f32 v22, v22
    v_exp_f32 v23, v23
    v_add_f32 v22, 1.0, v22
    v_add_f32 v23, 1.0, v23
    v_rcp_f32 v22, v22
    v_rcp_f32 v23, v23
    v_mul_f32 v20, v20, v22
    v_mul_f32 v21, v21, v23
    v_cvt_pk_bf16_f32 v27, v20, v21
    v_permlane16_swap_b32 v24, v26
    s_nop 0
    v_permlane16_swap_b32 v25, v27
    buffer_store_dwordx4 v[24:27], v100, s[12:15], 0 offen offset:64 sc1
    v_accvgpr_read_b32 v28, a4
    v_accvgpr_read_b32 v29, a5
    v_accvgpr_read_b32 v30, a6
    v_accvgpr_read_b32 v31, a7
    v_accvgpr_read_b32 v32, a20
    v_accvgpr_read_b32 v33, a21
    v_accvgpr_read_b32 v34, a22
    v_accvgpr_read_b32 v35, a23
    v_cvt_pk_bf16_f32 v36, v28, v29
    v_cvt_pk_bf16_f32 v37, v30, v31
    v_cvt_pk_bf16_f32 v38, v32, v33
    v_cvt_pk_bf16_f32 v39, v34, v35
    v_lshlrev_b32 v28, 16, v36
    v_and_b32 v29, 4294901760, v36
    v_mul_f32 v30, -1.4426950408889634, v28
    v_mul_f32 v31, -1.4426950408889634, v29
    v_exp_f32 v30, v30
    v_exp_f32 v31, v31
    v_add_f32 v30, 1.0, v30
    v_add_f32 v31, 1.0, v31
    v_rcp_f32 v30, v30
    v_rcp_f32 v31, v31
    v_mul_f32 v28, v28, v30
    v_mul_f32 v29, v29, v31
    v_cvt_pk_bf16_f32 v36, v28, v29
    v_lshlrev_b32 v32, 16, v37
    v_and_b32 v33, 4294901760, v37
    v_mul_f32 v34, -1.4426950408889634, v32
    v_mul_f32 v35, -1.4426950408889634, v33
    v_exp_f32 v34, v34
    v_exp_f32 v35, v35
    v_add_f32 v34, 1.0, v34
    v_add_f32 v35, 1.0, v35
    v_rcp_f32 v34, v34
    v_rcp_f32 v35, v35
    v_mul_f32 v32, v32, v34
    v_mul_f32 v33, v33, v35
    v_cvt_pk_bf16_f32 v37, v32, v33
    v_lshlrev_b32 v28, 16, v38
    v_and_b32 v29, 4294901760, v38
    v_mul_f32 v30, -1.4426950408889634, v28
    v_mul_f32 v31, -1.4426950408889634, v29
    v_exp_f32 v30, v30
    v_exp_f32 v31, v31
    v_add_f32 v30, 1.0, v30
    v_add_f32 v31, 1.0, v31
    v_rcp_f32 v30, v30
    v_rcp_f32 v31, v31
    v_mul_f32 v28, v28, v30
    v_mul_f32 v29, v29, v31
    v_cvt_pk_bf16_f32 v38, v28, v29
    v_lshlrev_b32 v32, 16, v39
    v_and_b32 v33, 4294901760, v39
    v_mul_f32 v34, -1.4426950408889634, v32
    v_mul_f32 v35, -1.4426950408889634, v33
    v_exp_f32 v34, v34
    v_exp_f32 v35, v35
    v_add_f32 v34, 1.0, v34
    v_add_f32 v35, 1.0, v35
    v_rcp_f32 v34, v34
    v_rcp_f32 v35, v35
    v_mul_f32 v32, v32, v34
    v_mul_f32 v33, v33, v35
    v_cvt_pk_bf16_f32 v39, v32, v33
    v_permlane16_swap_b32 v36, v38
    s_nop 0
    v_permlane16_swap_b32 v37, v39
    s_mov_b32 s27, 32768
    buffer_store_dwordx4 v[36:39], v100, s[12:15], s27 offen sc1
    v_accvgpr_read_b32 v40, a36
    v_accvgpr_read_b32 v41, a37
    v_accvgpr_read_b32 v42, a38
    v_accvgpr_read_b32 v43, a39
    v_accvgpr_read_b32 v44, a52
    v_accvgpr_read_b32 v45, a53
    v_accvgpr_read_b32 v46, a54
    v_accvgpr_read_b32 v47, a55
    v_cvt_pk_bf16_f32 v48, v40, v41
    v_cvt_pk_bf16_f32 v49, v42, v43
    v_cvt_pk_bf16_f32 v50, v44, v45
    v_cvt_pk_bf16_f32 v51, v46, v47
    v_lshlrev_b32 v40, 16, v48
    v_and_b32 v41, 4294901760, v48
    v_mul_f32 v42, -1.4426950408889634, v40
    v_mul_f32 v43, -1.4426950408889634, v41
    v_exp_f32 v42, v42
    v_exp_f32 v43, v43
    v_add_f32 v42, 1.0, v42
    v_add_f32 v43, 1.0, v43
    v_rcp_f32 v42, v42
    v_rcp_f32 v43, v43
    v_mul_f32 v40, v40, v42
    v_mul_f32 v41, v41, v43
    v_cvt_pk_bf16_f32 v48, v40, v41
    v_lshlrev_b32 v44, 16, v49
    v_and_b32 v45, 4294901760, v49
    v_mul_f32 v46, -1.4426950408889634, v44
    v_mul_f32 v47, -1.4426950408889634, v45
    v_exp_f32 v46, v46
    v_exp_f32 v47, v47
    v_add_f32 v46, 1.0, v46
    v_add_f32 v47, 1.0, v47
    v_rcp_f32 v46, v46
    v_rcp_f32 v47, v47
    v_mul_f32 v44, v44, v46
    v_mul_f32 v45, v45, v47
    v_cvt_pk_bf16_f32 v49, v44, v45
    v_lshlrev_b32 v40, 16, v50
    v_and_b32 v41, 4294901760, v50
    v_mul_f32 v42, -1.4426950408889634, v40
    v_mul_f32 v43, -1.4426950408889634, v41
    v_exp_f32 v42, v42
    v_exp_f32 v43, v43
    v_add_f32 v42, 1.0, v42
    v_add_f32 v43, 1.0, v43
    v_rcp_f32 v42, v42
    v_rcp_f32 v43, v43
    v_mul_f32 v40, v40, v42
    v_mul_f32 v41, v41, v43
    v_cvt_pk_bf16_f32 v50, v40, v41
    v_lshlrev_b32 v44, 16, v51
    v_and_b32 v45, 4294901760, v51
    v_mul_f32 v46, -1.4426950408889634, v44
    v_mul_f32 v47, -1.4426950408889634, v45
    v_exp_f32 v46, v46
    v_exp_f32 v47, v47
    v_add_f32 v46, 1.0, v46
    v_add_f32 v47, 1.0, v47
    v_rcp_f32 v46, v46
    v_rcp_f32 v47, v47
    v_mul_f32 v44, v44, v46
    v_mul_f32 v45, v45, v47
    v_cvt_pk_bf16_f32 v51, v44, v45
    v_permlane16_swap_b32 v48, v50
    s_nop 0
    v_permlane16_swap_b32 v49, v51
    s_mov_b32 s27, 32768
    buffer_store_dwordx4 v[48:51], v100, s[12:15], s27 offen offset:64 sc1
    v_accvgpr_read_b32 v4, a8
    v_accvgpr_read_b32 v5, a9
    v_accvgpr_read_b32 v6, a10
    v_accvgpr_read_b32 v7, a11
    v_accvgpr_read_b32 v8, a24
    v_accvgpr_read_b32 v9, a25
    v_accvgpr_read_b32 v10, a26
    v_accvgpr_read_b32 v11, a27
    v_cvt_pk_bf16_f32 v12, v4, v5
    v_cvt_pk_bf16_f32 v13, v6, v7
    v_cvt_pk_bf16_f32 v14, v8, v9
    v_cvt_pk_bf16_f32 v15, v10, v11
    v_lshlrev_b32 v4, 16, v12
    v_and_b32 v5, 4294901760, v12
    v_mul_f32 v6, -1.4426950408889634, v4
    v_mul_f32 v7, -1.4426950408889634, v5
    v_exp_f32 v6, v6
    v_exp_f32 v7, v7
    v_add_f32 v6, 1.0, v6
    v_add_f32 v7, 1.0, v7
    v_rcp_f32 v6, v6
    v_rcp_f32 v7, v7
    v_mul_f32 v4, v4, v6
    v_mul_f32 v5, v5, v7
    v_cvt_pk_bf16_f32 v12, v4, v5
    v_lshlrev_b32 v8, 16, v13
    v_and_b32 v9, 4294901760, v13
    v_mul_f32 v10, -1.4426950408889634, v8
    v_mul_f32 v11, -1.4426950408889634, v9
    v_exp_f32 v10, v10
    v_exp_f32 v11, v11
    v_add_f32 v10, 1.0, v10
    v_add_f32 v11, 1.0, v11
    v_rcp_f32 v10, v10
    v_rcp_f32 v11, v11
    v_mul_f32 v8, v8, v10
    v_mul_f32 v9, v9, v11
    v_cvt_pk_bf16_f32 v13, v8, v9
    v_lshlrev_b32 v4, 16, v14
    v_and_b32 v5, 4294901760, v14
    v_mul_f32 v6, -1.4426950408889634, v4
    v_mul_f32 v7, -1.4426950408889634, v5
    v_exp_f32 v6, v6
    v_exp_f32 v7, v7
    v_add_f32 v6, 1.0, v6
    v_add_f32 v7, 1.0, v7
    v_rcp_f32 v6, v6
    v_rcp_f32 v7, v7
    v_mul_f32 v4, v4, v6
    v_mul_f32 v5, v5, v7
    v_cvt_pk_bf16_f32 v14, v4, v5
    v_lshlrev_b32 v8, 16, v15
    v_and_b32 v9, 4294901760, v15
    v_mul_f32 v10, -1.4426950408889634, v8
    v_mul_f32 v11, -1.4426950408889634, v9
    v_exp_f32 v10, v10
    v_exp_f32 v11, v11
    v_add_f32 v10, 1.0, v10
    v_add_f32 v11, 1.0, v11
    v_rcp_f32 v10, v10
    v_rcp_f32 v11, v11
    v_mul_f32 v8, v8, v10
    v_mul_f32 v9, v9, v11
    v_cvt_pk_bf16_f32 v15, v8, v9
    v_permlane16_swap_b32 v12, v14
    s_nop 0
    v_permlane16_swap_b32 v13, v15
    s_mov_b32 s27, 65536
    buffer_store_dwordx4 v[12:15], v100, s[12:15], s27 offen sc1
    v_accvgpr_read_b32 v16, a40
    v_accvgpr_read_b32 v17, a41
    v_accvgpr_read_b32 v18, a42
    v_accvgpr_read_b32 v19, a43
    v_accvgpr_read_b32 v20, a56
    v_accvgpr_read_b32 v21, a57
    v_accvgpr_read_b32 v22, a58
    v_accvgpr_read_b32 v23, a59
    v_cvt_pk_bf16_f32 v24, v16, v17
    v_cvt_pk_bf16_f32 v25, v18, v19
    v_cvt_pk_bf16_f32 v26, v20, v21
    v_cvt_pk_bf16_f32 v27, v22, v23
    v_lshlrev_b32 v16, 16, v24
    v_and_b32 v17, 4294901760, v24
    v_mul_f32 v18, -1.4426950408889634, v16
    v_mul_f32 v19, -1.4426950408889634, v17
    v_exp_f32 v18, v18
    v_exp_f32 v19, v19
    v_add_f32 v18, 1.0, v18
    v_add_f32 v19, 1.0, v19
    v_rcp_f32 v18, v18
    v_rcp_f32 v19, v19
    v_mul_f32 v16, v16, v18
    v_mul_f32 v17, v17, v19
    v_cvt_pk_bf16_f32 v24, v16, v17
    v_lshlrev_b32 v20, 16, v25
    v_and_b32 v21, 4294901760, v25
    v_mul_f32 v22, -1.4426950408889634, v20
    v_mul_f32 v23, -1.4426950408889634, v21
    v_exp_f32 v22, v22
    v_exp_f32 v23, v23
    v_add_f32 v22, 1.0, v22
    v_add_f32 v23, 1.0, v23
    v_rcp_f32 v22, v22
    v_rcp_f32 v23, v23
    v_mul_f32 v20, v20, v22
    v_mul_f32 v21, v21, v23
    v_cvt_pk_bf16_f32 v25, v20, v21
    v_lshlrev_b32 v16, 16, v26
    v_and_b32 v17, 4294901760, v26
    v_mul_f32 v18, -1.4426950408889634, v16
    v_mul_f32 v19, -1.4426950408889634, v17
    v_exp_f32 v18, v18
    v_exp_f32 v19, v19
    v_add_f32 v18, 1.0, v18
    v_add_f32 v19, 1.0, v19
    v_rcp_f32 v18, v18
    v_rcp_f32 v19, v19
    v_mul_f32 v16, v16, v18
    v_mul_f32 v17, v17, v19
    v_cvt_pk_bf16_f32 v26, v16, v17
    v_lshlrev_b32 v20, 16, v27
    v_and_b32 v21, 4294901760, v27
    v_mul_f32 v22, -1.4426950408889634, v20
    v_mul_f32 v23, -1.4426950408889634, v21
    v_exp_f32 v22, v22
    v_exp_f32 v23, v23
    v_add_f32 v22, 1.0, v22
    v_add_f32 v23, 1.0, v23
    v_rcp_f32 v22, v22
    v_rcp_f32 v23, v23
    v_mul_f32 v20, v20, v22
    v_mul_f32 v21, v21, v23
    v_cvt_pk_bf16_f32 v27, v20, v21
    v_permlane16_swap_b32 v24, v26
    s_nop 0
    v_permlane16_swap_b32 v25, v27
    s_mov_b32 s27, 65536
    buffer_store_dwordx4 v[24:27], v100, s[12:15], s27 offen offset:64 sc1
    v_accvgpr_read_b32 v28, a12
    v_accvgpr_read_b32 v29, a13
    v_accvgpr_read_b32 v30, a14
    v_accvgpr_read_b32 v31, a15
    v_accvgpr_read_b32 v32, a28
    v_accvgpr_read_b32 v33, a29
    v_accvgpr_read_b32 v34, a30
    v_accvgpr_read_b32 v35, a31
    v_cvt_pk_bf16_f32 v36, v28, v29
    v_cvt_pk_bf16_f32 v37, v30, v31
    v_cvt_pk_bf16_f32 v38, v32, v33
    v_cvt_pk_bf16_f32 v39, v34, v35
    v_lshlrev_b32 v28, 16, v36
    v_and_b32 v29, 4294901760, v36
    v_mul_f32 v30, -1.4426950408889634, v28
    v_mul_f32 v31, -1.4426950408889634, v29
    v_exp_f32 v30, v30
    v_exp_f32 v31, v31
    v_add_f32 v30, 1.0, v30
    v_add_f32 v31, 1.0, v31
    v_rcp_f32 v30, v30
    v_rcp_f32 v31, v31
    v_mul_f32 v28, v28, v30
    v_mul_f32 v29, v29, v31
    v_cvt_pk_bf16_f32 v36, v28, v29
    v_lshlrev_b32 v32, 16, v37
    v_and_b32 v33, 4294901760, v37
    v_mul_f32 v34, -1.4426950408889634, v32
    v_mul_f32 v35, -1.4426950408889634, v33
    v_exp_f32 v34, v34
    v_exp_f32 v35, v35
    v_add_f32 v34, 1.0, v34
    v_add_f32 v35, 1.0, v35
    v_rcp_f32 v34, v34
    v_rcp_f32 v35, v35
    v_mul_f32 v32, v32, v34
    v_mul_f32 v33, v33, v35
    v_cvt_pk_bf16_f32 v37, v32, v33
    v_lshlrev_b32 v28, 16, v38
    v_and_b32 v29, 4294901760, v38
    v_mul_f32 v30, -1.4426950408889634, v28
    v_mul_f32 v31, -1.4426950408889634, v29
    v_exp_f32 v30, v30
    v_exp_f32 v31, v31
    v_add_f32 v30, 1.0, v30
    v_add_f32 v31, 1.0, v31
    v_rcp_f32 v30, v30
    v_rcp_f32 v31, v31
    v_mul_f32 v28, v28, v30
    v_mul_f32 v29, v29, v31
    v_cvt_pk_bf16_f32 v38, v28, v29
    v_lshlrev_b32 v32, 16, v39
    v_and_b32 v33, 4294901760, v39
    v_mul_f32 v34, -1.4426950408889634, v32
    v_mul_f32 v35, -1.4426950408889634, v33
    v_exp_f32 v34, v34
    v_exp_f32 v35, v35
    v_add_f32 v34, 1.0, v34
    v_add_f32 v35, 1.0, v35
    v_rcp_f32 v34, v34
    v_rcp_f32 v35, v35
    v_mul_f32 v32, v32, v34
    v_mul_f32 v33, v33, v35
    v_cvt_pk_bf16_f32 v39, v32, v33
    v_permlane16_swap_b32 v36, v38
    s_nop 0
    v_permlane16_swap_b32 v37, v39
    s_mov_b32 s27, 98304
    buffer_store_dwordx4 v[36:39], v100, s[12:15], s27 offen sc1
    v_accvgpr_read_b32 v40, a44
    v_accvgpr_read_b32 v41, a45
    v_accvgpr_read_b32 v42, a46
    v_accvgpr_read_b32 v43, a47
    v_accvgpr_read_b32 v44, a60
    v_accvgpr_read_b32 v45, a61
    v_accvgpr_read_b32 v46, a62
    v_accvgpr_read_b32 v47, a63
    v_cvt_pk_bf16_f32 v48, v40, v41
    v_cvt_pk_bf16_f32 v49, v42, v43
    v_cvt_pk_bf16_f32 v50, v44, v45
    v_cvt_pk_bf16_f32 v51, v46, v47
    v_lshlrev_b32 v40, 16, v48
    v_and_b32 v41, 4294901760, v48
    v_mul_f32 v42, -1.4426950408889634, v40
    v_mul_f32 v43, -1.4426950408889634, v41
    v_exp_f32 v42, v42
    v_exp_f32 v43, v43
    v_add_f32 v42, 1.0, v42
    v_add_f32 v43, 1.0, v43
    v_rcp_f32 v42, v42
    v_rcp_f32 v43, v43
    v_mul_f32 v40, v40, v42
    v_mul_f32 v41, v41, v43
    v_cvt_pk_bf16_f32 v48, v40, v41
    v_lshlrev_b32 v44, 16, v49
    v_and_b32 v45, 4294901760, v49
    v_mul_f32 v46, -1.4426950408889634, v44
    v_mul_f32 v47, -1.4426950408889634, v45
    v_exp_f32 v46, v46
    v_exp_f32 v47, v47
    v_add_f32 v46, 1.0, v46
    v_add_f32 v47, 1.0, v47
    v_rcp_f32 v46, v46
    v_rcp_f32 v47, v47
    v_mul_f32 v44, v44, v46
    v_mul_f32 v45, v45, v47
    v_cvt_pk_bf16_f32 v49, v44, v45
    v_lshlrev_b32 v40, 16, v50
    v_and_b32 v41, 4294901760, v50
    v_mul_f32 v42, -1.4426950408889634, v40
    v_mul_f32 v43, -1.4426950408889634, v41
    v_exp_f32 v42, v42
    v_exp_f32 v43, v43
    v_add_f32 v42, 1.0, v42
    v_add_f32 v43, 1.0, v43
    v_rcp_f32 v42, v42
    v_rcp_f32 v43, v43
    v_mul_f32 v40, v40, v42
    v_mul_f32 v41, v41, v43
    v_cvt_pk_bf16_f32 v50, v40, v41
    v_lshlrev_b32 v44, 16, v51
    v_and_b32 v45, 4294901760, v51
    v_mul_f32 v46, -1.4426950408889634, v44
    v_mul_f32 v47, -1.4426950408889634, v45
    v_exp_f32 v46, v46
    v_exp_f32 v47, v47
    v_add_f32 v46, 1.0, v46
    v_add_f32 v47, 1.0, v47
    v_rcp_f32 v46, v46
    v_rcp_f32 v47, v47
    v_mul_f32 v44, v44, v46
    v_mul_f32 v45, v45, v47
    v_cvt_pk_bf16_f32 v51, v44, v45
    v_permlane16_swap_b32 v48, v50
    s_nop 0
    v_permlane16_swap_b32 v49, v51
    s_mov_b32 s27, 98304
    buffer_store_dwordx4 v[48:51], v100, s[12:15], s27 offen offset:64 sc1
    s_waitcnt vmcnt(0)
    s_barrier
    v_lshrrev_b32 v101, 6, v0
    s_nop 0
    v_readfirstlane_b32 s29, v101
    s_cmp_lg_u32 s29, 0
    s_cbranch_scc1 gemm2_kernel_end
    v_mov_b32 v102, s50
    v_mov_b32 v103, 1
    buffer_store_dword v103, v102, s[60:63], 0 offen sc1
    s_branch gemm2_kernel_end
gemm2_kernel_epi_plain:
    s_waitcnt vmcnt(0) lgkmcnt(0)
    s_nop 15
    s_nop 7
    v_accvgpr_read_b32 v144, a0
    v_accvgpr_read_b32 v145, a1
    v_accvgpr_read_b32 v146, a2
    v_accvgpr_read_b32 v147, a3
    v_accvgpr_read_b32 v148, a16
    v_accvgpr_read_b32 v149, a17
    v_accvgpr_read_b32 v150, a18
    v_accvgpr_read_b32 v151, a19
    v_cvt_pk_bf16_f32 v4, v144, v145
    v_cvt_pk_bf16_f32 v5, v146, v147
    v_cvt_pk_bf16_f32 v6, v148, v149
    v_cvt_pk_bf16_f32 v7, v150, v151
    s_nop 0
    v_permlane16_swap_b32 v4, v6
    v_permlane16_swap_b32 v5, v7
    v_accvgpr_read_b32 v144, a32
    v_accvgpr_read_b32 v145, a33
    v_accvgpr_read_b32 v146, a34
    v_accvgpr_read_b32 v147, a35
    v_accvgpr_read_b32 v148, a48
    v_accvgpr_read_b32 v149, a49
    v_accvgpr_read_b32 v150, a50
    v_accvgpr_read_b32 v151, a51
    v_cvt_pk_bf16_f32 v8, v144, v145
    v_cvt_pk_bf16_f32 v9, v146, v147
    v_cvt_pk_bf16_f32 v10, v148, v149
    v_cvt_pk_bf16_f32 v11, v150, v151
    s_nop 0
    v_permlane16_swap_b32 v8, v10
    v_permlane16_swap_b32 v9, v11
    v_accvgpr_read_b32 v144, a4
    v_accvgpr_read_b32 v145, a5
    v_accvgpr_read_b32 v146, a6
    v_accvgpr_read_b32 v147, a7
    v_accvgpr_read_b32 v148, a20
    v_accvgpr_read_b32 v149, a21
    v_accvgpr_read_b32 v150, a22
    v_accvgpr_read_b32 v151, a23
    v_cvt_pk_bf16_f32 v12, v144, v145
    v_cvt_pk_bf16_f32 v13, v146, v147
    v_cvt_pk_bf16_f32 v14, v148, v149
    v_cvt_pk_bf16_f32 v15, v150, v151
    s_nop 0
    v_permlane16_swap_b32 v12, v14
    v_permlane16_swap_b32 v13, v15
    v_accvgpr_read_b32 v144, a36
    v_accvgpr_read_b32 v145, a37
    v_accvgpr_read_b32 v146, a38
    v_accvgpr_read_b32 v147, a39
    v_accvgpr_read_b32 v148, a52
    v_accvgpr_read_b32 v149, a53
    v_accvgpr_read_b32 v150, a54
    v_accvgpr_read_b32 v151, a55
    v_cvt_pk_bf16_f32 v16, v144, v145
    v_cvt_pk_bf16_f32 v17, v146, v147
    v_cvt_pk_bf16_f32 v18, v148, v149
    v_cvt_pk_bf16_f32 v19, v150, v151
    s_nop 0
    v_permlane16_swap_b32 v16, v18
    v_permlane16_swap_b32 v17, v19
    v_accvgpr_read_b32 v144, a8
    v_accvgpr_read_b32 v145, a9
    v_accvgpr_read_b32 v146, a10
    v_accvgpr_read_b32 v147, a11
    v_accvgpr_read_b32 v148, a24
    v_accvgpr_read_b32 v149, a25
    v_accvgpr_read_b32 v150, a26
    v_accvgpr_read_b32 v151, a27
    v_cvt_pk_bf16_f32 v20, v144, v145
    v_cvt_pk_bf16_f32 v21, v146, v147
    v_cvt_pk_bf16_f32 v22, v148, v149
    v_cvt_pk_bf16_f32 v23, v150, v151
    s_nop 0
    v_permlane16_swap_b32 v20, v22
    v_permlane16_swap_b32 v21, v23
    v_accvgpr_read_b32 v144, a40
    v_accvgpr_read_b32 v145, a41
    v_accvgpr_read_b32 v146, a42
    v_accvgpr_read_b32 v147, a43
    v_accvgpr_read_b32 v148, a56
    v_accvgpr_read_b32 v149, a57
    v_accvgpr_read_b32 v150, a58
    v_accvgpr_read_b32 v151, a59
    v_cvt_pk_bf16_f32 v24, v144, v145
    v_cvt_pk_bf16_f32 v25, v146, v147
    v_cvt_pk_bf16_f32 v26, v148, v149
    v_cvt_pk_bf16_f32 v27, v150, v151
    s_nop 0
    v_permlane16_swap_b32 v24, v26
    v_permlane16_swap_b32 v25, v27
    v_accvgpr_read_b32 v144, a12
    v_accvgpr_read_b32 v145, a13
    v_accvgpr_read_b32 v146, a14
    v_accvgpr_read_b32 v147, a15
    v_accvgpr_read_b32 v148, a28
    v_accvgpr_read_b32 v149, a29
    v_accvgpr_read_b32 v150, a30
    v_accvgpr_read_b32 v151, a31
    v_cvt_pk_bf16_f32 v28, v144, v145
    v_cvt_pk_bf16_f32 v29, v146, v147
    v_cvt_pk_bf16_f32 v30, v148, v149
    v_cvt_pk_bf16_f32 v31, v150, v151
    s_nop 0
    v_permlane16_swap_b32 v28, v30
    v_permlane16_swap_b32 v29, v31
    v_accvgpr_read_b32 v144, a44
    v_accvgpr_read_b32 v145, a45
    v_accvgpr_read_b32 v146, a46
    v_accvgpr_read_b32 v147, a47
    v_accvgpr_read_b32 v148, a60
    v_accvgpr_read_b32 v149, a61
    v_accvgpr_read_b32 v150, a62
    v_accvgpr_read_b32 v151, a63
    v_cvt_pk_bf16_f32 v32, v144, v145
    v_cvt_pk_bf16_f32 v33, v146, v147
    v_cvt_pk_bf16_f32 v34, v148, v149
    v_cvt_pk_bf16_f32 v35, v150, v151
    s_nop 0
    v_permlane16_swap_b32 v32, v34
    v_permlane16_swap_b32 v33, v35
    v_lshlrev_b32 v144, 16, v4
    v_and_b32 v145, 4294901760, v4
    v_lshlrev_b32 v146, 16, v112
    v_and_b32 v147, 4294901760, v112
    v_mul_f32 v144, v144, v146
    v_mul_f32 v145, v145, v147
    v_cvt_pk_bf16_f32 v150, v144, v145
    v_lshlrev_b32 v144, 16, v150
    v_and_b32 v145, 4294901760, v150
    v_lshlrev_b32 v148, 16, v160
    v_and_b32 v149, 4294901760, v160
    v_add_f32 v148, v148, v144
    v_add_f32 v149, v149, v145
    v_cvt_pk_bf16_f32 v4, v148, v149
    v_lshlrev_b32 v152, 16, v5
    v_and_b32 v153, 4294901760, v5
    v_lshlrev_b32 v154, 16, v113
    v_and_b32 v155, 4294901760, v113
    v_mul_f32 v152, v152, v154
    v_mul_f32 v153, v153, v155
    v_cvt_pk_bf16_f32 v158, v152, v153
    v_lshlrev_b32 v152, 16, v158
    v_and_b32 v153, 4294901760, v158
    v_lshlrev_b32 v156, 16, v161
    v_and_b32 v157, 4294901760, v161
    v_add_f32 v156, v156, v152
    v_add_f32 v157, v157, v153
    v_cvt_pk_bf16_f32 v5, v156, v157
    v_lshlrev_b32 v144, 16, v6
    v_and_b32 v145, 4294901760, v6
    v_lshlrev_b32 v146, 16, v114
    v_and_b32 v147, 4294901760, v114
    v_mul_f32 v144, v144, v146
    v_mul_f32 v145, v145, v147
    v_cvt_pk_bf16_f32 v150, v144, v145
    v_lshlrev_b32 v144, 16, v150
    v_and_b32 v145, 4294901760, v150
    v_lshlrev_b32 v148, 16, v162
    v_and_b32 v149, 4294901760, v162
    v_add_f32 v148, v148, v144
    v_add_f32 v149, v149, v145
    v_cvt_pk_bf16_f32 v6, v148, v149
    v_lshlrev_b32 v152, 16, v7
    v_and_b32 v153, 4294901760, v7
    v_lshlrev_b32 v154, 16, v115
    v_and_b32 v155, 4294901760, v115
    v_mul_f32 v152, v152, v154
    v_mul_f32 v153, v153, v155
    v_cvt_pk_bf16_f32 v158, v152, v153
    v_lshlrev_b32 v152, 16, v158
    v_and_b32 v153, 4294901760, v158
    v_lshlrev_b32 v156, 16, v163
    v_and_b32 v157, 4294901760, v163
    v_add_f32 v156, v156, v152
    v_add_f32 v157, v157, v153
    v_cvt_pk_bf16_f32 v7, v156, v157
    s_mov_b32 s27, 0
    buffer_store_dwordx4 v[4:7], v100, s[12:15], s27 offen
    v_lshlrev_b32 v144, 16, v8
    v_and_b32 v145, 4294901760, v8
    v_lshlrev_b32 v146, 16, v116
    v_and_b32 v147, 4294901760, v116
    v_mul_f32 v144, v144, v146
    v_mul_f32 v145, v145, v147
    v_cvt_pk_bf16_f32 v150, v144, v145
    v_lshlrev_b32 v144, 16, v150
    v_and_b32 v145, 4294901760, v150
    v_lshlrev_b32 v148, 16, v164
    v_and_b32 v149, 4294901760, v164
    v_add_f32 v148, v148, v144
    v_add_f32 v149, v149, v145
    v_cvt_pk_bf16_f32 v8, v148, v149
    v_lshlrev_b32 v152, 16, v9
    v_and_b32 v153, 4294901760, v9
    v_lshlrev_b32 v154, 16, v117
    v_and_b32 v155, 4294901760, v117
    v_mul_f32 v152, v152, v154
    v_mul_f32 v153, v153, v155
    v_cvt_pk_bf16_f32 v158, v152, v153
    v_lshlrev_b32 v152, 16, v158
    v_and_b32 v153, 4294901760, v158
    v_lshlrev_b32 v156, 16, v165
    v_and_b32 v157, 4294901760, v165
    v_add_f32 v156, v156, v152
    v_add_f32 v157, v157, v153
    v_cvt_pk_bf16_f32 v9, v156, v157
    v_lshlrev_b32 v144, 16, v10
    v_and_b32 v145, 4294901760, v10
    v_lshlrev_b32 v146, 16, v118
    v_and_b32 v147, 4294901760, v118
    v_mul_f32 v144, v144, v146
    v_mul_f32 v145, v145, v147
    v_cvt_pk_bf16_f32 v150, v144, v145
    v_lshlrev_b32 v144, 16, v150
    v_and_b32 v145, 4294901760, v150
    v_lshlrev_b32 v148, 16, v166
    v_and_b32 v149, 4294901760, v166
    v_add_f32 v148, v148, v144
    v_add_f32 v149, v149, v145
    v_cvt_pk_bf16_f32 v10, v148, v149
    v_lshlrev_b32 v152, 16, v11
    v_and_b32 v153, 4294901760, v11
    v_lshlrev_b32 v154, 16, v119
    v_and_b32 v155, 4294901760, v119
    v_mul_f32 v152, v152, v154
    v_mul_f32 v153, v153, v155
    v_cvt_pk_bf16_f32 v158, v152, v153
    v_lshlrev_b32 v152, 16, v158
    v_and_b32 v153, 4294901760, v158
    v_lshlrev_b32 v156, 16, v167
    v_and_b32 v157, 4294901760, v167
    v_add_f32 v156, v156, v152
    v_add_f32 v157, v157, v153
    v_cvt_pk_bf16_f32 v11, v156, v157
    s_mov_b32 s27, 0
    buffer_store_dwordx4 v[8:11], v100, s[12:15], s27 offen offset:64
    v_lshlrev_b32 v144, 16, v12
    v_and_b32 v145, 4294901760, v12
    v_lshlrev_b32 v146, 16, v120
    v_and_b32 v147, 4294901760, v120
    v_mul_f32 v144, v144, v146
    v_mul_f32 v145, v145, v147
    v_cvt_pk_bf16_f32 v150, v144, v145
    v_lshlrev_b32 v144, 16, v150
    v_and_b32 v145, 4294901760, v150
    v_lshlrev_b32 v148, 16, v168
    v_and_b32 v149, 4294901760, v168
    v_add_f32 v148, v148, v144
    v_add_f32 v149, v149, v145
    v_cvt_pk_bf16_f32 v12, v148, v149
    v_lshlrev_b32 v152, 16, v13
    v_and_b32 v153, 4294901760, v13
    v_lshlrev_b32 v154, 16, v121
    v_and_b32 v155, 4294901760, v121
    v_mul_f32 v152, v152, v154
    v_mul_f32 v153, v153, v155
    v_cvt_pk_bf16_f32 v158, v152, v153
    v_lshlrev_b32 v152, 16, v158
    v_and_b32 v153, 4294901760, v158
    v_lshlrev_b32 v156, 16, v169
    v_and_b32 v157, 4294901760, v169
    v_add_f32 v156, v156, v152
    v_add_f32 v157, v157, v153
    v_cvt_pk_bf16_f32 v13, v156, v157
    v_lshlrev_b32 v144, 16, v14
    v_and_b32 v145, 4294901760, v14
    v_lshlrev_b32 v146, 16, v122
    v_and_b32 v147, 4294901760, v122
    v_mul_f32 v144, v144, v146
    v_mul_f32 v145, v145, v147
    v_cvt_pk_bf16_f32 v150, v144, v145
    v_lshlrev_b32 v144, 16, v150
    v_and_b32 v145, 4294901760, v150
    v_lshlrev_b32 v148, 16, v170
    v_and_b32 v149, 4294901760, v170
    v_add_f32 v148, v148, v144
    v_add_f32 v149, v149, v145
    v_cvt_pk_bf16_f32 v14, v148, v149
    v_lshlrev_b32 v152, 16, v15
    v_and_b32 v153, 4294901760, v15
    v_lshlrev_b32 v154, 16, v123
    v_and_b32 v155, 4294901760, v123
    v_mul_f32 v152, v152, v154
    v_mul_f32 v153, v153, v155
    v_cvt_pk_bf16_f32 v158, v152, v153
    v_lshlrev_b32 v152, 16, v158
    v_and_b32 v153, 4294901760, v158
    v_lshlrev_b32 v156, 16, v171
    v_and_b32 v157, 4294901760, v171
    v_add_f32 v156, v156, v152
    v_add_f32 v157, v157, v153
    v_cvt_pk_bf16_f32 v15, v156, v157
    s_mov_b32 s27, 32768
    buffer_store_dwordx4 v[12:15], v100, s[12:15], s27 offen
    v_lshlrev_b32 v144, 16, v16
    v_and_b32 v145, 4294901760, v16
    v_lshlrev_b32 v146, 16, v124
    v_and_b32 v147, 4294901760, v124
    v_mul_f32 v144, v144, v146
    v_mul_f32 v145, v145, v147
    v_cvt_pk_bf16_f32 v150, v144, v145
    v_lshlrev_b32 v144, 16, v150
    v_and_b32 v145, 4294901760, v150
    v_lshlrev_b32 v148, 16, v172
    v_and_b32 v149, 4294901760, v172
    v_add_f32 v148, v148, v144
    v_add_f32 v149, v149, v145
    v_cvt_pk_bf16_f32 v16, v148, v149
    v_lshlrev_b32 v152, 16, v17
    v_and_b32 v153, 4294901760, v17
    v_lshlrev_b32 v154, 16, v125
    v_and_b32 v155, 4294901760, v125
    v_mul_f32 v152, v152, v154
    v_mul_f32 v153, v153, v155
    v_cvt_pk_bf16_f32 v158, v152, v153
    v_lshlrev_b32 v152, 16, v158
    v_and_b32 v153, 4294901760, v158
    v_lshlrev_b32 v156, 16, v173
    v_and_b32 v157, 4294901760, v173
    v_add_f32 v156, v156, v152
    v_add_f32 v157, v157, v153
    v_cvt_pk_bf16_f32 v17, v156, v157
    v_lshlrev_b32 v144, 16, v18
    v_and_b32 v145, 4294901760, v18
    v_lshlrev_b32 v146, 16, v126
    v_and_b32 v147, 4294901760, v126
    v_mul_f32 v144, v144, v146
    v_mul_f32 v145, v145, v147
    v_cvt_pk_bf16_f32 v150, v144, v145
    v_lshlrev_b32 v144, 16, v150
    v_and_b32 v145, 4294901760, v150
    v_lshlrev_b32 v148, 16, v174
    v_and_b32 v149, 4294901760, v174
    v_add_f32 v148, v148, v144
    v_add_f32 v149, v149, v145
    v_cvt_pk_bf16_f32 v18, v148, v149
    v_lshlrev_b32 v152, 16, v19
    v_and_b32 v153, 4294901760, v19
    v_lshlrev_b32 v154, 16, v127
    v_and_b32 v155, 4294901760, v127
    v_mul_f32 v152, v152, v154
    v_mul_f32 v153, v153, v155
    v_cvt_pk_bf16_f32 v158, v152, v153
    v_lshlrev_b32 v152, 16, v158
    v_and_b32 v153, 4294901760, v158
    v_lshlrev_b32 v156, 16, v175
    v_and_b32 v157, 4294901760, v175
    v_add_f32 v156, v156, v152
    v_add_f32 v157, v157, v153
    v_cvt_pk_bf16_f32 v19, v156, v157
    s_mov_b32 s27, 32768
    buffer_store_dwordx4 v[16:19], v100, s[12:15], s27 offen offset:64
    v_lshlrev_b32 v144, 16, v20
    v_and_b32 v145, 4294901760, v20
    v_lshlrev_b32 v146, 16, v128
    v_and_b32 v147, 4294901760, v128
    v_mul_f32 v144, v144, v146
    v_mul_f32 v145, v145, v147
    v_cvt_pk_bf16_f32 v150, v144, v145
    v_lshlrev_b32 v144, 16, v150
    v_and_b32 v145, 4294901760, v150
    v_lshlrev_b32 v148, 16, v176
    v_and_b32 v149, 4294901760, v176
    v_add_f32 v148, v148, v144
    v_add_f32 v149, v149, v145
    v_cvt_pk_bf16_f32 v20, v148, v149
    v_lshlrev_b32 v152, 16, v21
    v_and_b32 v153, 4294901760, v21
    v_lshlrev_b32 v154, 16, v129
    v_and_b32 v155, 4294901760, v129
    v_mul_f32 v152, v152, v154
    v_mul_f32 v153, v153, v155
    v_cvt_pk_bf16_f32 v158, v152, v153
    v_lshlrev_b32 v152, 16, v158
    v_and_b32 v153, 4294901760, v158
    v_lshlrev_b32 v156, 16, v177
    v_and_b32 v157, 4294901760, v177
    v_add_f32 v156, v156, v152
    v_add_f32 v157, v157, v153
    v_cvt_pk_bf16_f32 v21, v156, v157
    v_lshlrev_b32 v144, 16, v22
    v_and_b32 v145, 4294901760, v22
    v_lshlrev_b32 v146, 16, v130
    v_and_b32 v147, 4294901760, v130
    v_mul_f32 v144, v144, v146
    v_mul_f32 v145, v145, v147
    v_cvt_pk_bf16_f32 v150, v144, v145
    v_lshlrev_b32 v144, 16, v150
    v_and_b32 v145, 4294901760, v150
    v_lshlrev_b32 v148, 16, v178
    v_and_b32 v149, 4294901760, v178
    v_add_f32 v148, v148, v144
    v_add_f32 v149, v149, v145
    v_cvt_pk_bf16_f32 v22, v148, v149
    v_lshlrev_b32 v152, 16, v23
    v_and_b32 v153, 4294901760, v23
    v_lshlrev_b32 v154, 16, v131
    v_and_b32 v155, 4294901760, v131
    v_mul_f32 v152, v152, v154
    v_mul_f32 v153, v153, v155
    v_cvt_pk_bf16_f32 v158, v152, v153
    v_lshlrev_b32 v152, 16, v158
    v_and_b32 v153, 4294901760, v158
    v_lshlrev_b32 v156, 16, v179
    v_and_b32 v157, 4294901760, v179
    v_add_f32 v156, v156, v152
    v_add_f32 v157, v157, v153
    v_cvt_pk_bf16_f32 v23, v156, v157
    s_mov_b32 s27, 65536
    buffer_store_dwordx4 v[20:23], v100, s[12:15], s27 offen
    v_lshlrev_b32 v144, 16, v24
    v_and_b32 v145, 4294901760, v24
    v_lshlrev_b32 v146, 16, v132
    v_and_b32 v147, 4294901760, v132
    v_mul_f32 v144, v144, v146
    v_mul_f32 v145, v145, v147
    v_cvt_pk_bf16_f32 v150, v144, v145
    v_lshlrev_b32 v144, 16, v150
    v_and_b32 v145, 4294901760, v150
    v_lshlrev_b32 v148, 16, v180
    v_and_b32 v149, 4294901760, v180
    v_add_f32 v148, v148, v144
    v_add_f32 v149, v149, v145
    v_cvt_pk_bf16_f32 v24, v148, v149
    v_lshlrev_b32 v152, 16, v25
    v_and_b32 v153, 4294901760, v25
    v_lshlrev_b32 v154, 16, v133
    v_and_b32 v155, 4294901760, v133
    v_mul_f32 v152, v152, v154
    v_mul_f32 v153, v153, v155
    v_cvt_pk_bf16_f32 v158, v152, v153
    v_lshlrev_b32 v152, 16, v158
    v_and_b32 v153, 4294901760, v158
    v_lshlrev_b32 v156, 16, v181
    v_and_b32 v157, 4294901760, v181
    v_add_f32 v156, v156, v152
    v_add_f32 v157, v157, v153
    v_cvt_pk_bf16_f32 v25, v156, v157
    v_lshlrev_b32 v144, 16, v26
    v_and_b32 v145, 4294901760, v26
    v_lshlrev_b32 v146, 16, v134
    v_and_b32 v147, 4294901760, v134
    v_mul_f32 v144, v144, v146
    v_mul_f32 v145, v145, v147
    v_cvt_pk_bf16_f32 v150, v144, v145
    v_lshlrev_b32 v144, 16, v150
    v_and_b32 v145, 4294901760, v150
    v_lshlrev_b32 v148, 16, v182
    v_and_b32 v149, 4294901760, v182
    v_add_f32 v148, v148, v144
    v_add_f32 v149, v149, v145
    v_cvt_pk_bf16_f32 v26, v148, v149
    v_lshlrev_b32 v152, 16, v27
    v_and_b32 v153, 4294901760, v27
    v_lshlrev_b32 v154, 16, v135
    v_and_b32 v155, 4294901760, v135
    v_mul_f32 v152, v152, v154
    v_mul_f32 v153, v153, v155
    v_cvt_pk_bf16_f32 v158, v152, v153
    v_lshlrev_b32 v152, 16, v158
    v_and_b32 v153, 4294901760, v158
    v_lshlrev_b32 v156, 16, v183
    v_and_b32 v157, 4294901760, v183
    v_add_f32 v156, v156, v152
    v_add_f32 v157, v157, v153
    v_cvt_pk_bf16_f32 v27, v156, v157
    s_mov_b32 s27, 65536
    buffer_store_dwordx4 v[24:27], v100, s[12:15], s27 offen offset:64
    v_lshlrev_b32 v144, 16, v28
    v_and_b32 v145, 4294901760, v28
    v_lshlrev_b32 v146, 16, v136
    v_and_b32 v147, 4294901760, v136
    v_mul_f32 v144, v144, v146
    v_mul_f32 v145, v145, v147
    v_cvt_pk_bf16_f32 v150, v144, v145
    v_lshlrev_b32 v144, 16, v150
    v_and_b32 v145, 4294901760, v150
    v_lshlrev_b32 v148, 16, v184
    v_and_b32 v149, 4294901760, v184
    v_add_f32 v148, v148, v144
    v_add_f32 v149, v149, v145
    v_cvt_pk_bf16_f32 v28, v148, v149
    v_lshlrev_b32 v152, 16, v29
    v_and_b32 v153, 4294901760, v29
    v_lshlrev_b32 v154, 16, v137
    v_and_b32 v155, 4294901760, v137
    v_mul_f32 v152, v152, v154
    v_mul_f32 v153, v153, v155
    v_cvt_pk_bf16_f32 v158, v152, v153
    v_lshlrev_b32 v152, 16, v158
    v_and_b32 v153, 4294901760, v158
    v_lshlrev_b32 v156, 16, v185
    v_and_b32 v157, 4294901760, v185
    v_add_f32 v156, v156, v152
    v_add_f32 v157, v157, v153
    v_cvt_pk_bf16_f32 v29, v156, v157
    v_lshlrev_b32 v144, 16, v30
    v_and_b32 v145, 4294901760, v30
    v_lshlrev_b32 v146, 16, v138
    v_and_b32 v147, 4294901760, v138
    v_mul_f32 v144, v144, v146
    v_mul_f32 v145, v145, v147
    v_cvt_pk_bf16_f32 v150, v144, v145
    v_lshlrev_b32 v144, 16, v150
    v_and_b32 v145, 4294901760, v150
    v_lshlrev_b32 v148, 16, v186
    v_and_b32 v149, 4294901760, v186
    v_add_f32 v148, v148, v144
    v_add_f32 v149, v149, v145
    v_cvt_pk_bf16_f32 v30, v148, v149
    v_lshlrev_b32 v152, 16, v31
    v_and_b32 v153, 4294901760, v31
    v_lshlrev_b32 v154, 16, v139
    v_and_b32 v155, 4294901760, v139
    v_mul_f32 v152, v152, v154
    v_mul_f32 v153, v153, v155
    v_cvt_pk_bf16_f32 v158, v152, v153
    v_lshlrev_b32 v152, 16, v158
    v_and_b32 v153, 4294901760, v158
    v_lshlrev_b32 v156, 16, v187
    v_and_b32 v157, 4294901760, v187
    v_add_f32 v156, v156, v152
    v_add_f32 v157, v157, v153
    v_cvt_pk_bf16_f32 v31, v156, v157
    s_mov_b32 s27, 98304
    buffer_store_dwordx4 v[28:31], v100, s[12:15], s27 offen
    v_lshlrev_b32 v144, 16, v32
    v_and_b32 v145, 4294901760, v32
    v_lshlrev_b32 v146, 16, v140
    v_and_b32 v147, 4294901760, v140
    v_mul_f32 v144, v144, v146
    v_mul_f32 v145, v145, v147
    v_cvt_pk_bf16_f32 v150, v144, v145
    v_lshlrev_b32 v144, 16, v150
    v_and_b32 v145, 4294901760, v150
    v_lshlrev_b32 v148, 16, v188
    v_and_b32 v149, 4294901760, v188
    v_add_f32 v148, v148, v144
    v_add_f32 v149, v149, v145
    v_cvt_pk_bf16_f32 v32, v148, v149
    v_lshlrev_b32 v152, 16, v33
    v_and_b32 v153, 4294901760, v33
    v_lshlrev_b32 v154, 16, v141
    v_and_b32 v155, 4294901760, v141
    v_mul_f32 v152, v152, v154
    v_mul_f32 v153, v153, v155
    v_cvt_pk_bf16_f32 v158, v152, v153
    v_lshlrev_b32 v152, 16, v158
    v_and_b32 v153, 4294901760, v158
    v_lshlrev_b32 v156, 16, v189
    v_and_b32 v157, 4294901760, v189
    v_add_f32 v156, v156, v152
    v_add_f32 v157, v157, v153
    v_cvt_pk_bf16_f32 v33, v156, v157
    v_lshlrev_b32 v144, 16, v34
    v_and_b32 v145, 4294901760, v34
    v_lshlrev_b32 v146, 16, v142
    v_and_b32 v147, 4294901760, v142
    v_mul_f32 v144, v144, v146
    v_mul_f32 v145, v145, v147
    v_cvt_pk_bf16_f32 v150, v144, v145
    v_lshlrev_b32 v144, 16, v150
    v_and_b32 v145, 4294901760, v150
    v_lshlrev_b32 v148, 16, v190
    v_and_b32 v149, 4294901760, v190
    v_add_f32 v148, v148, v144
    v_add_f32 v149, v149, v145
    v_cvt_pk_bf16_f32 v34, v148, v149
    v_lshlrev_b32 v152, 16, v35
    v_and_b32 v153, 4294901760, v35
    v_lshlrev_b32 v154, 16, v143
    v_and_b32 v155, 4294901760, v143
    v_mul_f32 v152, v152, v154
    v_mul_f32 v153, v153, v155
    v_cvt_pk_bf16_f32 v158, v152, v153
    v_lshlrev_b32 v152, 16, v158
    v_and_b32 v153, 4294901760, v158
    v_lshlrev_b32 v156, 16, v191
    v_and_b32 v157, 4294901760, v191
    v_add_f32 v156, v156, v152
    v_add_f32 v157, v157, v153
    v_cvt_pk_bf16_f32 v35, v156, v157
    s_mov_b32 s27, 98304
    buffer_store_dwordx4 v[32:35], v100, s[12:15], s27 offen offset:64
gemm2_kernel_end:
    s_endpgm
.section .rodata,"a"
.p2align 6
.amdhsa_kernel ln_kernel
  .amdhsa_next_free_vgpr 72
  .amdhsa_next_free_sgpr 32
  .amdhsa_accum_offset 72
  .amdhsa_group_segment_fixed_size 0
  .amdhsa_kernarg_size 88
  .amdhsa_user_sgpr_count 2
  .amdhsa_user_sgpr_kernarg_segment_ptr 1
  .amdhsa_system_sgpr_workgroup_id_x 1
  .amdhsa_float_denorm_mode_32 3
.end_amdhsa_kernel
.p2align 6
.amdhsa_kernel gemm1_kernel
  .amdhsa_next_free_vgpr 436
  .amdhsa_next_free_sgpr 64
  .amdhsa_accum_offset 180
  .amdhsa_group_segment_fixed_size 0
  .amdhsa_kernarg_size 88
  .amdhsa_user_sgpr_count 2
  .amdhsa_user_sgpr_kernarg_segment_ptr 1
  .amdhsa_system_sgpr_workgroup_id_x 1
  .amdhsa_float_denorm_mode_32 3
.end_amdhsa_kernel
.p2align 6
.amdhsa_kernel attn_kernel
  .amdhsa_next_free_vgpr 252
  .amdhsa_next_free_sgpr 48
  .amdhsa_accum_offset 252
  .amdhsa_group_segment_fixed_size 0
  .amdhsa_kernarg_size 88
  .amdhsa_user_sgpr_count 2
  .amdhsa_user_sgpr_kernarg_segment_ptr 1
  .amdhsa_system_sgpr_workgroup_id_x 1
  .amdhsa_float_denorm_mode_32 3
.end_amdhsa_kernel
.p2align 6
.amdhsa_kernel gemm2_kernel
  .amdhsa_next_free_vgpr 256
  .amdhsa_next_free_sgpr 64
  .amdhsa_accum_offset 192
  .amdhsa_group_segment_fixed_size 0
  .amdhsa_kernarg_size 88
  .amdhsa_user_sgpr_count 2
  .amdhsa_user_sgpr_kernarg_segment_ptr 1
  .amdhsa_system_sgpr_workgroup_id_x 1
  .amdhsa_float_denorm_mode_32 3
.end_amdhsa_kernel
```
